```python
import torch

def _softmax(x, axis=-1):
    return torch.softmax(x, dim=axis)
def _gelu(x):
    return torch.nn.functional.gelu(x, approximate="tanh")
def _silu(x):
    return torch.nn.functional.silu(x)
def _sigmoid(x):
    return torch.sigmoid(x)
def _layernorm(x, axis=-1, eps=1e-5):
    m = x.mean(dim=axis, keepdim=True)
    v = x.var(dim=axis, keepdim=True, unbiased=False)
    return (x - m) / torch.sqrt(v + eps)
def _scatter_add(tgt, idx, src, axis=0):
    return tgt.clone().index_add_(axis, idx, src)
def _segment_sum(src, seg, n):
    out = torch.zeros((n,) + src.shape[1:], dtype=src.dtype)
    return out.index_add_(0, seg, src)
def _pad(x, pw):
    flat = tuple(v for pair in reversed(pw) for v in pair)
    return torch.nn.functional.pad(x, flat)

kernel_name = 'interleave_layers__linear_attn_block__dense_activation_silu__prompt'

def setup_inputs():

    _w = (lambda a: (lambda t: t.to(torch.bfloat16) if t.is_floating_point() else t)(torch.as_tensor(a)))
    def _A_setup():
        B, S, D = 1, 2048, 512
        return {
            "x": _w((lambda *s: torch.randn(*s, dtype=torch.bfloat16) * 0.05)(B, S, D)),
            "wqkv": _w((lambda *s: torch.randn(*s, dtype=torch.bfloat16) * 0.05)(D, 3 * D)),
            "wo": _w((lambda *s: torch.randn(*s, dtype=torch.bfloat16) * 0.05)(D, D)),
        }
    _A_in = _A_setup()

    def _B_setup():
        B, S, D, F = 1, 2048, 512, 1376
        return {
            "x": _w((lambda *s: torch.randn(*s, dtype=torch.bfloat16) * 0.05)(B, S, D)),
            "w1": _w((lambda *s: torch.randn(*s, dtype=torch.bfloat16) * 0.8)(D, F) * (D ** -0.5)),
            "w2": _w((lambda *s: torch.randn(*s, dtype=torch.bfloat16) * 0.8)(F, D) * (F ** -0.5)),
        }
    _B_in = _B_setup()

    return {
        "A_x": _A_in["x"],
        "A_wqkv": _A_in["wqkv"],
        "A_wo": _A_in["wo"],
        "B_x": _B_in["x"],
        "B_w1": _B_in["w1"],
        "B_w2": _B_in["w2"],
    }

def reference(A_x, A_wqkv, A_wo, B_x, B_w1, B_w2):
    def _A_ref(x, wqkv, wo):
        B, S, D = x.shape
        H = 32; Dh = D // H
        qkv = (lambda x, *d: x.permute(*d))((x @ wqkv).reshape(B, S, 3, H, Dh), 2, 0, 3, 1, 4)
        q, k, v = qkv[0], qkv[1], qkv[2]
        phi = lambda t: torch.where(t > 0, t + 1, torch.exp(t)) + 1e-6
        pq, pk = phi(q), phi(k)
        kv = torch.einsum("bhsd,bhse->bhde", pk, v)
        z = torch.einsum("bhsd->bhd", pk)
        num = torch.einsum("bhqd,bhde->bhqe", pq, kv)
        den = torch.einsum("bhqd,bhd->bhq", pq, z)[..., None] + 1e-6
        o = num / den
        return (lambda x, *d: x.permute(*d))(o, 0, 2, 1, 3).reshape(B, S, D) @ wo

    def _B_ref(x, w1, w2):
        h = torch.einsum("bsd,df->bsf", x, w1)
        h = _silu(h)
        out = torch.einsum("bsf,fd->bsd", h, w2)
        return out

    x = A_x
    x = x + _A_ref(_layernorm(x, axis=-1), A_wqkv, A_wo)
    x = x + _B_ref(_layernorm(x, axis=-1), B_w1, B_w2)
    x = x + _A_ref(_layernorm(x, axis=-1), A_wqkv, A_wo)
    x = x + _B_ref(_layernorm(x, axis=-1), B_w1, B_w2)
    return x
```

```asm
; @launch grid=(256,1,1) block=(256,1,1) lds=163840
.amdgcn_target "amdgcn-amd-amdhsa--gfx950"
.text
.globl interleave_layers__linear_attn_block__dense_activation_silu__prompt_kernel
.p2align 8
.type interleave_layers__linear_attn_block__dense_activation_silu__prompt_kernel,@function
interleave_layers__linear_attn_block__dense_activation_silu__prompt_kernel:
    s_cmp_ge_u32 s2, 256
    s_cbranch_scc1 L_end
    s_load_dwordx4 s[4:7], s[0:1], 0
    s_load_dwordx2 s[20:21], s[0:1], 64
    s_load_dwordx2 s[8:9], s[0:1], 16
    s_load_dwordx4 s[12:15], s[0:1], 32
    s_load_dwordx4 s[16:19], s[0:1], 48
    s_getpc_b64 s[90:91]
L_pc:
    v_lshrrev_b32 v156, 6, v0
    v_and_b32 v0, 63, v0
    v_readfirstlane_b32 s50, v156
    s_lshr_b32 s77, s2, 3
    s_lshl_b32 s79, s77, 2
    s_add_u32 s79, s79, s50
    s_and_b32 s76, s79, 31
    s_lshl_b32 s76, s76, 11
    v_lshlrev_b32 v179, 7, v0
    v_add_u32 v156, s76, v179
    v_min_u32 v156, L_end-L_pc, v156
    s_mov_b64 exec, 0xffff
    global_load_dword v178, v156, s[90:91]
    s_mov_b64 exec, -1
    s_and_b32 s40, s2, 7
    s_and_b32 s49, s77, 7
    s_lshr_b32 s10, s77, 3
    s_lshl_b32 s76, s40, 2
    s_add_u32 s48, s76, s10
    s_lshl_b32 s55, s48, 16
    s_lshl_b32 s99, s50, 11
    v_lshrrev_b32 v159, 4, v0
    v_and_b32 v158, 15, v0
    s_mul_i32 s78, s79, 12288
    v_lshlrev_b32 v169, 10, v0
    v_add_u32 v168, s78, v169
    s_lshl_b32 s78, s40, 18
    s_lshl_b32 s76, s79, 11
    s_add_u32 s76, s76, s78
    v_add_u32 v169, s76, v169
    v_lshrrev_b32 v162, 3, v0
    v_and_b32 v163, 7, v0
    v_xor_b32 v160, v163, v159
    v_lshlrev_b32 v160, 4, v160
    v_lshl_add_u32 v160, v162, 10, v160
    s_lshl_b32 s77, s50, 14
    v_add_u32 v11, s77, v160
    v_xor_b32 v12, 64, v11
    v_add_u32 v12, 7168, v12
    v_and_b32 v160, 1, v159
    v_lshlrev_b32 v160, 1, v160
    v_xor_b32 v164, v163, v160
    v_lshlrev_b32 v164, 4, v164
    s_and_b32 s77, s50, 1
    s_lshl_b32 s77, s77, 6
    v_xor_b32 v160, s77, v164
    s_lshl_b32 s77, s50, 3
    v_add_u32 v161, s77, v162
    v_mul_u32_u24 v161, 3072, v161
    v_add_u32 v13, v160, v161
    s_lshl_b32 s101, s49, 7
    v_add_u32 v13, s101, v13
    s_add_u32 s93, s99, 0xfc00
    s_lshl_b32 s100, s40, 7
    s_mul_i32 s101, s40, 196608
    s_waitcnt lgkmcnt(0)
    s_add_u32 s88, s20, 0x390000
    s_addc_u32 s89, s21, 0
    s_load_dword s23, s[88:89], 0
    s_mov_b32 s28, s6
    s_and_b32 s29, s7, 0xffff
    s_mov_b32 s30, 0x180000
    s_mov_b32 s31, 0x20000
    s_add_u32 s24, s4, s55
    s_addc_u32 s25, s5, 0
    s_and_b32 s25, s25, 0xffff
    s_mov_b32 s26, 0x10000
    s_mov_b32 s27, 0x20000
    s_mov_b32 s44, s4
    s_and_b32 s45, s5, 0xffff
    s_mov_b32 s46, 0x200000
    s_mov_b32 s47, 0x20000
    v_lshrrev_b32 v160, 3, v169
    v_lshlrev_b32 v160, 10, v0
    v_sub_u32 v169, v169, v160
    v_add_u32 v169, v169, v179
    s_sub_u32 s76, 0x180, s6
    s_and_b32 s76, s76, 0x380
    s_mov_b64 exec, 0xfff
    buffer_load_dword v178, v168, s[28:31], s76 offen
    s_sub_u32 s76, 0x180, s4
    s_and_b32 s76, s76, 0x0
    s_mov_b64 exec, 0xffff
    buffer_load_dword v178, v169, s[44:47], s76 offen
    s_mov_b64 exec, -1
    s_add_u32 m0, s99, 0x0
    s_nop 0
    buffer_load_dwordx4 v11, s[24:27], s100 offen lds
    buffer_load_dwordx4 v12, s[24:27], s100 offen offset:1024 lds
    s_add_u32 m0, s93, 0x0
    s_nop 0
    buffer_load_dwordx4 v13, s[28:31], s101 offen offset:1024 lds
    buffer_load_dwordx4 v13, s[28:31], s101 offen offset:2048 lds
    s_add_u32 s101, s101, 98304
    s_add_u32 m0, s93, 0x2000
    s_nop 0
    buffer_load_dwordx4 v13, s[28:31], s101 offen offset:1024 lds
    buffer_load_dwordx4 v13, s[28:31], s101 offen offset:2048 lds
    s_add_u32 m0, s99, 0x2000
    s_add_u32 s100, s100, 128
    s_and_b32 s100, s100, 0x380
    buffer_load_dwordx4 v11, s[24:27], s100 offen lds
    buffer_load_dwordx4 v12, s[24:27], s100 offen offset:1024 lds
    s_add_u32 s101, s101, 98304
    s_cmp_eq_u32 s101, 1572864
    s_cselect_b32 s101, 0, s101
    s_add_u32 m0, s93, 0x4000
    s_nop 0
    buffer_load_dwordx4 v13, s[28:31], s101 offen offset:1024 lds
    buffer_load_dwordx4 v13, s[28:31], s101 offen offset:2048 lds
    s_add_u32 s101, s101, 98304
    s_add_u32 m0, s93, 0x6000
    s_nop 0
    buffer_load_dwordx4 v13, s[28:31], s101 offen offset:1024 lds
    buffer_load_dwordx4 v13, s[28:31], s101 offen offset:2048 lds
    s_getreg_b32 s97, hwreg(HW_REG_XCC_ID, 0, 4)
    s_mov_b32 s61, 0x100000
    s_mov_b32 s32, s20
    s_and_b32 s33, s21, 0xffff
    s_mov_b32 s34, 0x1000000
    s_mov_b32 s35, 0x20000
    s_mov_b32 s36, s16
    s_and_b32 s37, s17, 0xffff
    s_mov_b32 s38, 0x200000
    s_mov_b32 s39, 0x20000
    v_lshlrev_b32 v1, 4, v0
    v_lshlrev_b32 v15, 2, v0
    s_lshl_b32 s43, s50, 10
    s_lshl_b32 s76, s49, 2
    s_add_u32 s76, s76, s50
    s_mul_i32 s53, s76, 2688
    s_add_u32 s53, s53, 0x480000
    v_mov_b32 v19, 0
    s_and_b32 s77, s48, 15
    s_mul_i32 s77, s77, 168
    s_add_u32 s77, s77, s53
    s_lshr_b32 s78, s48, 4
    s_mul_i32 s78, s78, 86016
    s_add_u32 s77, s77, s78
    v_mov_b32 v180, 0
    v_mov_b32 v181, 0
    v_lshlrev_b32 v160, 3, v0
    s_mov_b32 exec_lo, 0x1fffff
    s_mov_b32 exec_hi, 0x0
    buffer_store_dwordx2 v[180:181], v160, s[32:35], s77 offen sc1
    s_mov_b64 exec, -1
    s_mul_i32 s52, s76, 109568
    s_lshl_b32 s54, s48, 7
    s_lshl_b32 s3, s49, 12
    s_add_u32 s3, s3, 0x398000
    s_add_u32 s54, s54, 0x380000
    s_lshl_b32 s98, s76, 2
    s_add_u32 s98, s98, s54
    s_lshl_b32 s42, s48, 14
    s_add_u32 s42, s42, 0x400000
    s_lshl_b32 s41, s76, 8
    s_add_u32 s41, s41, s42
    s_add_u32 s42, s42, s99
    s_mul_i32 s56, s48, 180224
    s_lshl_b32 s57, s49, 12
    s_lshl_b32 s77, s50, 9
    s_add_u32 s57, s57, s77
    s_lshl_b32 s63, s76, 5
    s_mul_i32 s76, s76, 3
    s_add_u32 s77, s76, 0
    s_lshr_b32 s78, s77, 2
    s_lshl_b32 s78, s78, 12
    s_and_b32 s79, s77, 3
    s_lshl_b32 s79, s79, 9
    s_add_u32 s78, s78, s79
    s_add_u32 s78, s78, s56
    s_cmp_lt_u32 s77, 86
    s_cselect_b32 s58, s78, 0x1000000
    s_cselect_b32 s78, 0, 0x1000000
    v_add_u32 v192, s78, v1
    s_add_u32 s77, s76, 1
    s_lshr_b32 s78, s77, 2
    s_lshl_b32 s78, s78, 12
    s_and_b32 s79, s77, 3
    s_lshl_b32 s79, s79, 9
    s_add_u32 s78, s78, s79
    s_add_u32 s78, s78, s56
    s_cmp_lt_u32 s77, 86
    s_cselect_b32 s59, s78, 0x1000000
    s_cselect_b32 s78, 0, 0x1000000
    v_add_u32 v193, s78, v1
    s_add_u32 s77, s76, 2
    s_lshr_b32 s78, s77, 2
    s_lshl_b32 s78, s78, 12
    s_and_b32 s79, s77, 3
    s_lshl_b32 s79, s79, 9
    s_add_u32 s78, s78, s79
    s_add_u32 s78, s78, s56
    s_cmp_lt_u32 s77, 86
    s_cselect_b32 s60, s78, 0x1000000
    s_cselect_b32 s78, 0, 0x1000000
    v_add_u32 v194, s78, v1
    v_add_u32 v2, 0x10000, v1
    v_add_u32 v4, s43, v1
    v_add_u32 v181, s99, v1
    s_lshr_b32 s77, s50, 1
    s_add_u32 s66, s40, s77
    s_and_b32 s66, s66, 7
    s_lshl_b32 s66, s66, 12
    s_lshl_b32 s77, s77, 12
    s_sub_u32 s65, s55, s77
    v_and_b32 v14, 0x7c, v15
    v_lshrrev_b32 v160, 1, v159
    v_lshlrev_b32 v160, 8, v160
    v_lshl_add_u32 v160, v158, 4, v160
    v_and_b32 v161, 1, v159
    v_lshl_add_u32 v5, v161, 11, v160
    v_lshlrev_b32 v17, 4, v159
    v_add_u32 v17, 0x26800, v17
    v_lshlrev_b32 v18, 3, v158
    v_add_u32 v18, 0x26a00, v18
    s_lshl_b32 s76, s50, 6
    s_add_u32 s76, s76, 0x26800
    v_lshlrev_b32 v177, 2, v158
    v_add_u32 v177, s76, v177
    v_lshrrev_b32 v160, 3, v158
    v_lshlrev_b32 v160, 10, v160
    v_and_b32 v161, 7, v158
    v_lshl_add_u32 v160, v161, 7, v160
    v_lshrrev_b32 v161, 1, v158
    v_xor_b32 v161, v161, v159
    v_lshl_add_u32 v6, v161, 4, v160
    v_xor_b32 v7, 64, v6
    v_add_u32 v8, s99, v6
    v_add_u32 v9, s99, v7
    v_bfe_u32 v160, v0, 2, 2
    v_bfe_u32 v161, v0, 3, 1
    v_lshlrev_b32 v161, 1, v161
    v_bfe_u32 v166, v0, 4, 1
    v_lshl_add_u32 v161, v166, 2, v161
    v_bfe_u32 v166, v0, 1, 1
    v_xor_b32 v161, v161, v166
    v_lshlrev_b32 v161, 4, v161
    v_lshl_add_u32 v165, v160, 7, v161
    v_and_b32 v166, 1, v0
    v_lshl_add_u32 v165, v166, 3, v165
    s_lshl_b32 s77, s50, 5
    v_xor_b32 v160, s77, v165
    v_lshl_add_u32 v195, v159, 10, v160
    v_add_u32 v195, 0x14000, v195
    v_lshl_add_u32 v160, v159, 11, v160
    v_add_u32 v10, 0x10000, v160
    v_mov_b32 v56, 0x3f803f80
    v_mov_b32 v57, 0x3f803f80
    v_mov_b32 v58, 0x3f803f80
    v_mov_b32 v59, 0x3f803f80
    v_mov_b32 v182, 0x3fb8aa3b
    v_mov_b32 v183, 0x358637bd
    s_mul_i32 s76, s50, 2560
    s_add_u32 s76, s76, 0x24000
    v_add_u32 v3, s76, v15
    v_add_u32 v160, 0, v0
    v_mul_u32_u24 v161, 4370, v160
    v_lshrrev_b32 v161, 16, v161
    v_add_u32 v160, v160, v161
    v_lshlrev_b32 v160, 2, v160
    v_add_u32 v172, s76, v160
    v_add_u32 v160, 64, v0
    v_mul_u32_u24 v161, 4370, v160
    v_lshrrev_b32 v161, 16, v161
    v_add_u32 v160, v160, v161
    v_lshlrev_b32 v160, 2, v160
    v_add_u32 v173, s76, v160
    v_add_u32 v160, 128, v0
    v_mul_u32_u24 v161, 4370, v160
    v_lshrrev_b32 v161, 16, v161
    v_add_u32 v160, v160, v161
    v_lshlrev_b32 v160, 2, v160
    v_add_u32 v174, s76, v160
    v_add_u32 v160, 192, v0
    v_mul_u32_u24 v161, 4370, v160
    v_lshrrev_b32 v161, 16, v161
    v_add_u32 v160, v160, v161
    v_lshlrev_b32 v160, 2, v160
    v_add_u32 v175, s76, v160
    v_lshrrev_b32 v160, 1, v159
    v_add_u32 v160, v160, v159
    v_lshlrev_b32 v160, 4, v160
    s_add_u32 s76, s76, 1104
    v_add_u32 v176, s76, v160
    v_cmp_eq_u32 vcc, 15, v158
    s_nop 1
    v_cndmask_b32 v160, 0, 1.0, vcc
    s_waitcnt lgkmcnt(0)
    ds_write_b32 v3, v160 offset:0
    ds_write_b32 v3, v160 offset:256
    ds_write_b32 v3, v160 offset:512
    ds_write_b32 v3, v160 offset:768
    ds_write_b32 v3, v160 offset:1024
    s_xor_b32 s22, s23, 0x80000000
    s_and_b32 s22, s22, 0xfffffff0
    s_mov_b32 s62, 0x358637bd
    s_mov_b32 s68, 0x22222222
    s_mov_b32 s69, 0x22222222
    s_mov_b32 s70, 0x44444444
    s_mov_b32 s71, 0x44444444
    s_mov_b32 s72, 0x88888888
    s_mov_b32 s73, 0x88888888
    s_mov_b32 s74, 0x00f0000f
    s_mov_b32 s75, 0xf0000f00
    v_lshlrev_b32 v160, 10, v159
    s_lshl_b32 s76, s50, 12
    v_add_u32 v160, s76, v160
    v_xor_b32 v48, 0, v165
    v_add_u32 v48, v48, v160
    v_add_u32 v48, 0x20000, v48
    v_xor_b32 v49, 32, v165
    v_add_u32 v49, v49, v160
    v_add_u32 v49, 0x20000, v49
    v_xor_b32 v50, 64, v165
    v_add_u32 v50, v50, v160
    v_add_u32 v50, 0x20000, v50
    v_xor_b32 v51, 96, v165
    v_add_u32 v51, v51, v160
    v_add_u32 v51, 0x20000, v51
    v_and_b32 v170, 31, v0
    v_lshlrev_b32 v170, 10, v170
    v_lshrrev_b32 v160, 5, v0
    v_lshl_add_u32 v170, v160, 4, v170
    s_add_u32 s76, s22, s97
    v_mov_b32 v171, s76
    s_lshl_b32 s76, s48, 2
    s_add_u32 s76, s76, s50
    s_mul_i32 s88, s49, 438272
    s_mov_b32 s47, 0x20000
    s_cmp_ge_u32 s76, 16
    s_cbranch_scc1 Lpk_1
    s_mov_b32 s44, s8
    s_and_b32 s45, s9, 0xffff
    s_mov_b32 s46, 524288
    s_movk_i32 s78, 1024
    s_lshl_b32 s77, s76, 15
    s_lshl_b32 s89, s49, 7
    s_add_u32 s77, s77, s89
    s_add_u32 s89, s76, 0
    s_lshl_b32 s89, s89, 10
    s_add_u32 s88, s88, s89
    s_add_u32 s80, s88, 0
    s_add_u32 s81, s88, 109568
    s_add_u32 s82, s88, 219136
    s_add_u32 s83, s88, 328704
    s_branch Lpk_4
Lpk_1:
    s_cmp_ge_u32 s76, 64
    s_cbranch_scc1 Lpk_2
    s_sub_u32 s76, s76, 16
    s_mul_i32 s89, s76, 43
    s_lshr_b32 s89, s89, 7
    s_mul_i32 s92, s89, 3
    s_sub_u32 s92, s76, s92
    s_mov_b32 s44, s12
    s_and_b32 s45, s13, 0xffff
    s_mov_b32 s46, 1409024
    s_movk_i32 s78, 2752
    s_mul_i32 s77, s89, 88064
    s_mul_i32 s79, s49, 384
    s_add_u32 s77, s77, s79
    s_lshl_b32 s79, s92, 7
    s_add_u32 s77, s77, s79
    s_mul_i32 s89, s89, 3072
    s_add_u32 s88, s88, s89
    s_add_u32 s88, s88, 16384
    s_lshl_b32 s79, s92, 2
    s_add_u32 s79, s79, 0
    s_mul_i32 s89, s79, 43
    s_lshr_b32 s89, s89, 7
    s_mul_i32 s80, s89, 106496
    s_lshl_b32 s79, s79, 10
    s_add_u32 s80, s80, s79
    s_add_u32 s80, s80, s88
    s_lshl_b32 s79, s92, 2
    s_add_u32 s79, s79, 1
    s_mul_i32 s89, s79, 43
    s_lshr_b32 s89, s89, 7
    s_mul_i32 s81, s89, 106496
    s_lshl_b32 s79, s79, 10
    s_add_u32 s81, s81, s79
    s_add_u32 s81, s81, s88
    s_lshl_b32 s79, s92, 2
    s_add_u32 s79, s79, 2
    s_mul_i32 s89, s79, 43
    s_lshr_b32 s89, s89, 7
    s_mul_i32 s82, s89, 106496
    s_lshl_b32 s79, s79, 10
    s_add_u32 s82, s82, s79
    s_add_u32 s82, s82, s88
    s_lshl_b32 s79, s92, 2
    s_add_u32 s79, s79, 3
    s_mul_i32 s89, s79, 43
    s_lshr_b32 s89, s89, 7
    s_mul_i32 s83, s89, 106496
    s_lshl_b32 s79, s79, 10
    s_add_u32 s83, s83, s79
    s_add_u32 s83, s83, s88
    s_mul_i32 s79, s49, 3
    s_add_u32 s79, s79, s92
    s_cmp_ge_u32 s79, 22
    s_cbranch_scc1 Lpk_3
    s_branch Lpk_4
Lpk_2:
    s_cmp_ge_u32 s76, 107
    s_cbranch_scc1 Lpk_3
    s_sub_u32 s76, s76, 64
    s_mov_b32 s44, s14
    s_and_b32 s45, s15, 0xffff
    s_mov_b32 s46, 1409024
    s_movk_i32 s78, 1024
    s_lshl_b32 s77, s76, 15
    s_lshl_b32 s89, s49, 7
    s_add_u32 s77, s77, s89
    s_add_u32 s89, s76, 64
    s_lshl_b32 s89, s89, 10
    s_add_u32 s88, s88, s89
    s_add_u32 s80, s88, 0
    s_add_u32 s81, s88, 109568
    s_add_u32 s82, s88, 219136
    s_add_u32 s83, s88, 328704
    s_branch Lpk_4
Lpk_3:
    s_mov_b32 s44, s6
    s_and_b32 s45, s7, 0xffff
    s_mov_b32 s46, 0
    s_movk_i32 s78, 1024
    s_mov_b32 s77, 0
    s_mov_b32 s80, 0x1000000
    s_mov_b32 s81, 0x1000000
    s_mov_b32 s82, 0x1000000
    s_mov_b32 s83, 0x1000000
Lpk_4:
    v_mul_lo_u32 v160, v162, s78
    v_add_u32 v166, v160, v164
    v_xor_b32 v161, 64, v164
    v_add_u32 v167, v160, v161
    s_lshl_b32 s78, s78, 3
    s_lshl_b32 s86, s50, 12
    s_mov_b32 s84, s77
    s_mov_b32 s85, s78
    s_add_u32 m0, s99, 0x4000
    s_add_u32 s100, s100, 128
    s_and_b32 s100, s100, 0x380
    buffer_load_dwordx4 v11, s[24:27], s100 offen lds
    buffer_load_dwordx4 v12, s[24:27], s100 offen offset:1024 lds
    s_add_u32 s101, s101, 98304
    s_cmp_eq_u32 s101, 1572864
    s_cselect_b32 s101, 0, s101
    s_add_u32 m0, s93, 0x8000
    s_nop 0
    buffer_load_dwordx4 v13, s[28:31], s101 offen offset:1024 lds
    buffer_load_dwordx4 v13, s[28:31], s101 offen offset:2048 lds
    s_add_u32 s101, s101, 98304
    s_add_u32 m0, s93, 0xa000
    s_nop 0
    buffer_load_dwordx4 v13, s[28:31], s101 offen offset:1024 lds
    buffer_load_dwordx4 v13, s[28:31], s101 offen offset:2048 lds
    s_add_u32 m0, s86, 0x20000
    s_nop 0
    buffer_load_dwordx4 v166, s[44:47], s84 offen lds
    s_add_u32 m0, s86, 0x20400
    s_add_u32 s84, s84, s85
    buffer_load_dwordx4 v167, s[44:47], s84 offen lds
    s_add_u32 m0, s86, 0x20800
    s_add_u32 s84, s84, s85
    buffer_load_dwordx4 v166, s[44:47], s84 offen lds
    s_add_u32 m0, s86, 0x20c00
    s_add_u32 s84, s84, s85
    buffer_load_dwordx4 v167, s[44:47], s84 offen lds
    s_mov_b64 exec, 1
    buffer_load_dword v178, off, s[32:35], s54 sc1
    s_mov_b64 exec, -1
    s_waitcnt vmcnt(20)
    s_barrier
    ds_read_b64_tr_b16 a[0:1], v10 offset:0
    ds_read_b64_tr_b16 a[2:3], v10 offset:512
    ds_read_b64_tr_b16 a[4:5], v10 offset:1024
    ds_read_b64_tr_b16 a[6:7], v10 offset:1536
    ds_read_b128 v[108:111], v6 offset:0
    ds_read_b128 v[112:115], v6 offset:2048
    ds_read_b128 v[116:119], v6 offset:4096
    ds_read_b128 v[120:123], v6 offset:6144
    ds_read_b128 v[124:127], v8 offset:0
    s_add_u32 m0, s99, 0x6000
    s_add_u32 s100, s100, 128
    s_and_b32 s100, s100, 0x380
    buffer_load_dwordx4 v11, s[24:27], s100 offen lds
    buffer_load_dwordx4 v12, s[24:27], s100 offen offset:1024 lds
    s_add_u32 s101, s101, 98304
    s_cmp_eq_u32 s101, 1572864
    s_cselect_b32 s101, 0, s101
    s_add_u32 m0, s93, 0xc000
    s_nop 0
    buffer_load_dwordx4 v13, s[28:31], s101 offen offset:1024 lds
    buffer_load_dwordx4 v13, s[28:31], s101 offen offset:2048 lds
    s_add_u32 s101, s101, 98304
    s_add_u32 m0, s93, 0xe000
    s_nop 0
    buffer_load_dwordx4 v13, s[28:31], s101 offen offset:1024 lds
    buffer_load_dwordx4 v13, s[28:31], s101 offen offset:2048 lds
    s_waitcnt lgkmcnt(0)
    s_waitcnt vmcnt(24)
    s_barrier
    ds_read_b64_tr_b16 a[8:9], v10 offset:8192
    ds_read_b64_tr_b16 a[10:11], v10 offset:8704
    ds_read_b64_tr_b16 a[12:13], v10 offset:9216
    v_mfma_f32_16x16x32_bf16 v[60:63], v[108:111], a[0:3], 0
    ds_read_b64_tr_b16 a[14:15], v10 offset:9728
    ds_read_b128 v[128:131], v7 offset:0
    v_mfma_f32_16x16x32_bf16 v[76:79], v[108:111], a[4:7], 0
    ds_read_b128 v[132:135], v7 offset:2048
    ds_read_b128 v[136:139], v7 offset:4096
    s_add_u32 m0, s99, 0x8000
    v_mfma_f32_16x16x32_bf16 v[64:67], v[112:115], a[0:3], 0
    ds_read_b128 v[140:143], v7 offset:6144
    ds_read_b128 v[144:147], v9 offset:0
    s_add_u32 s100, s100, 128
    v_mfma_f32_16x16x32_bf16 v[80:83], v[112:115], a[4:7], 0
    s_and_b32 s100, s100, 0x380
    v_mfma_f32_16x16x32_bf16 v[68:71], v[116:119], a[0:3], 0
    buffer_load_dwordx4 v11, s[24:27], s100 offen lds
    v_mfma_f32_16x16x32_bf16 v[84:87], v[116:119], a[4:7], 0
    buffer_load_dwordx4 v12, s[24:27], s100 offen offset:1024 lds
    v_mfma_f32_16x16x32_bf16 v[72:75], v[120:123], a[0:3], 0
    s_add_u32 s101, s101, 98304
    s_cmp_eq_u32 s101, 1572864
    s_cselect_b32 s101, 0, s101
    s_add_u32 m0, s93, 0x0
    v_mfma_f32_16x16x32_bf16 v[88:91], v[120:123], a[4:7], 0
    buffer_load_dwordx4 v13, s[28:31], s101 offen offset:1024 lds
    v_mfma_f32_16x16x32_bf16 v[184:187], v[56:59], v[124:127], 0
    buffer_load_dwordx4 v13, s[28:31], s101 offen offset:2048 lds
    v_mfma_f32_16x16x32_bf16 v[188:191], v[124:127], v[124:127], 0
    v_mfma_f32_16x16x32_bf16 v[236:239], v[56:59], a[0:3], 0
    v_mfma_f32_16x16x32_bf16 v[232:235], v[56:59], a[4:7], 0
    s_waitcnt lgkmcnt(0)
    s_waitcnt vmcnt(24)
    s_waitcnt vmcnt(21)
    s_barrier
    s_cmp_lg_u32 s50, 0
    s_cbranch_scc1 Lann_5
    s_lshl_b32 s76, s48, 7
    s_add_u32 s76, s76, s3
    s_mov_b64 exec, 1
    buffer_store_dword v171, off, s[32:35], s76 sc1
    s_mov_b64 exec, -1
Lann_5:
    ds_read_b64_tr_b16 a[16:17], v10 offset:16384
    ds_read_b64_tr_b16 a[18:19], v10 offset:16896
    ds_read_b64_tr_b16 a[20:21], v10 offset:17408
    v_mfma_f32_16x16x32_bf16 v[60:63], v[128:131], a[8:11], v[60:63]
    ds_read_b64_tr_b16 a[22:23], v10 offset:17920
    ds_read_b128 v[108:111], v6 offset:8192
    v_mfma_f32_16x16x32_bf16 v[76:79], v[128:131], a[12:15], v[76:79]
    ds_read_b128 v[112:115], v6 offset:10240
    ds_read_b128 v[116:119], v6 offset:12288
    s_add_u32 s101, s101, 98304
    v_mfma_f32_16x16x32_bf16 v[64:67], v[132:135], a[8:11], v[64:67]
    ds_read_b128 v[120:123], v6 offset:14336
    ds_read_b128 v[124:127], v8 offset:8192
    s_add_u32 m0, s93, 0x2000
    v_mfma_f32_16x16x32_bf16 v[80:83], v[132:135], a[12:15], v[80:83]
    buffer_load_dwordx4 v13, s[28:31], s101 offen offset:1024 lds
    v_mfma_f32_16x16x32_bf16 v[68:71], v[136:139], a[8:11], v[68:71]
    buffer_load_dwordx4 v13, s[28:31], s101 offen offset:2048 lds
    v_mfma_f32_16x16x32_bf16 v[84:87], v[136:139], a[12:15], v[84:87]
    v_mfma_f32_16x16x32_bf16 v[72:75], v[140:143], a[8:11], v[72:75]
    v_mfma_f32_16x16x32_bf16 v[88:91], v[140:143], a[12:15], v[88:91]
    v_mfma_f32_16x16x32_bf16 v[184:187], v[56:59], v[144:147], v[184:187]
    v_mfma_f32_16x16x32_bf16 v[188:191], v[144:147], v[144:147], v[188:191]
    v_mfma_f32_16x16x32_bf16 v[236:239], v[56:59], a[8:11], v[236:239]
    v_mfma_f32_16x16x32_bf16 v[232:235], v[56:59], a[12:15], v[232:235]
    s_waitcnt lgkmcnt(0)
    s_barrier
    ds_read_b64_tr_b16 a[24:25], v10 offset:24576
    ds_read_b64_tr_b16 a[26:27], v10 offset:25088
    ds_read_b64_tr_b16 a[28:29], v10 offset:25600
    v_mfma_f32_16x16x32_bf16 v[60:63], v[108:111], a[16:19], v[60:63]
    ds_read_b64_tr_b16 a[30:31], v10 offset:26112
    ds_read_b128 v[128:131], v7 offset:8192
    v_mfma_f32_16x16x32_bf16 v[76:79], v[108:111], a[20:23], v[76:79]
    ds_read_b128 v[132:135], v7 offset:10240
    ds_read_b128 v[136:139], v7 offset:12288
    s_add_u32 m0, s99, 0xa000
    v_mfma_f32_16x16x32_bf16 v[64:67], v[112:115], a[16:19], v[64:67]
    ds_read_b128 v[140:143], v7 offset:14336
    ds_read_b128 v[144:147], v9 offset:8192
    s_add_u32 s100, s100, 128
    v_mfma_f32_16x16x32_bf16 v[80:83], v[112:115], a[20:23], v[80:83]
    s_and_b32 s100, s100, 0x380
    v_mfma_f32_16x16x32_bf16 v[68:71], v[116:119], a[16:19], v[68:71]
    buffer_load_dwordx4 v11, s[24:27], s100 offen lds
    v_mfma_f32_16x16x32_bf16 v[84:87], v[116:119], a[20:23], v[84:87]
    buffer_load_dwordx4 v12, s[24:27], s100 offen offset:1024 lds
    v_mfma_f32_16x16x32_bf16 v[72:75], v[120:123], a[16:19], v[72:75]
    s_add_u32 s101, s101, 98304
    s_cmp_eq_u32 s101, 1572864
    s_cselect_b32 s101, 0, s101
    s_add_u32 m0, s93, 0x4000
    v_mfma_f32_16x16x32_bf16 v[88:91], v[120:123], a[20:23], v[88:91]
    buffer_load_dwordx4 v13, s[28:31], s101 offen offset:1024 lds
    v_mfma_f32_16x16x32_bf16 v[184:187], v[56:59], v[124:127], v[184:187]
    buffer_load_dwordx4 v13, s[28:31], s101 offen offset:2048 lds
    v_mfma_f32_16x16x32_bf16 v[188:191], v[124:127], v[124:127], v[188:191]
    v_mfma_f32_16x16x32_bf16 v[236:239], v[56:59], a[16:19], v[236:239]
    v_mfma_f32_16x16x32_bf16 v[232:235], v[56:59], a[20:23], v[232:235]
    s_waitcnt lgkmcnt(0)
    s_waitcnt vmcnt(23)
    s_barrier
    ds_read_b64_tr_b16 a[32:33], v10 offset:32768
    ds_read_b64_tr_b16 a[34:35], v10 offset:33280
    ds_read_b64_tr_b16 a[36:37], v10 offset:33792
    v_mfma_f32_16x16x32_bf16 v[60:63], v[128:131], a[24:27], v[60:63]
    ds_read_b64_tr_b16 a[38:39], v10 offset:34304
    ds_read_b128 v[108:111], v6 offset:16384
    v_mfma_f32_16x16x32_bf16 v[76:79], v[128:131], a[28:31], v[76:79]
    ds_read_b128 v[112:115], v6 offset:18432
    ds_read_b128 v[116:119], v6 offset:20480
    s_add_u32 s101, s101, 98304
    v_mfma_f32_16x16x32_bf16 v[64:67], v[132:135], a[24:27], v[64:67]
    ds_read_b128 v[120:123], v6 offset:22528
    ds_read_b128 v[124:127], v8 offset:16384
    s_add_u32 m0, s93, 0x6000
    v_mfma_f32_16x16x32_bf16 v[80:83], v[132:135], a[28:31], v[80:83]
    buffer_load_dwordx4 v13, s[28:31], s101 offen offset:1024 lds
    v_mfma_f32_16x16x32_bf16 v[68:71], v[136:139], a[24:27], v[68:71]
    buffer_load_dwordx4 v13, s[28:31], s101 offen offset:2048 lds
    v_mfma_f32_16x16x32_bf16 v[84:87], v[136:139], a[28:31], v[84:87]
    s_waitcnt vmcnt(19)
    ds_read_b64_tr_b16 v[252:253], v48 offset:0
    ds_read_b64_tr_b16 v[254:255], v48 offset:512
    ds_read_b64_tr_b16 v[248:249], v49 offset:0
    ds_read_b64_tr_b16 v[250:251], v49 offset:512
    ds_read_b64_tr_b16 v[244:245], v50 offset:0
    ds_read_b64_tr_b16 v[246:247], v50 offset:512
    ds_read_b64_tr_b16 v[240:241], v51 offset:0
    ds_read_b64_tr_b16 v[242:243], v51 offset:512
    v_mfma_f32_16x16x32_bf16 v[72:75], v[140:143], a[24:27], v[72:75]
    v_mfma_f32_16x16x32_bf16 v[88:91], v[140:143], a[28:31], v[88:91]
    v_mfma_f32_16x16x32_bf16 v[184:187], v[56:59], v[144:147], v[184:187]
    v_mfma_f32_16x16x32_bf16 v[188:191], v[144:147], v[144:147], v[188:191]
    v_mfma_f32_16x16x32_bf16 v[236:239], v[56:59], a[24:27], v[236:239]
    v_mfma_f32_16x16x32_bf16 v[232:235], v[56:59], a[28:31], v[232:235]
    s_waitcnt lgkmcnt(0)
    buffer_store_dwordx4 v[252:255], v1, s[32:35], s80 offen sc1
    buffer_store_dwordx4 v[248:251], v1, s[32:35], s81 offen sc1
    buffer_store_dwordx4 v[244:247], v1, s[32:35], s82 offen sc1
    buffer_store_dwordx4 v[240:243], v1, s[32:35], s83 offen sc1
    s_barrier
    ds_read_b64_tr_b16 a[40:41], v10 offset:40960
    ds_read_b64_tr_b16 a[42:43], v10 offset:41472
    ds_read_b64_tr_b16 a[44:45], v10 offset:41984
    v_mfma_f32_16x16x32_bf16 v[60:63], v[108:111], a[32:35], v[60:63]
    ds_read_b64_tr_b16 a[46:47], v10 offset:42496
    ds_read_b128 v[128:131], v7 offset:16384
    v_mfma_f32_16x16x32_bf16 v[76:79], v[108:111], a[36:39], v[76:79]
    ds_read_b128 v[132:135], v7 offset:18432
    ds_read_b128 v[136:139], v7 offset:20480
    s_add_u32 m0, s99, 0xc000
    v_mfma_f32_16x16x32_bf16 v[64:67], v[112:115], a[32:35], v[64:67]
    ds_read_b128 v[140:143], v7 offset:22528
    ds_read_b128 v[144:147], v9 offset:16384
    s_add_u32 s100, s100, 128
    v_mfma_f32_16x16x32_bf16 v[80:83], v[112:115], a[36:39], v[80:83]
    s_and_b32 s100, s100, 0x380
    v_mfma_f32_16x16x32_bf16 v[68:71], v[116:119], a[32:35], v[68:71]
    buffer_load_dwordx4 v11, s[24:27], s100 offen lds
    v_mfma_f32_16x16x32_bf16 v[84:87], v[116:119], a[36:39], v[84:87]
    buffer_load_dwordx4 v12, s[24:27], s100 offen offset:1024 lds
    v_mfma_f32_16x16x32_bf16 v[72:75], v[120:123], a[32:35], v[72:75]
    s_add_u32 s101, s101, 98304
    s_cmp_eq_u32 s101, 1572864
    s_cselect_b32 s101, 0, s101
    s_add_u32 m0, s93, 0x8000
    v_mfma_f32_16x16x32_bf16 v[88:91], v[120:123], a[36:39], v[88:91]
    buffer_load_dwordx4 v13, s[28:31], s101 offen offset:1024 lds
    v_mfma_f32_16x16x32_bf16 v[184:187], v[56:59], v[124:127], v[184:187]
    buffer_load_dwordx4 v13, s[28:31], s101 offen offset:2048 lds
    v_mfma_f32_16x16x32_bf16 v[188:191], v[124:127], v[124:127], v[188:191]
    v_mfma_f32_16x16x32_bf16 v[236:239], v[56:59], a[32:35], v[236:239]
    v_mfma_f32_16x16x32_bf16 v[232:235], v[56:59], a[36:39], v[232:235]
    s_waitcnt lgkmcnt(0)
    s_waitcnt vmcnt(22)
    s_barrier
    ds_read_b64_tr_b16 a[48:49], v10 offset:49152
    ds_read_b64_tr_b16 a[50:51], v10 offset:49664
    ds_read_b64_tr_b16 a[52:53], v10 offset:50176
    v_mfma_f32_16x16x32_bf16 v[60:63], v[128:131], a[40:43], v[60:63]
    ds_read_b64_tr_b16 a[54:55], v10 offset:50688
    ds_read_b128 v[108:111], v6 offset:24576
    v_mfma_f32_16x16x32_bf16 v[76:79], v[128:131], a[44:47], v[76:79]
    ds_read_b128 v[112:115], v6 offset:26624
    ds_read_b128 v[116:119], v6 offset:28672
    s_add_u32 s101, s101, 98304
    v_mfma_f32_16x16x32_bf16 v[64:67], v[132:135], a[40:43], v[64:67]
    ds_read_b128 v[120:123], v6 offset:30720
    ds_read_b128 v[124:127], v8 offset:24576
    s_add_u32 m0, s93, 0xa000
    v_mfma_f32_16x16x32_bf16 v[80:83], v[132:135], a[44:47], v[80:83]
    buffer_load_dwordx4 v13, s[28:31], s101 offen offset:1024 lds
    v_mfma_f32_16x16x32_bf16 v[68:71], v[136:139], a[40:43], v[68:71]
    buffer_load_dwordx4 v13, s[28:31], s101 offen offset:2048 lds
    v_mfma_f32_16x16x32_bf16 v[84:87], v[136:139], a[44:47], v[84:87]
    v_mfma_f32_16x16x32_bf16 v[72:75], v[140:143], a[40:43], v[72:75]
    v_mfma_f32_16x16x32_bf16 v[88:91], v[140:143], a[44:47], v[88:91]
    v_mfma_f32_16x16x32_bf16 v[184:187], v[56:59], v[144:147], v[184:187]
    v_mfma_f32_16x16x32_bf16 v[188:191], v[144:147], v[144:147], v[188:191]
    v_mfma_f32_16x16x32_bf16 v[236:239], v[56:59], a[40:43], v[236:239]
    v_mfma_f32_16x16x32_bf16 v[232:235], v[56:59], a[44:47], v[232:235]
    s_waitcnt lgkmcnt(0)
    s_waitcnt vmcnt(22)
    s_barrier
    ds_read_b64_tr_b16 a[56:57], v10 offset:57344
    ds_read_b64_tr_b16 a[58:59], v10 offset:57856
    ds_read_b64_tr_b16 a[60:61], v10 offset:58368
    v_mfma_f32_16x16x32_bf16 v[60:63], v[108:111], a[48:51], v[60:63]
    ds_read_b64_tr_b16 a[62:63], v10 offset:58880
    ds_read_b128 v[128:131], v7 offset:24576
    v_mfma_f32_16x16x32_bf16 v[76:79], v[108:111], a[52:55], v[76:79]
    ds_read_b128 v[132:135], v7 offset:26624
    ds_read_b128 v[136:139], v7 offset:28672
    s_add_u32 m0, s99, 0xe000
    v_mfma_f32_16x16x32_bf16 v[64:67], v[112:115], a[48:51], v[64:67]
    ds_read_b128 v[140:143], v7 offset:30720
    ds_read_b128 v[144:147], v9 offset:24576
    s_add_u32 s100, s100, 128
    v_mfma_f32_16x16x32_bf16 v[80:83], v[112:115], a[52:55], v[80:83]
    s_and_b32 s100, s100, 0x380
    v_mfma_f32_16x16x32_bf16 v[68:71], v[116:119], a[48:51], v[68:71]
    buffer_load_dwordx4 v11, s[24:27], s100 offen lds
    v_mfma_f32_16x16x32_bf16 v[84:87], v[116:119], a[52:55], v[84:87]
    buffer_load_dwordx4 v12, s[24:27], s100 offen offset:1024 lds
    v_mfma_f32_16x16x32_bf16 v[72:75], v[120:123], a[48:51], v[72:75]
    s_add_u32 s101, s101, 98304
    s_cmp_eq_u32 s101, 1572864
    s_cselect_b32 s101, 0, s101
    s_add_u32 m0, s93, 0xc000
    v_mfma_f32_16x16x32_bf16 v[88:91], v[120:123], a[52:55], v[88:91]
    buffer_load_dwordx4 v13, s[28:31], s101 offen offset:1024 lds
    v_mfma_f32_16x16x32_bf16 v[184:187], v[56:59], v[124:127], v[184:187]
    buffer_load_dwordx4 v13, s[28:31], s101 offen offset:2048 lds
    v_mfma_f32_16x16x32_bf16 v[188:191], v[124:127], v[124:127], v[188:191]
    v_mfma_f32_16x16x32_bf16 v[236:239], v[56:59], a[48:51], v[236:239]
    v_mfma_f32_16x16x32_bf16 v[232:235], v[56:59], a[52:55], v[232:235]
    s_waitcnt lgkmcnt(0)
    s_waitcnt vmcnt(22)
    s_barrier
    ds_read_b64_tr_b16 a[64:65], v10 offset:0
    ds_read_b64_tr_b16 a[66:67], v10 offset:512
    ds_read_b64_tr_b16 a[68:69], v10 offset:1024
    v_mfma_f32_16x16x32_bf16 v[60:63], v[128:131], a[56:59], v[60:63]
    ds_read_b64_tr_b16 a[70:71], v10 offset:1536
    ds_read_b128 v[108:111], v6 offset:32768
    v_mfma_f32_16x16x32_bf16 v[76:79], v[128:131], a[60:63], v[76:79]
    ds_read_b128 v[112:115], v6 offset:34816
    ds_read_b128 v[116:119], v6 offset:36864
    s_add_u32 s101, s101, 98304
    v_mfma_f32_16x16x32_bf16 v[64:67], v[132:135], a[56:59], v[64:67]
    ds_read_b128 v[120:123], v6 offset:38912
    ds_read_b128 v[124:127], v8 offset:32768
    s_add_u32 m0, s93, 0xe000
    v_mfma_f32_16x16x32_bf16 v[80:83], v[132:135], a[60:63], v[80:83]
    buffer_load_dwordx4 v13, s[28:31], s101 offen offset:1024 lds
    v_mfma_f32_16x16x32_bf16 v[68:71], v[136:139], a[56:59], v[68:71]
    buffer_load_dwordx4 v13, s[28:31], s101 offen offset:2048 lds
    v_mfma_f32_16x16x32_bf16 v[84:87], v[136:139], a[60:63], v[84:87]
    v_mfma_f32_16x16x32_bf16 v[72:75], v[140:143], a[56:59], v[72:75]
    v_mfma_f32_16x16x32_bf16 v[88:91], v[140:143], a[60:63], v[88:91]
    v_mfma_f32_16x16x32_bf16 v[184:187], v[56:59], v[144:147], v[184:187]
    v_mfma_f32_16x16x32_bf16 v[188:191], v[144:147], v[144:147], v[188:191]
    v_mfma_f32_16x16x32_bf16 v[236:239], v[56:59], a[56:59], v[236:239]
    v_mfma_f32_16x16x32_bf16 v[232:235], v[56:59], a[60:63], v[232:235]
    s_waitcnt lgkmcnt(0)
    s_waitcnt vmcnt(22)
    s_waitcnt vmcnt(12)
    s_barrier
    s_cmp_lg_u32 s50, 0
    s_cbranch_scc1 Lann_6
    s_lshl_b32 s76, s48, 7
    s_add_u32 s76, s76, s3
    s_add_u32 s76, s76, 0x38000
    s_mov_b64 exec, 1
    buffer_store_dword v171, off, s[32:35], s76 sc1
    s_mov_b64 exec, -1
Lann_6:
    ds_read_b64_tr_b16 a[72:73], v10 offset:8192
    ds_read_b64_tr_b16 a[74:75], v10 offset:8704
    ds_read_b64_tr_b16 a[76:77], v10 offset:9216
    v_mfma_f32_16x16x32_bf16 v[60:63], v[108:111], a[64:67], v[60:63]
    ds_read_b64_tr_b16 a[78:79], v10 offset:9728
    ds_read_b128 v[128:131], v7 offset:32768
    v_mfma_f32_16x16x32_bf16 v[76:79], v[108:111], a[68:71], v[76:79]
    ds_read_b128 v[132:135], v7 offset:34816
    ds_read_b128 v[136:139], v7 offset:36864
    s_add_u32 s101, s101, 98304
    v_mfma_f32_16x16x32_bf16 v[64:67], v[112:115], a[64:67], v[64:67]
    ds_read_b128 v[140:143], v7 offset:38912
    ds_read_b128 v[144:147], v9 offset:32768
    s_cmp_eq_u32 s101, 1572864
    v_mfma_f32_16x16x32_bf16 v[80:83], v[112:115], a[68:71], v[80:83]
    s_cselect_b32 s101, 0, s101
    s_add_u32 m0, s43, 0x20000
    v_mfma_f32_16x16x32_bf16 v[68:71], v[116:119], a[64:67], v[68:71]
    buffer_load_dwordx4 v13, s[28:31], s101 offen lds
    v_mfma_f32_16x16x32_bf16 v[84:87], v[116:119], a[68:71], v[84:87]
    s_add_u32 s101, s101, 98304
    s_add_u32 m0, s43, 0x21000
    v_mfma_f32_16x16x32_bf16 v[72:75], v[120:123], a[64:67], v[72:75]
    buffer_load_dwordx4 v13, s[28:31], s101 offen lds
    v_mfma_f32_16x16x32_bf16 v[88:91], v[120:123], a[68:71], v[88:91]
    s_add_u32 s101, s101, 98304
    s_cmp_eq_u32 s101, 1572864
    s_cselect_b32 s101, 0, s101
    s_add_u32 m0, s43, 0x22000
    v_mfma_f32_16x16x32_bf16 v[184:187], v[56:59], v[124:127], v[184:187]
    buffer_load_dwordx4 v13, s[28:31], s101 offen lds
    v_mfma_f32_16x16x32_bf16 v[188:191], v[124:127], v[124:127], v[188:191]
    v_mfma_f32_16x16x32_bf16 v[236:239], v[56:59], a[64:67], v[236:239]
    v_mfma_f32_16x16x32_bf16 v[232:235], v[56:59], a[68:71], v[232:235]
    s_waitcnt lgkmcnt(0)
    s_barrier
    ds_read_b64_tr_b16 a[80:81], v10 offset:16384
    ds_read_b64_tr_b16 a[82:83], v10 offset:16896
    ds_read_b64_tr_b16 a[84:85], v10 offset:17408
    v_mfma_f32_16x16x32_bf16 v[60:63], v[128:131], a[72:75], v[60:63]
    ds_read_b64_tr_b16 a[86:87], v10 offset:17920
    ds_read_b128 v[108:111], v6 offset:40960
    v_mfma_f32_16x16x32_bf16 v[76:79], v[128:131], a[76:79], v[76:79]
    ds_read_b128 v[112:115], v6 offset:43008
    ds_read_b128 v[116:119], v6 offset:45056
    s_add_u32 s101, s101, 98304
    v_mfma_f32_16x16x32_bf16 v[64:67], v[132:135], a[72:75], v[64:67]
    ds_read_b128 v[120:123], v6 offset:47104
    ds_read_b128 v[124:127], v8 offset:40960
    s_add_u32 m0, s43, 0x23000
    v_mfma_f32_16x16x32_bf16 v[80:83], v[132:135], a[76:79], v[80:83]
    buffer_load_dwordx4 v13, s[28:31], s101 offen lds
    v_mfma_f32_16x16x32_bf16 v[68:71], v[136:139], a[72:75], v[68:71]
    v_mfma_f32_16x16x32_bf16 v[84:87], v[136:139], a[76:79], v[84:87]
    v_mfma_f32_16x16x32_bf16 v[72:75], v[140:143], a[72:75], v[72:75]
    v_mfma_f32_16x16x32_bf16 v[88:91], v[140:143], a[76:79], v[88:91]
    v_mfma_f32_16x16x32_bf16 v[184:187], v[56:59], v[144:147], v[184:187]
    v_mfma_f32_16x16x32_bf16 v[188:191], v[144:147], v[144:147], v[188:191]
    v_mfma_f32_16x16x32_bf16 v[236:239], v[56:59], a[72:75], v[236:239]
    v_mfma_f32_16x16x32_bf16 v[232:235], v[56:59], a[76:79], v[232:235]
    s_waitcnt lgkmcnt(0)
    s_barrier
    ds_read_b64_tr_b16 a[88:89], v10 offset:24576
    ds_read_b64_tr_b16 a[90:91], v10 offset:25088
    ds_read_b64_tr_b16 a[92:93], v10 offset:25600
    v_mfma_f32_16x16x32_bf16 v[60:63], v[108:111], a[80:83], v[60:63]
    ds_read_b64_tr_b16 a[94:95], v10 offset:26112
    ds_read_b128 v[128:131], v7 offset:40960
    v_mfma_f32_16x16x32_bf16 v[76:79], v[108:111], a[84:87], v[76:79]
    ds_read_b128 v[132:135], v7 offset:43008
    ds_read_b128 v[136:139], v7 offset:45056
    s_add_u32 s101, s101, 98304
    v_mfma_f32_16x16x32_bf16 v[64:67], v[112:115], a[80:83], v[64:67]
    ds_read_b128 v[140:143], v7 offset:47104
    ds_read_b128 v[144:147], v9 offset:40960
    s_cmp_eq_u32 s101, 1572864
    v_mfma_f32_16x16x32_bf16 v[80:83], v[112:115], a[84:87], v[80:83]
    s_cselect_b32 s101, 0, s101
    s_add_u32 m0, s43, 0x14000
    v_mfma_f32_16x16x32_bf16 v[68:71], v[116:119], a[80:83], v[68:71]
    buffer_load_dwordx4 v13, s[28:31], s101 offen lds
    v_mfma_f32_16x16x32_bf16 v[84:87], v[116:119], a[84:87], v[84:87]
    s_add_u32 s101, s101, 98304
    s_add_u32 m0, s43, 0x15000
    v_mfma_f32_16x16x32_bf16 v[72:75], v[120:123], a[80:83], v[72:75]
    buffer_load_dwordx4 v13, s[28:31], s101 offen lds
    v_mfma_f32_16x16x32_bf16 v[88:91], v[120:123], a[84:87], v[88:91]
    v_mfma_f32_16x16x32_bf16 v[184:187], v[56:59], v[124:127], v[184:187]
    v_mfma_f32_16x16x32_bf16 v[188:191], v[124:127], v[124:127], v[188:191]
    v_mfma_f32_16x16x32_bf16 v[236:239], v[56:59], a[80:83], v[236:239]
    v_mfma_f32_16x16x32_bf16 v[232:235], v[56:59], a[84:87], v[232:235]
    s_waitcnt lgkmcnt(0)
    s_waitcnt vmcnt(14)
    s_barrier
    ds_read_b64_tr_b16 a[96:97], v10 offset:32768
    ds_read_b64_tr_b16 a[98:99], v10 offset:33280
    ds_read_b64_tr_b16 a[100:101], v10 offset:33792
    v_mfma_f32_16x16x32_bf16 v[60:63], v[128:131], a[88:91], v[60:63]
    ds_read_b64_tr_b16 a[102:103], v10 offset:34304
    ds_read_b128 v[108:111], v6 offset:49152
    v_mfma_f32_16x16x32_bf16 v[76:79], v[128:131], a[92:95], v[76:79]
    ds_read_b128 v[112:115], v6 offset:51200
    ds_read_b128 v[116:119], v6 offset:53248
    s_add_u32 s101, s101, 98304
    v_mfma_f32_16x16x32_bf16 v[64:67], v[132:135], a[88:91], v[64:67]
    ds_read_b128 v[120:123], v6 offset:55296
    ds_read_b128 v[124:127], v8 offset:49152
    s_cmp_eq_u32 s101, 1572864
    v_mfma_f32_16x16x32_bf16 v[80:83], v[132:135], a[92:95], v[80:83]
    s_cselect_b32 s101, 0, s101
    s_add_u32 m0, s43, 0x16000
    v_mfma_f32_16x16x32_bf16 v[68:71], v[136:139], a[88:91], v[68:71]
    buffer_load_dwordx4 v13, s[28:31], s101 offen lds
    v_mfma_f32_16x16x32_bf16 v[84:87], v[136:139], a[92:95], v[84:87]
    s_add_u32 s101, s101, 98304
    s_add_u32 m0, s43, 0x17000
    v_mfma_f32_16x16x32_bf16 v[72:75], v[140:143], a[88:91], v[72:75]
    buffer_load_dwordx4 v13, s[28:31], s101 offen lds
    v_mfma_f32_16x16x32_bf16 v[88:91], v[140:143], a[92:95], v[88:91]
    v_and_b32 v46, 7, v0
    v_subrev_u32 v46, s49, v46
    v_lshlrev_b32 v46, 12, v46
    s_lshl_b32 s76, s48, 7
    s_add_u32 s76, s76, s3
    v_add_u32 v46, s76, v46
    v_add_u32 v161, s3, v179
    v_cmp_gt_u32 vcc, 32, v0
    s_nop 1
    v_cndmask_b32 v46, v46, v161, vcc
    buffer_load_dword v180, v46, s[32:35], 0 offen sc1
    v_mfma_f32_16x16x32_bf16 v[184:187], v[56:59], v[144:147], v[184:187]
    v_mfma_f32_16x16x32_bf16 v[188:191], v[144:147], v[144:147], v[188:191]
    v_mfma_f32_16x16x32_bf16 v[236:239], v[56:59], a[88:91], v[236:239]
    v_mfma_f32_16x16x32_bf16 v[232:235], v[56:59], a[92:95], v[232:235]
    s_waitcnt lgkmcnt(0)
    s_waitcnt vmcnt(15)
    s_barrier
    ds_read_b64_tr_b16 a[104:105], v10 offset:40960
    ds_read_b64_tr_b16 a[106:107], v10 offset:41472
    ds_read_b64_tr_b16 a[108:109], v10 offset:41984
    v_mfma_f32_16x16x32_bf16 v[60:63], v[108:111], a[96:99], v[60:63]
    ds_read_b64_tr_b16 a[110:111], v10 offset:42496
    ds_read_b128 v[128:131], v7 offset:49152
    v_mfma_f32_16x16x32_bf16 v[76:79], v[108:111], a[100:103], v[76:79]
    ds_read_b128 v[132:135], v7 offset:51200
    ds_read_b128 v[136:139], v7 offset:53248
    s_add_u32 s101, s101, 98304
    v_mfma_f32_16x16x32_bf16 v[64:67], v[112:115], a[96:99], v[64:67]
    ds_read_b128 v[140:143], v7 offset:55296
    ds_read_b128 v[144:147], v9 offset:49152
    s_cmp_eq_u32 s101, 1572864
    v_mfma_f32_16x16x32_bf16 v[80:83], v[112:115], a[100:103], v[80:83]
    s_cselect_b32 s101, 0, s101
    s_add_u32 m0, s43, 0x18000
    v_mfma_f32_16x16x32_bf16 v[68:71], v[116:119], a[96:99], v[68:71]
    buffer_load_dwordx4 v13, s[28:31], s101 offen lds
    v_mfma_f32_16x16x32_bf16 v[84:87], v[116:119], a[100:103], v[84:87]
    s_add_u32 s101, s101, 98304
    s_add_u32 m0, s43, 0x19000
    v_mfma_f32_16x16x32_bf16 v[72:75], v[120:123], a[96:99], v[72:75]
    buffer_load_dwordx4 v13, s[28:31], s101 offen lds
    v_mfma_f32_16x16x32_bf16 v[88:91], v[120:123], a[100:103], v[88:91]
    v_mfma_f32_16x16x32_bf16 v[184:187], v[56:59], v[124:127], v[184:187]
    v_mfma_f32_16x16x32_bf16 v[188:191], v[124:127], v[124:127], v[188:191]
    v_mfma_f32_16x16x32_bf16 v[236:239], v[56:59], a[96:99], v[236:239]
    v_mfma_f32_16x16x32_bf16 v[232:235], v[56:59], a[100:103], v[232:235]
    s_waitcnt lgkmcnt(0)
    s_waitcnt vmcnt(13)
    s_barrier
    ds_read_b64_tr_b16 a[112:113], v10 offset:49152
    ds_read_b64_tr_b16 a[114:115], v10 offset:49664
    ds_read_b64_tr_b16 a[116:117], v10 offset:50176
    v_mfma_f32_16x16x32_bf16 v[60:63], v[128:131], a[104:107], v[60:63]
    ds_read_b64_tr_b16 a[118:119], v10 offset:50688
    ds_read_b128 v[108:111], v6 offset:57344
    v_mfma_f32_16x16x32_bf16 v[76:79], v[128:131], a[108:111], v[76:79]
    ds_read_b128 v[112:115], v6 offset:59392
    ds_read_b128 v[116:119], v6 offset:61440
    s_add_u32 s101, s101, 98304
    v_mfma_f32_16x16x32_bf16 v[64:67], v[132:135], a[104:107], v[64:67]
    ds_read_b128 v[120:123], v6 offset:63488
    ds_read_b128 v[124:127], v8 offset:57344
    s_cmp_eq_u32 s101, 1572864
    v_mfma_f32_16x16x32_bf16 v[80:83], v[132:135], a[108:111], v[80:83]
    s_cselect_b32 s101, 0, s101
    s_add_u32 m0, s43, 0x1a000
    v_mfma_f32_16x16x32_bf16 v[68:71], v[136:139], a[104:107], v[68:71]
    buffer_load_dwordx4 v13, s[28:31], s101 offen lds
    v_mfma_f32_16x16x32_bf16 v[84:87], v[136:139], a[108:111], v[84:87]
    s_add_u32 s101, s101, 98304
    s_add_u32 m0, s43, 0x1b000
    v_mfma_f32_16x16x32_bf16 v[72:75], v[140:143], a[104:107], v[72:75]
    buffer_load_dwordx4 v13, s[28:31], s101 offen lds
    v_mfma_f32_16x16x32_bf16 v[88:91], v[140:143], a[108:111], v[88:91]
    v_mfma_f32_16x16x32_bf16 v[184:187], v[56:59], v[144:147], v[184:187]
    v_mfma_f32_16x16x32_bf16 v[188:191], v[144:147], v[144:147], v[188:191]
    v_mfma_f32_16x16x32_bf16 v[236:239], v[56:59], a[104:107], v[236:239]
    v_mfma_f32_16x16x32_bf16 v[232:235], v[56:59], a[108:111], v[232:235]
    s_waitcnt lgkmcnt(0)
    s_waitcnt vmcnt(13)
    s_barrier
    ds_read_b64_tr_b16 a[120:121], v10 offset:57344
    ds_read_b64_tr_b16 a[122:123], v10 offset:57856
    ds_read_b64_tr_b16 a[124:125], v10 offset:58368
    v_mfma_f32_16x16x32_bf16 v[60:63], v[108:111], a[112:115], v[60:63]
    ds_read_b64_tr_b16 a[126:127], v10 offset:58880
    ds_read_b128 v[128:131], v7 offset:57344
    v_mfma_f32_16x16x32_bf16 v[76:79], v[108:111], a[116:119], v[76:79]
    ds_read_b128 v[132:135], v7 offset:59392
    ds_read_b128 v[136:139], v7 offset:61440
    s_add_u32 s101, s101, 98304
    v_mfma_f32_16x16x32_bf16 v[64:67], v[112:115], a[112:115], v[64:67]
    ds_read_b128 v[140:143], v7 offset:63488
    ds_read_b128 v[144:147], v9 offset:57344
    s_cmp_eq_u32 s101, 1572864
    v_mfma_f32_16x16x32_bf16 v[80:83], v[112:115], a[116:119], v[80:83]
    s_cselect_b32 s101, 0, s101
    s_add_u32 m0, s43, 0x1c000
    v_mfma_f32_16x16x32_bf16 v[68:71], v[116:119], a[112:115], v[68:71]
    buffer_load_dwordx4 v13, s[28:31], s101 offen lds
    v_mfma_f32_16x16x32_bf16 v[84:87], v[116:119], a[116:119], v[84:87]
    s_add_u32 s101, s101, 98304
    s_add_u32 m0, s43, 0x1d000
    v_mfma_f32_16x16x32_bf16 v[72:75], v[120:123], a[112:115], v[72:75]
    buffer_load_dwordx4 v13, s[28:31], s101 offen lds
    v_mfma_f32_16x16x32_bf16 v[88:91], v[120:123], a[116:119], v[88:91]
    s_and_b32 s78, s50, 1
    s_lshl_b32 s76, s78, 15
    s_add_u32 s76, s76, s55
    s_add_u32 s76, s76, 0x800000
    s_mul_i32 s77, s78, 90112
    s_add_u32 s77, s77, s56
    s_add_u32 s77, s77, 0xa00000
    s_bitcmp1_b32 s50, 1
    s_cselect_b32 s76, s76, s77
    s_lshl_b32 s77, s49, 12
    s_add_u32 s76, s76, s77
    s_mov_b32 exec_hi, 0
    buffer_load_dword v178, v179, s[32:35], s76 offen sc1
    s_mov_b32 exec_hi, -1
    v_and_b32 v156, 1, v0
    v_lshrrev_b32 v157, 1, v0
    v_lshlrev_b32 v157, 13, v157
    v_lshl_add_u32 v161, v156, 7, v157
    s_mov_b64 exec, 15
    buffer_load_dword v178, v161, s[32:35], s41 offen sc1
    s_mov_b64 exec, -1
    v_mfma_f32_16x16x32_bf16 v[184:187], v[56:59], v[124:127], v[184:187]
    v_mfma_f32_16x16x32_bf16 v[188:191], v[124:127], v[124:127], v[188:191]
    v_mfma_f32_16x16x32_bf16 v[236:239], v[56:59], a[112:115], v[236:239]
    v_mfma_f32_16x16x32_bf16 v[232:235], v[56:59], a[116:119], v[232:235]
    s_waitcnt lgkmcnt(0)
    v_mfma_f32_16x16x32_bf16 v[60:63], v[128:131], a[120:123], v[60:63]
    v_mfma_f32_16x16x32_bf16 v[76:79], v[128:131], a[124:127], v[76:79]
    v_mfma_f32_16x16x32_bf16 v[64:67], v[132:135], a[120:123], v[64:67]
    v_mfma_f32_16x16x32_bf16 v[80:83], v[132:135], a[124:127], v[80:83]
    v_mfma_f32_16x16x32_bf16 v[68:71], v[136:139], a[120:123], v[68:71]
    v_mfma_f32_16x16x32_bf16 v[84:87], v[136:139], a[124:127], v[84:87]
    v_mfma_f32_16x16x32_bf16 v[72:75], v[140:143], a[120:123], v[72:75]
    v_mfma_f32_16x16x32_bf16 v[88:91], v[140:143], a[124:127], v[88:91]
    v_mfma_f32_16x16x32_bf16 v[184:187], v[56:59], v[144:147], v[184:187]
    v_mfma_f32_16x16x32_bf16 v[188:191], v[144:147], v[144:147], v[188:191]
    v_mfma_f32_16x16x32_bf16 v[236:239], v[56:59], a[120:123], v[236:239]
    v_mfma_f32_16x16x32_bf16 v[232:235], v[56:59], a[124:127], v[232:235]
    s_waitcnt lgkmcnt(0)
    s_sub_u32 s76, s49, s40
    s_and_b32 s76, s76, 7
    s_lshl_b32 s76, s76, 13
    v_lshrrev_b32 v156, 4, v0
    v_lshrrev_b32 v157, 5, v0
    v_xor_b32 v157, v157, v156
    s_lshl_b32 s77, s50, 1
    v_xor_b32 v157, s77, v157
    v_lshlrev_b32 v157, 4, v157
    v_xor_b32 v157, v157, v6
    v_and_b32 v156, 1, v156
    v_lshl_add_u32 v157, v156, 3, v157
    v_add_u32 v157, s76, v157
    ds_read_b64 v[92:93], v157 offset:0
    ds_read_b64 v[94:95], v157 offset:2048
    ds_read_b64 v[96:97], v157 offset:4096
    ds_read_b64 v[98:99], v157 offset:6144
    v_mov_b32 v11, v170
    s_waitcnt vmcnt(8)
    s_branch Ltagc_9
Ltag_7:
    buffer_load_dword v180, v46, s[32:35], 0 offen sc1
    s_waitcnt vmcnt(0)
Ltagc_9:
    v_subrev_u32 v180, s22, v180
    v_cmp_gt_u32 vcc, 16, v180
    s_nop 1
    s_cmp_eq_u64 vcc, exec
    s_cbranch_scc1 Ltagd_8
    s_sub_u32 s61, s61, 1
    s_cmp_lg_u32 s61, 0
    s_cbranch_scc1 Ltag_7
    s_branch L_end
Ltagd_8:
    v_cmp_eq_u32 vcc, s97, v180
    s_nop 1
    s_cmp_eq_u32 vcc_hi, -1
    s_cselect_b32 s51, 1, 0
    v_mul_f32 v157, 0x3b000000, v184
    v_cndmask_b32 v156, v188, v189, s[68:69]
    v_cndmask_b32 v156, v156, v190, s[70:71]
    v_cndmask_b32 v156, v156, v191, s[72:73]
    v_mul_f32 v156, 0x3b000000, v156
    v_fma_f32 v156, -v157, v157, v156
    v_max_f32 v156, 0, v156
    v_add_f32 v156, 0x3727c5ac, v156
    v_rsq_f32 v158, v156
    v_lshlrev_b32 v160, 1, v177
    v_mul_f32_e64 v159, -v157, v158
    v_subrev_u32 v160, 0x26600, v160
    s_mov_b64 exec, s[74:75]
    ds_write_b32 v177, v158
    ds_write_b32 v177, v159 offset:256
    ds_write_b64 v160, v[158:159]
    s_mov_b64 exec, -1
    s_waitcnt lgkmcnt(0)
    s_barrier
    s_add_u32 s101, s101, 98304
    s_cmp_eq_u32 s101, 1572864
    s_cselect_b32 s101, 0, s101
    s_add_u32 m0, s43, 0x1e000
    s_nop 0
    buffer_load_dwordx4 v13, s[28:31], s101 offen lds
    s_add_u32 s101, s101, 98304
    s_add_u32 m0, s43, 0x1f000
    s_nop 0
    buffer_load_dwordx4 v13, s[28:31], s101 offen lds
    ds_read_b128 v[108:111], v17 offset:0
    ds_read_b128 v[124:127], v17 offset:256
    ds_read_b128 v[112:115], v17 offset:64
    ds_read_b128 v[128:131], v17 offset:320
    ds_read_b128 v[116:119], v17 offset:128
    ds_read_b128 v[132:135], v17 offset:384
    ds_read_b128 v[120:123], v17 offset:192
    ds_read_b128 v[136:139], v17 offset:448
    ds_read_b64 v[148:149], v18 offset:0
    ds_read_b64 v[150:151], v18 offset:128
    ds_read_b64 v[152:153], v18 offset:256
    ds_read_b64 v[154:155], v18 offset:384
    v_mov_b32 v40, v236
    v_mov_b32 v42, v232
    v_mov_b32 v41, v236
    v_mov_b32 v43, v232
    v_add_u32 v8, s99, v15
    v_add_u32 v9, 0x26c00, v15
    s_lshl_b32 s76, s50, 8
    v_add_u32 v177, s76, v9
    v_and_b32 v156, 15, v0
    v_lshrrev_b32 v157, 5, v0
    v_lshlrev_b32 v157, 6, v157
    v_lshl_add_u32 v10, v156, 2, v157
    s_add_u32 s76, s76, 0x26800
    v_add_u32 v10, s76, v10
    v_lshlrev_b32 v20, 16, v92
    v_and_b32 v21, 0xffff0000, v92
    v_lshlrev_b32 v22, 16, v93
    v_and_b32 v23, 0xffff0000, v93
    v_lshlrev_b32 v24, 16, v94
    v_and_b32 v25, 0xffff0000, v94
    v_lshlrev_b32 v26, 16, v95
    v_and_b32 v27, 0xffff0000, v95
    v_lshlrev_b32 v28, 16, v96
    v_and_b32 v29, 0xffff0000, v96
    v_lshlrev_b32 v30, 16, v97
    v_and_b32 v31, 0xffff0000, v97
    v_lshlrev_b32 v32, 16, v98
    v_and_b32 v33, 0xffff0000, v98
    v_lshlrev_b32 v34, 16, v99
    v_and_b32 v35, 0xffff0000, v99
    v_and_b32 v44, 0xfff, v179
    s_add_u32 s3, s3, 0x38000
    buffer_load_dword v180, v44, s[32:35], s3 offen sc1
    s_waitcnt lgkmcnt(0)
    s_lshl_b32 s76, s50, 8
    v_add_u32 v17, s76, v17
    v_pk_fma_f32 v[156:157], v[124:125], v[40:41], v[182:183] op_sel:[0,0,1] op_sel_hi:[1,1,1]
    v_pk_mul_f32 v[164:165], v[124:125], v[42:43]
    v_pk_fma_f32 v[158:159], v[126:127], v[40:41], v[182:183] op_sel:[0,0,1] op_sel_hi:[1,1,1]
    v_pk_mul_f32 v[166:167], v[126:127], v[42:43]
    v_pk_fma_f32 v[160:161], v[128:129], v[40:41], v[182:183] op_sel:[0,0,1] op_sel_hi:[1,1,1]
    v_pk_mul_f32 v[168:169], v[128:129], v[42:43]
    v_pk_fma_f32 v[162:163], v[130:131], v[40:41], v[182:183] op_sel:[0,0,1] op_sel_hi:[1,1,1]
    v_pk_mul_f32 v[170:171], v[130:131], v[42:43]
    v_pk_fma_f32 v[60:61], v[108:109], v[60:61], v[156:157]
    v_pk_fma_f32 v[76:77], v[108:109], v[76:77], v[164:165]
    v_pk_fma_f32 v[62:63], v[110:111], v[62:63], v[158:159]
    v_pk_fma_f32 v[78:79], v[110:111], v[78:79], v[166:167]
    v_pk_fma_f32 v[64:65], v[112:113], v[64:65], v[160:161]
    v_pk_fma_f32 v[80:81], v[112:113], v[80:81], v[168:169]
    v_pk_fma_f32 v[66:67], v[114:115], v[66:67], v[162:163]
    v_pk_fma_f32 v[82:83], v[114:115], v[82:83], v[170:171]
    v_cvt_pk_bf16_f32 v76, v76, v77
    v_cvt_pk_bf16_f32 v77, v78, v79
    v_cvt_pk_bf16_f32 v78, v80, v81
    v_cvt_pk_bf16_f32 v79, v82, v83
    v_pk_mul_f32 v[156:157], v[60:61], v[182:183] op_sel:[0,0] op_sel_hi:[1,0]
    v_pk_mul_f32 v[158:159], v[62:63], v[182:183] op_sel:[0,0] op_sel_hi:[1,0]
    v_pk_mul_f32 v[160:161], v[64:65], v[182:183] op_sel:[0,0] op_sel_hi:[1,0]
    v_pk_mul_f32 v[162:163], v[66:67], v[182:183] op_sel:[0,0] op_sel_hi:[1,0]
    v_exp_f32_e64 v156, v156 clamp
    v_max_f32 v60, v183, v60
    v_exp_f32_e64 v157, v157 clamp
    v_max_f32 v61, v183, v61
    v_exp_f32_e64 v158, v158 clamp
    v_max_f32 v62, v183, v62
    v_exp_f32_e64 v159, v159 clamp
    v_max_f32 v63, v183, v63
    v_exp_f32_e64 v160, v160 clamp
    v_max_f32 v64, v183, v64
    v_exp_f32_e64 v161, v161 clamp
    v_max_f32 v65, v183, v65
    v_exp_f32_e64 v162, v162 clamp
    v_max_f32 v66, v183, v66
    v_exp_f32_e64 v163, v163 clamp
    v_max_f32 v67, v183, v67
    v_pk_add_f32 v[60:61], v[60:61], v[156:157]
    v_pk_add_f32 v[62:63], v[62:63], v[158:159]
    v_pk_add_f32 v[64:65], v[64:65], v[160:161]
    v_pk_add_f32 v[66:67], v[66:67], v[162:163]
    v_cvt_pk_bf16_f32 v60, v60, v61
    v_cvt_pk_bf16_f32 v61, v62, v63
    v_cvt_pk_bf16_f32 v62, v64, v65
    v_cvt_pk_bf16_f32 v63, v66, v67
    v_pk_fma_f32 v[156:157], v[132:133], v[40:41], v[182:183] op_sel:[0,0,1] op_sel_hi:[1,1,1]
    v_pk_mul_f32 v[164:165], v[132:133], v[42:43]
    v_pk_fma_f32 v[158:159], v[134:135], v[40:41], v[182:183] op_sel:[0,0,1] op_sel_hi:[1,1,1]
    v_pk_mul_f32 v[166:167], v[134:135], v[42:43]
    v_pk_fma_f32 v[160:161], v[136:137], v[40:41], v[182:183] op_sel:[0,0,1] op_sel_hi:[1,1,1]
    v_pk_mul_f32 v[168:169], v[136:137], v[42:43]
    v_pk_fma_f32 v[162:163], v[138:139], v[40:41], v[182:183] op_sel:[0,0,1] op_sel_hi:[1,1,1]
    v_pk_mul_f32 v[170:171], v[138:139], v[42:43]
    v_pk_fma_f32 v[68:69], v[116:117], v[68:69], v[156:157]
    v_pk_fma_f32 v[84:85], v[116:117], v[84:85], v[164:165]
    v_pk_fma_f32 v[70:71], v[118:119], v[70:71], v[158:159]
    v_pk_fma_f32 v[86:87], v[118:119], v[86:87], v[166:167]
    v_pk_fma_f32 v[72:73], v[120:121], v[72:73], v[160:161]
    v_pk_fma_f32 v[88:89], v[120:121], v[88:89], v[168:169]
    v_pk_fma_f32 v[74:75], v[122:123], v[74:75], v[162:163]
    v_pk_fma_f32 v[90:91], v[122:123], v[90:91], v[170:171]
    v_cvt_pk_bf16_f32 v84, v84, v85
    v_cvt_pk_bf16_f32 v85, v86, v87
    v_cvt_pk_bf16_f32 v86, v88, v89
    v_cvt_pk_bf16_f32 v87, v90, v91
    v_pk_mul_f32 v[156:157], v[68:69], v[182:183] op_sel:[0,0] op_sel_hi:[1,0]
    v_pk_mul_f32 v[158:159], v[70:71], v[182:183] op_sel:[0,0] op_sel_hi:[1,0]
    v_pk_mul_f32 v[160:161], v[72:73], v[182:183] op_sel:[0,0] op_sel_hi:[1,0]
    v_pk_mul_f32 v[162:163], v[74:75], v[182:183] op_sel:[0,0] op_sel_hi:[1,0]
    v_exp_f32_e64 v156, v156 clamp
    v_max_f32 v68, v183, v68
    v_exp_f32_e64 v157, v157 clamp
    v_max_f32 v69, v183, v69
    v_exp_f32_e64 v158, v158 clamp
    v_max_f32 v70, v183, v70
    v_exp_f32_e64 v159, v159 clamp
    v_max_f32 v71, v183, v71
    v_exp_f32_e64 v160, v160 clamp
    v_max_f32 v72, v183, v72
    v_exp_f32_e64 v161, v161 clamp
    v_max_f32 v73, v183, v73
    v_exp_f32_e64 v162, v162 clamp
    v_max_f32 v74, v183, v74
    v_exp_f32_e64 v163, v163 clamp
    v_max_f32 v75, v183, v75
    v_pk_add_f32 v[68:69], v[68:69], v[156:157]
    v_pk_add_f32 v[70:71], v[70:71], v[158:159]
    v_pk_add_f32 v[72:73], v[72:73], v[160:161]
    v_pk_add_f32 v[74:75], v[74:75], v[162:163]
    v_cvt_pk_bf16_f32 v68, v68, v69
    v_cvt_pk_bf16_f32 v69, v70, v71
    v_cvt_pk_bf16_f32 v70, v72, v73
    v_cvt_pk_bf16_f32 v71, v74, v75
    v_mfma_f32_16x16x32_bf16 v[184:187], v[60:63], v[76:79], 0
    v_mfma_f32_16x16x32_bf16 v[188:191], v[60:63], v[56:59], 0
    v_mfma_f32_16x16x32_bf16 v[184:187], v[68:71], v[84:87], v[184:187]
    v_mfma_f32_16x16x32_bf16 v[188:191], v[68:71], v[56:59], v[188:191]
    s_add_u32 s88, s53, 0
    s_and_b32 s89, s48, 1
    s_mul_i32 s89, s89, 1344
    s_add_u32 s89, s89, s88
    s_nop 2
    ds_write_b32 v172, v184
    ds_write_b32 v173, v185
    ds_write_b32 v174, v186
    ds_write_b32 v175, v187
    s_mov_b32 exec_lo, 0x00010001
    s_mov_b32 exec_hi, 0x00010001
    ds_write_b128 v176, v[188:191]
    s_mov_b64 exec, -1
    ds_read_b32 v156, v3 offset:0
    ds_read_b32 v157, v3 offset:256
    ds_read_b32 v158, v3 offset:512
    ds_read_b32 v159, v3 offset:768
    ds_read_b32 v160, v3 offset:1024
    s_waitcnt lgkmcnt(4)
    buffer_atomic_add_f32 v156, v15, s[32:35], s89 offen offset:0
    s_waitcnt lgkmcnt(3)
    buffer_atomic_add_f32 v157, v15, s[32:35], s89 offen offset:256
    s_waitcnt lgkmcnt(2)
    buffer_atomic_add_f32 v158, v15, s[32:35], s89 offen offset:512
    s_waitcnt lgkmcnt(1)
    buffer_atomic_add_f32 v159, v15, s[32:35], s89 offen offset:768
    s_waitcnt lgkmcnt(0)
    s_mov_b32 exec_hi, 0xffff
    buffer_atomic_add_f32 v160, v15, s[32:35], s89 offen offset:1024
    s_mov_b64 exec, -1
    s_waitcnt vmcnt(5)
    s_branch Lr3c_12
Lr3_10:
    buffer_load_dword v180, v44, s[32:35], s3 offen sc1
    s_waitcnt vmcnt(0)
Lr3c_12:
    v_subrev_u32 v180, s22, v180
    v_cmp_gt_u32 vcc, 16, v180
    s_nop 1
    s_cmp_eq_u64 vcc, exec
    s_cbranch_scc1 Lr3d_11
    s_sub_u32 s61, s61, 1
    s_cmp_lg_u32 s61, 0
    s_cbranch_scc1 Lr3_10
    s_branch L_end
Lr3d_11:
    s_barrier
    v_add_u32 v19, 0x400, v1
    v_cmp_gt_u32 vcc, 12, v0
    v_mov_b32 v164, 0x1000000
    s_nop 0
    v_cndmask_b32 v19, v164, v19, vcc
    ds_read_b64_tr_b16 v[108:109], v195 offset:49152
    ds_read_b64_tr_b16 v[110:111], v195 offset:49664
    ds_read_b128 v[112:115], v6 offset:0
    ds_read_b128 v[116:119], v6 offset:2048
    ds_read_b128 v[120:123], v6 offset:4096
    ds_read_b128 v[124:127], v6 offset:6144
    s_waitcnt lgkmcnt(4)
    ds_read_b64_tr_b16 v[128:129], v195 offset:53248
    ds_read_b64_tr_b16 v[130:131], v195 offset:53760
    s_waitcnt lgkmcnt(5)
    v_mfma_f32_16x16x32_bf16 v[60:63], v[108:111], v[112:115], 0
    ds_read_b128 v[132:135], v7 offset:0
    s_add_u32 s96, s52, 0x0
    v_mfma_f32_16x16x32_bf16 v[36:39], v[108:111], v[56:59], 0
    buffer_load_dwordx4 a[128:131], v1, s[32:35], s96 offen offset:0 sc1
    s_waitcnt lgkmcnt(5)
    v_mfma_f32_16x16x32_bf16 v[64:67], v[108:111], v[116:119], 0
    ds_read_b128 v[136:139], v7 offset:2048
    s_waitcnt lgkmcnt(5)
    v_mfma_f32_16x16x32_bf16 v[68:71], v[108:111], v[120:123], 0
    ds_read_b128 v[140:143], v7 offset:4096
    s_waitcnt lgkmcnt(5)
    v_mfma_f32_16x16x32_bf16 v[72:75], v[108:111], v[124:127], 0
    buffer_load_dwordx4 a[132:135], v1, s[32:35], s96 offen offset:1024 sc1
    s_waitcnt lgkmcnt(3)
    ds_read_b128 v[144:147], v7 offset:6144
    s_waitcnt lgkmcnt(3)
    v_mfma_f32_16x16x32_bf16 v[60:63], v[128:131], v[132:135], v[60:63]
    ds_read_b64_tr_b16 v[108:109], v195 offset:57344
    ds_read_b64_tr_b16 v[110:111], v195 offset:57856
    ds_read_b128 v[112:115], v6 offset:8192
    v_mfma_f32_16x16x32_bf16 v[36:39], v[128:131], v[56:59], v[36:39]
    buffer_load_dwordx4 a[136:139], v1, s[32:35], s96 offen offset:2048 sc1
    s_waitcnt lgkmcnt(5)
    v_mfma_f32_16x16x32_bf16 v[64:67], v[128:131], v[136:139], v[64:67]
    ds_read_b128 v[116:119], v6 offset:10240
    s_waitcnt lgkmcnt(5)
    v_mfma_f32_16x16x32_bf16 v[68:71], v[128:131], v[140:143], v[68:71]
    ds_read_b128 v[120:123], v6 offset:12288
    s_waitcnt lgkmcnt(5)
    v_mfma_f32_16x16x32_bf16 v[72:75], v[128:131], v[144:147], v[72:75]
    buffer_load_dwordx4 a[140:143], v1, s[32:35], s96 offen offset:3072 sc1
    s_waitcnt lgkmcnt(3)
    ds_read_b128 v[124:127], v6 offset:14336
    s_waitcnt lgkmcnt(3)
    v_mfma_f32_16x16x32_bf16 v[60:63], v[108:111], v[112:115], v[60:63]
    ds_read_b64_tr_b16 v[128:129], v195 offset:61440
    ds_read_b64_tr_b16 v[130:131], v195 offset:61952
    ds_read_b128 v[132:135], v7 offset:8192
    v_mfma_f32_16x16x32_bf16 v[36:39], v[108:111], v[56:59], v[36:39]
    s_add_u32 s96, s52, 0x1000
    s_waitcnt lgkmcnt(5)
    v_mfma_f32_16x16x32_bf16 v[64:67], v[108:111], v[116:119], v[64:67]
    buffer_load_dwordx4 a[144:147], v1, s[32:35], s96 offen offset:0 sc1
    s_waitcnt lgkmcnt(4)
    v_mfma_f32_16x16x32_bf16 v[68:71], v[108:111], v[120:123], v[68:71]
    ds_read_b128 v[136:139], v7 offset:10240
    ds_read_b128 v[140:143], v7 offset:12288
    s_waitcnt lgkmcnt(5)
    v_mfma_f32_16x16x32_bf16 v[72:75], v[108:111], v[124:127], v[72:75]
    ds_read_b128 v[144:147], v7 offset:14336
    s_waitcnt lgkmcnt(4)
    ds_read_b64_tr_b16 v[108:109], v195 offset:0
    ds_read_b64_tr_b16 v[110:111], v195 offset:512
    s_waitcnt lgkmcnt(5)
    v_mfma_f32_16x16x32_bf16 v[60:63], v[128:131], v[132:135], v[60:63]
    buffer_load_dwordx4 a[148:151], v1, s[32:35], s96 offen offset:1024 sc1
    v_mfma_f32_16x16x32_bf16 v[36:39], v[128:131], v[56:59], v[36:39]
    ds_read_b128 v[112:115], v6 offset:16384
    s_waitcnt lgkmcnt(5)
    v_mfma_f32_16x16x32_bf16 v[64:67], v[128:131], v[136:139], v[64:67]
    ds_read_b128 v[116:119], v6 offset:18432
    s_waitcnt lgkmcnt(5)
    v_mfma_f32_16x16x32_bf16 v[68:71], v[128:131], v[140:143], v[68:71]
    buffer_load_dwordx4 a[152:155], v1, s[32:35], s96 offen offset:2048 sc1
    s_waitcnt lgkmcnt(4)
    v_mfma_f32_16x16x32_bf16 v[72:75], v[128:131], v[144:147], v[72:75]
    ds_read_b128 v[120:123], v6 offset:20480
    ds_read_b128 v[124:127], v6 offset:22528
    s_waitcnt lgkmcnt(4)
    ds_read_b64_tr_b16 v[128:129], v195 offset:4096
    ds_read_b64_tr_b16 v[130:131], v195 offset:4608
    s_waitcnt lgkmcnt(5)
    v_mfma_f32_16x16x32_bf16 v[60:63], v[108:111], v[112:115], v[60:63]
    buffer_load_dwordx4 a[156:159], v1, s[32:35], s96 offen offset:3072 sc1
    v_mfma_f32_16x16x32_bf16 v[36:39], v[108:111], v[56:59], v[36:39]
    ds_read_b128 v[132:135], v7 offset:16384
    s_add_u32 s96, s52, 0x2000
    s_waitcnt lgkmcnt(5)
    v_mfma_f32_16x16x32_bf16 v[64:67], v[108:111], v[116:119], v[64:67]
    ds_read_b128 v[136:139], v7 offset:18432
    s_waitcnt lgkmcnt(5)
    v_mfma_f32_16x16x32_bf16 v[68:71], v[108:111], v[120:123], v[68:71]
    buffer_load_dwordx4 a[160:163], v1, s[32:35], s96 offen offset:0 sc1
    s_waitcnt lgkmcnt(4)
    v_mfma_f32_16x16x32_bf16 v[72:75], v[108:111], v[124:127], v[72:75]
    ds_read_b128 v[140:143], v7 offset:20480
    ds_read_b128 v[144:147], v7 offset:22528
    s_waitcnt lgkmcnt(4)
    ds_read_b64_tr_b16 v[108:109], v195 offset:8192
    ds_read_b64_tr_b16 v[110:111], v195 offset:8704
    s_waitcnt lgkmcnt(5)
    v_mfma_f32_16x16x32_bf16 v[60:63], v[128:131], v[132:135], v[60:63]
    buffer_load_dwordx4 a[164:167], v1, s[32:35], s96 offen offset:1024 sc1
    v_mfma_f32_16x16x32_bf16 v[36:39], v[128:131], v[56:59], v[36:39]
    ds_read_b128 v[112:115], v6 offset:24576
    s_waitcnt lgkmcnt(5)
    v_mfma_f32_16x16x32_bf16 v[64:67], v[128:131], v[136:139], v[64:67]
    ds_read_b128 v[116:119], v6 offset:26624
    s_waitcnt lgkmcnt(5)
    v_mfma_f32_16x16x32_bf16 v[68:71], v[128:131], v[140:143], v[68:71]
    buffer_load_dwordx4 a[168:171], v1, s[32:35], s96 offen offset:2048 sc1
    s_waitcnt lgkmcnt(4)
    v_mfma_f32_16x16x32_bf16 v[72:75], v[128:131], v[144:147], v[72:75]
    ds_read_b128 v[120:123], v6 offset:28672
    ds_read_b128 v[124:127], v6 offset:30720
    s_waitcnt lgkmcnt(4)
    ds_read_b64_tr_b16 v[128:129], v195 offset:12288
    ds_read_b64_tr_b16 v[130:131], v195 offset:12800
    s_waitcnt lgkmcnt(5)
    v_mfma_f32_16x16x32_bf16 v[60:63], v[108:111], v[112:115], v[60:63]
    buffer_load_dwordx4 a[172:175], v1, s[32:35], s96 offen offset:3072 sc1
    v_mfma_f32_16x16x32_bf16 v[36:39], v[108:111], v[56:59], v[36:39]
    ds_read_b128 v[132:135], v7 offset:24576
    s_add_u32 s96, s52, 0x3000
    s_waitcnt lgkmcnt(5)
    v_mfma_f32_16x16x32_bf16 v[64:67], v[108:111], v[116:119], v[64:67]
    ds_read_b128 v[136:139], v7 offset:26624
    s_waitcnt lgkmcnt(5)
    v_mfma_f32_16x16x32_bf16 v[68:71], v[108:111], v[120:123], v[68:71]
    buffer_load_dwordx4 a[176:179], v1, s[32:35], s96 offen offset:0 sc1
    s_waitcnt lgkmcnt(4)
    v_mfma_f32_16x16x32_bf16 v[72:75], v[108:111], v[124:127], v[72:75]
    ds_read_b128 v[140:143], v7 offset:28672
    ds_read_b128 v[144:147], v7 offset:30720
    s_waitcnt lgkmcnt(4)
    ds_read_b64_tr_b16 v[108:109], v195 offset:16384
    ds_read_b64_tr_b16 v[110:111], v195 offset:16896
    s_waitcnt lgkmcnt(5)
    v_mfma_f32_16x16x32_bf16 v[60:63], v[128:131], v[132:135], v[60:63]
    buffer_load_dwordx4 a[180:183], v1, s[32:35], s96 offen offset:1024 sc1
    v_mfma_f32_16x16x32_bf16 v[36:39], v[128:131], v[56:59], v[36:39]
    ds_read_b128 v[112:115], v6 offset:32768
    s_waitcnt lgkmcnt(5)
    v_mfma_f32_16x16x32_bf16 v[64:67], v[128:131], v[136:139], v[64:67]
    ds_read_b128 v[116:119], v6 offset:34816
    s_waitcnt lgkmcnt(5)
    v_mfma_f32_16x16x32_bf16 v[68:71], v[128:131], v[140:143], v[68:71]
    buffer_load_dwordx4 a[184:187], v1, s[32:35], s96 offen offset:2048 sc1
    s_waitcnt lgkmcnt(4)
    v_mfma_f32_16x16x32_bf16 v[72:75], v[128:131], v[144:147], v[72:75]
    ds_read_b128 v[120:123], v6 offset:36864
    ds_read_b128 v[124:127], v6 offset:38912
    s_waitcnt lgkmcnt(4)
    ds_read_b64_tr_b16 v[128:129], v195 offset:20480
    ds_read_b64_tr_b16 v[130:131], v195 offset:20992
    s_waitcnt lgkmcnt(5)
    v_mfma_f32_16x16x32_bf16 v[60:63], v[108:111], v[112:115], v[60:63]
    buffer_load_dwordx4 a[188:191], v1, s[32:35], s96 offen offset:3072 sc1
    v_mfma_f32_16x16x32_bf16 v[36:39], v[108:111], v[56:59], v[36:39]
    ds_read_b128 v[132:135], v7 offset:32768
    s_add_u32 s96, s52, 0x4000
    s_waitcnt lgkmcnt(5)
    v_mfma_f32_16x16x32_bf16 v[64:67], v[108:111], v[116:119], v[64:67]
    ds_read_b128 v[136:139], v7 offset:34816
    s_waitcnt lgkmcnt(5)
    v_mfma_f32_16x16x32_bf16 v[68:71], v[108:111], v[120:123], v[68:71]
    buffer_load_dwordx4 a[192:195], v192, s[32:35], s96 offen offset:0 sc1
    s_waitcnt lgkmcnt(4)
    v_mfma_f32_16x16x32_bf16 v[72:75], v[108:111], v[124:127], v[72:75]
    ds_read_b128 v[140:143], v7 offset:36864
    ds_read_b128 v[144:147], v7 offset:38912
    s_waitcnt lgkmcnt(4)
    ds_read_b64_tr_b16 v[108:109], v195 offset:24576
    ds_read_b64_tr_b16 v[110:111], v195 offset:25088
    s_waitcnt lgkmcnt(5)
    v_mfma_f32_16x16x32_bf16 v[60:63], v[128:131], v[132:135], v[60:63]
    buffer_load_dwordx4 a[196:199], v193, s[32:35], s96 offen offset:1024 sc1
    v_mfma_f32_16x16x32_bf16 v[36:39], v[128:131], v[56:59], v[36:39]
    ds_read_b128 v[112:115], v6 offset:40960
    s_waitcnt lgkmcnt(5)
    v_mfma_f32_16x16x32_bf16 v[64:67], v[128:131], v[136:139], v[64:67]
    ds_read_b128 v[116:119], v6 offset:43008
    s_waitcnt lgkmcnt(5)
    v_mfma_f32_16x16x32_bf16 v[68:71], v[128:131], v[140:143], v[68:71]
    buffer_load_dwordx4 a[200:203], v194, s[32:35], s96 offen offset:2048 sc1
    s_waitcnt lgkmcnt(4)
    v_mfma_f32_16x16x32_bf16 v[72:75], v[128:131], v[144:147], v[72:75]
    ds_read_b128 v[120:123], v6 offset:45056
    ds_read_b128 v[124:127], v6 offset:47104
    s_waitcnt lgkmcnt(4)
    ds_read_b64_tr_b16 v[128:129], v195 offset:28672
    ds_read_b64_tr_b16 v[130:131], v195 offset:29184
    s_waitcnt lgkmcnt(5)
    v_mfma_f32_16x16x32_bf16 v[60:63], v[108:111], v[112:115], v[60:63]
    buffer_load_dwordx4 a[204:207], v192, s[32:35], s96 offen offset:3072 sc1
    v_mfma_f32_16x16x32_bf16 v[36:39], v[108:111], v[56:59], v[36:39]
    ds_read_b128 v[132:135], v7 offset:40960
    s_add_u32 s96, s52, 0x5000
    s_waitcnt lgkmcnt(5)
    v_mfma_f32_16x16x32_bf16 v[64:67], v[108:111], v[116:119], v[64:67]
    ds_read_b128 v[136:139], v7 offset:43008
    s_waitcnt lgkmcnt(5)
    v_mfma_f32_16x16x32_bf16 v[68:71], v[108:111], v[120:123], v[68:71]
    buffer_load_dwordx4 a[208:211], v193, s[32:35], s96 offen offset:0 sc1
    s_waitcnt lgkmcnt(4)
    v_mfma_f32_16x16x32_bf16 v[72:75], v[108:111], v[124:127], v[72:75]
    ds_read_b128 v[140:143], v7 offset:45056
    ds_read_b128 v[144:147], v7 offset:47104
    s_waitcnt lgkmcnt(4)
    ds_read_b64_tr_b16 v[108:109], v195 offset:32768
    ds_read_b64_tr_b16 v[110:111], v195 offset:33280
    s_waitcnt lgkmcnt(5)
    v_mfma_f32_16x16x32_bf16 v[60:63], v[128:131], v[132:135], v[60:63]
    buffer_load_dwordx4 a[212:215], v194, s[32:35], s96 offen offset:1024 sc1
    v_mfma_f32_16x16x32_bf16 v[36:39], v[128:131], v[56:59], v[36:39]
    ds_read_b128 v[112:115], v6 offset:49152
    s_waitcnt lgkmcnt(5)
    v_mfma_f32_16x16x32_bf16 v[64:67], v[128:131], v[136:139], v[64:67]
    ds_read_b128 v[116:119], v6 offset:51200
    s_waitcnt lgkmcnt(5)
    v_mfma_f32_16x16x32_bf16 v[68:71], v[128:131], v[140:143], v[68:71]
    buffer_load_dwordx4 a[216:219], v192, s[32:35], s96 offen offset:2048 sc1
    s_waitcnt lgkmcnt(4)
    v_mfma_f32_16x16x32_bf16 v[72:75], v[128:131], v[144:147], v[72:75]
    ds_read_b128 v[120:123], v6 offset:53248
    ds_read_b128 v[124:127], v6 offset:55296
    s_waitcnt lgkmcnt(4)
    ds_read_b64_tr_b16 v[128:129], v195 offset:36864
    ds_read_b64_tr_b16 v[130:131], v195 offset:37376
    s_waitcnt lgkmcnt(5)
    v_mfma_f32_16x16x32_bf16 v[60:63], v[108:111], v[112:115], v[60:63]
    buffer_load_dwordx4 a[220:223], v193, s[32:35], s96 offen offset:3072 sc1
    v_mfma_f32_16x16x32_bf16 v[36:39], v[108:111], v[56:59], v[36:39]
    ds_read_b128 v[132:135], v7 offset:49152
    s_add_u32 s96, s52, 0x6000
    s_waitcnt lgkmcnt(5)
    v_mfma_f32_16x16x32_bf16 v[64:67], v[108:111], v[116:119], v[64:67]
    ds_read_b128 v[136:139], v7 offset:51200
    s_waitcnt lgkmcnt(5)
    v_mfma_f32_16x16x32_bf16 v[68:71], v[108:111], v[120:123], v[68:71]
    buffer_load_dwordx4 a[224:227], v194, s[32:35], s96 offen offset:0 sc1
    s_waitcnt lgkmcnt(4)
    v_mfma_f32_16x16x32_bf16 v[72:75], v[108:111], v[124:127], v[72:75]
    ds_read_b128 v[140:143], v7 offset:53248
    ds_read_b128 v[144:147], v7 offset:55296
    s_waitcnt lgkmcnt(4)
    ds_read_b64_tr_b16 v[108:109], v195 offset:40960
    ds_read_b64_tr_b16 v[110:111], v195 offset:41472
    s_waitcnt lgkmcnt(5)
    v_mfma_f32_16x16x32_bf16 v[60:63], v[128:131], v[132:135], v[60:63]
    buffer_load_dwordx4 a[228:231], v192, s[32:35], s96 offen offset:1024 sc1
    v_mfma_f32_16x16x32_bf16 v[36:39], v[128:131], v[56:59], v[36:39]
    ds_read_b128 v[112:115], v6 offset:57344
    s_waitcnt lgkmcnt(5)
    v_mfma_f32_16x16x32_bf16 v[64:67], v[128:131], v[136:139], v[64:67]
    ds_read_b128 v[116:119], v6 offset:59392
    s_waitcnt lgkmcnt(5)
    v_mfma_f32_16x16x32_bf16 v[68:71], v[128:131], v[140:143], v[68:71]
    buffer_load_dwordx4 a[232:235], v193, s[32:35], s96 offen offset:2048 sc1
    s_waitcnt lgkmcnt(4)
    v_mfma_f32_16x16x32_bf16 v[72:75], v[128:131], v[144:147], v[72:75]
    ds_read_b128 v[120:123], v6 offset:61440
    ds_read_b128 v[124:127], v6 offset:63488
    s_waitcnt lgkmcnt(4)
    ds_read_b64_tr_b16 v[128:129], v195 offset:45056
    ds_read_b64_tr_b16 v[130:131], v195 offset:45568
    s_waitcnt lgkmcnt(5)
    v_mfma_f32_16x16x32_bf16 v[60:63], v[108:111], v[112:115], v[60:63]
    buffer_load_dwordx4 a[236:239], v194, s[32:35], s96 offen offset:3072 sc1
    v_mfma_f32_16x16x32_bf16 v[36:39], v[108:111], v[56:59], v[36:39]
    ds_read_b128 v[132:135], v7 offset:57344
    s_add_u32 s96, s52, 0x7000
    s_waitcnt lgkmcnt(5)
    v_mfma_f32_16x16x32_bf16 v[64:67], v[108:111], v[116:119], v[64:67]
    ds_read_b128 v[136:139], v7 offset:59392
    s_waitcnt lgkmcnt(5)
    v_mfma_f32_16x16x32_bf16 v[68:71], v[108:111], v[120:123], v[68:71]
    buffer_load_dwordx4 a[240:243], v192, s[32:35], s96 offen offset:0 sc1
    s_waitcnt lgkmcnt(4)
    v_mfma_f32_16x16x32_bf16 v[72:75], v[108:111], v[124:127], v[72:75]
    ds_read_b128 v[140:143], v7 offset:61440
    ds_read_b128 v[144:147], v7 offset:63488
    s_waitcnt lgkmcnt(4)
    s_waitcnt lgkmcnt(3)
    v_mfma_f32_16x16x32_bf16 v[60:63], v[128:131], v[132:135], v[60:63]
    v_mfma_f32_16x16x32_bf16 v[36:39], v[128:131], v[56:59], v[36:39]
    buffer_load_dwordx4 a[244:247], v193, s[32:35], s96 offen offset:1024 sc1
    s_waitcnt lgkmcnt(2)
    v_mfma_f32_16x16x32_bf16 v[64:67], v[128:131], v[136:139], v[64:67]
    s_waitcnt lgkmcnt(1)
    v_mfma_f32_16x16x32_bf16 v[68:71], v[128:131], v[140:143], v[68:71]
    s_waitcnt lgkmcnt(0)
    v_mfma_f32_16x16x32_bf16 v[72:75], v[128:131], v[144:147], v[72:75]
    buffer_load_dwordx4 a[248:251], v194, s[32:35], s96 offen offset:2048 sc1
    buffer_load_dwordx4 v[92:95], v1, s[32:35], s88 offen offset:0 sc1
    buffer_load_dwordx4 v[96:99], v1, s[32:35], s88 offen offset:1344 sc1
    buffer_load_dwordx4 v[100:103], v19, s[32:35], s88 offen offset:0 sc1
    buffer_load_dwordx4 v[104:107], v19, s[32:35], s88 offen offset:1344 sc1
    v_pk_fma_f32 v[156:157], v[36:37], v[148:149], v[182:183] op_sel:[0,1,1] op_sel_hi:[1,1,1]
    v_pk_fma_f32 v[158:159], v[38:39], v[148:149], v[182:183] op_sel:[0,1,1] op_sel_hi:[1,1,1]
    v_pk_fma_f32 v[160:161], v[36:37], v[150:151], v[182:183] op_sel:[0,1,1] op_sel_hi:[1,1,1]
    v_pk_fma_f32 v[162:163], v[38:39], v[150:151], v[182:183] op_sel:[0,1,1] op_sel_hi:[1,1,1]
    v_pk_fma_f32 v[164:165], v[36:37], v[152:153], v[182:183] op_sel:[0,1,1] op_sel_hi:[1,1,1]
    v_pk_fma_f32 v[166:167], v[38:39], v[152:153], v[182:183] op_sel:[0,1,1] op_sel_hi:[1,1,1]
    v_pk_fma_f32 v[168:169], v[36:37], v[154:155], v[182:183] op_sel:[0,1,1] op_sel_hi:[1,1,1]
    v_pk_fma_f32 v[170:171], v[38:39], v[154:155], v[182:183] op_sel:[0,1,1] op_sel_hi:[1,1,1]
    v_pk_fma_f32 v[60:61], v[60:61], v[148:149], v[156:157] op_sel:[0,0,0] op_sel_hi:[1,0,1]
    v_pk_fma_f32 v[62:63], v[62:63], v[148:149], v[158:159] op_sel:[0,0,0] op_sel_hi:[1,0,1]
    v_pk_fma_f32 v[64:65], v[64:65], v[150:151], v[160:161] op_sel:[0,0,0] op_sel_hi:[1,0,1]
    v_pk_fma_f32 v[66:67], v[66:67], v[150:151], v[162:163] op_sel:[0,0,0] op_sel_hi:[1,0,1]
    v_pk_fma_f32 v[68:69], v[68:69], v[152:153], v[164:165] op_sel:[0,0,0] op_sel_hi:[1,0,1]
    v_pk_fma_f32 v[70:71], v[70:71], v[152:153], v[166:167] op_sel:[0,0,0] op_sel_hi:[1,0,1]
    v_pk_fma_f32 v[72:73], v[72:73], v[154:155], v[168:169] op_sel:[0,0,0] op_sel_hi:[1,0,1]
    v_pk_fma_f32 v[74:75], v[74:75], v[154:155], v[170:171] op_sel:[0,0,0] op_sel_hi:[1,0,1]
    v_pk_mul_f32 v[156:157], v[60:61], v[182:183] op_sel:[0,0] op_sel_hi:[1,0]
    v_pk_mul_f32 v[158:159], v[62:63], v[182:183] op_sel:[0,0] op_sel_hi:[1,0]
    v_pk_mul_f32 v[160:161], v[64:65], v[182:183] op_sel:[0,0] op_sel_hi:[1,0]
    v_pk_mul_f32 v[162:163], v[66:67], v[182:183] op_sel:[0,0] op_sel_hi:[1,0]
    v_exp_f32_e64 v156, v156 clamp
    v_max_f32 v60, v183, v60
    v_exp_f32_e64 v157, v157 clamp
    v_max_f32 v61, v183, v61
    v_exp_f32_e64 v158, v158 clamp
    v_max_f32 v62, v183, v62
    v_exp_f32_e64 v159, v159 clamp
    v_max_f32 v63, v183, v63
    v_exp_f32_e64 v160, v160 clamp
    v_max_f32 v64, v183, v64
    v_exp_f32_e64 v161, v161 clamp
    v_max_f32 v65, v183, v65
    v_exp_f32_e64 v162, v162 clamp
    v_max_f32 v66, v183, v66
    v_exp_f32_e64 v163, v163 clamp
    v_max_f32 v67, v183, v67
    v_pk_add_f32 v[60:61], v[60:61], v[156:157]
    v_pk_add_f32 v[62:63], v[62:63], v[158:159]
    v_pk_add_f32 v[64:65], v[64:65], v[160:161]
    v_pk_add_f32 v[66:67], v[66:67], v[162:163]
    v_cvt_pk_bf16_f32 v76, v60, v61
    v_cvt_pk_bf16_f32 v77, v62, v63
    v_cvt_pk_bf16_f32 v78, v64, v65
    v_cvt_pk_bf16_f32 v79, v66, v67
    v_pk_mul_f32 v[156:157], v[68:69], v[182:183] op_sel:[0,0] op_sel_hi:[1,0]
    v_pk_mul_f32 v[158:159], v[70:71], v[182:183] op_sel:[0,0] op_sel_hi:[1,0]
    v_pk_mul_f32 v[160:161], v[72:73], v[182:183] op_sel:[0,0] op_sel_hi:[1,0]
    v_pk_mul_f32 v[162:163], v[74:75], v[182:183] op_sel:[0,0] op_sel_hi:[1,0]
    v_exp_f32_e64 v156, v156 clamp
    v_max_f32 v68, v183, v68
    v_exp_f32_e64 v157, v157 clamp
    v_max_f32 v69, v183, v69
    v_exp_f32_e64 v158, v158 clamp
    v_max_f32 v70, v183, v70
    v_exp_f32_e64 v159, v159 clamp
    v_max_f32 v71, v183, v71
    v_exp_f32_e64 v160, v160 clamp
    v_max_f32 v72, v183, v72
    v_exp_f32_e64 v161, v161 clamp
    v_max_f32 v73, v183, v73
    v_exp_f32_e64 v162, v162 clamp
    v_max_f32 v74, v183, v74
    v_exp_f32_e64 v163, v163 clamp
    v_max_f32 v75, v183, v75
    v_pk_add_f32 v[68:69], v[68:69], v[156:157]
    v_pk_add_f32 v[70:71], v[70:71], v[158:159]
    v_pk_add_f32 v[72:73], v[72:73], v[160:161]
    v_pk_add_f32 v[74:75], v[74:75], v[162:163]
    v_cvt_pk_bf16_f32 v80, v68, v69
    v_cvt_pk_bf16_f32 v81, v70, v71
    v_cvt_pk_bf16_f32 v82, v72, v73
    v_cvt_pk_bf16_f32 v83, v74, v75
    buffer_load_dwordx4 a[252:255], v192, s[32:35], s96 offen offset:3072 sc1
    s_add_u32 s96, s52, 0x8000
    buffer_load_dwordx4 v[196:199], v193, s[32:35], s96 offen offset:0 sc1
    buffer_load_dwordx4 v[200:203], v194, s[32:35], s96 offen offset:1024 sc1
    buffer_load_dwordx4 v[204:207], v192, s[32:35], s96 offen offset:2048 sc1
    buffer_load_dwordx4 v[208:211], v193, s[32:35], s96 offen offset:3072 sc1
    s_add_u32 s96, s52, 0x9000
    buffer_load_dwordx4 v[212:215], v194, s[32:35], s96 offen offset:0 sc1
    buffer_load_dwordx4 v[216:219], v192, s[32:35], s96 offen offset:1024 sc1
    buffer_load_dwordx4 v[220:223], v193, s[32:35], s96 offen offset:2048 sc1
    buffer_load_dwordx4 v[224:227], v194, s[32:35], s96 offen offset:3072 sc1
    s_add_u32 s96, s52, 0xa000
    buffer_load_dwordx4 v[228:231], v192, s[32:35], s96 offen offset:0 sc1
    buffer_load_dwordx4 v[252:255], v193, s[32:35], s96 offen offset:1024 sc1
    buffer_load_dwordx4 v[248:251], v194, s[32:35], s96 offen offset:2048 sc1
    s_add_u32 s82, s56, s57
    s_add_u32 s82, s82, 0xa00000
    s_add_u32 s83, s82, 90112
    v_lshl_add_u32 v124, v0, 4, v3
    v_sub_u32 v124, v124, v15
    s_waitcnt vmcnt(12)
    s_branch Lkvc_15
Lkv_13:
    buffer_load_dwordx4 v[92:95], v1, s[32:35], s88 offen offset:0 sc1
    buffer_load_dwordx4 v[96:99], v1, s[32:35], s88 offen offset:1344 sc1
    buffer_load_dwordx4 v[100:103], v19, s[32:35], s88 offen offset:0 sc1
    buffer_load_dwordx4 v[104:107], v19, s[32:35], s88 offen offset:1344 sc1
    s_waitcnt vmcnt(0)
Lkvc_15:
    v_pk_add_f32 v[156:157], v[92:93], v[96:97]
    v_pk_add_f32 v[158:159], v[94:95], v[98:99]
    v_pk_add_f32 v[164:165], v[100:101], v[104:105]
    v_pk_add_f32 v[166:167], v[102:103], v[106:107]
    ds_write_b128 v124, v[156:159] offset:1280
    s_mov_b64 exec, 0xfff
    ds_write_b128 v124, v[164:167] offset:2304
    s_mov_b64 exec, -1
    ds_read_b128 v[160:163], v176 offset:1280
    ds_read_b32 v168, v172 offset:1280
    ds_read_b32 v169, v173 offset:1280
    ds_read_b32 v170, v174 offset:1280
    ds_read_b32 v171, v175 offset:1280
    v_cmp_eq_f32 vcc, 0x42000000, v159
    v_cmp_eq_f32 s[76:77], v167, v159
    s_nop 0
    s_and_b64 vcc, vcc, s[72:73]
    s_and_b32 s76, s76, 0x888
    s_xor_b32 s76, s76, 0x888
    s_xor_b64 vcc, vcc, s[72:73]
    s_or_b32 s76, s76, vcc_lo
    s_or_b32 s76, s76, vcc_hi
    s_cbranch_scc0 Lkvd_14
    s_waitcnt lgkmcnt(0)
    s_sub_u32 s61, s61, 1
    s_cmp_lg_u32 s61, 0
    s_cbranch_scc1 Lkv_13
    s_branch L_end
Lkvd_14:
    s_waitcnt lgkmcnt(4)
    v_cvt_pk_bf16_f32 v166, v160, v161
    v_cvt_pk_bf16_f32 v167, v162, v163
    s_nop 1
    v_mfma_f32_16x16x16_bf16 v[108:111], v[166:167], v[76:77], 0
    v_mfma_f32_16x16x16_bf16 v[112:115], v[166:167], v[78:79], 0
    v_mfma_f32_16x16x16_bf16 v[116:119], v[166:167], v[80:81], 0
    v_mfma_f32_16x16x16_bf16 v[120:123], v[166:167], v[82:83], 0
    s_waitcnt lgkmcnt(0)
    v_cvt_pk_bf16_f32 v164, v168, v169
    v_cvt_pk_bf16_f32 v165, v170, v171
    s_nop 1
    v_mfma_f32_16x16x16_bf16 v[60:63], v[164:165], v[76:77], 0
    v_mfma_f32_16x16x16_bf16 v[64:67], v[164:165], v[78:79], 0
    v_mfma_f32_16x16x16_bf16 v[68:71], v[164:165], v[80:81], 0
    v_mfma_f32_16x16x16_bf16 v[72:75], v[164:165], v[82:83], 0
    v_add_f32 v108, s62, v108
    v_add_f32 v112, s62, v112
    v_add_f32 v116, s62, v116
    v_add_f32 v120, s62, v120
    v_rcp_f32 v108, v108
    v_rcp_f32 v112, v112
    v_rcp_f32 v116, v116
    v_rcp_f32 v120, v120
    v_pk_mul_f32 v[60:61], v[60:61], v[108:109] op_sel_hi:[1,0]
    v_pk_mul_f32 v[62:63], v[62:63], v[108:109] op_sel_hi:[1,0]
    v_pk_mul_f32 v[64:65], v[64:65], v[112:113] op_sel_hi:[1,0]
    v_pk_mul_f32 v[66:67], v[66:67], v[112:113] op_sel_hi:[1,0]
    v_pk_mul_f32 v[68:69], v[68:69], v[116:117] op_sel_hi:[1,0]
    v_pk_mul_f32 v[70:71], v[70:71], v[116:117] op_sel_hi:[1,0]
    v_pk_mul_f32 v[72:73], v[72:73], v[120:121] op_sel_hi:[1,0]
    v_pk_mul_f32 v[74:75], v[74:75], v[120:121] op_sel_hi:[1,0]
    v_cvt_pk_bf16_f32 v156, v60, v61
    v_cvt_pk_bf16_f32 v157, v62, v63
    v_cvt_pk_bf16_f32 v158, v64, v65
    v_cvt_pk_bf16_f32 v159, v66, v67
    v_cvt_pk_bf16_f32 v160, v68, v69
    v_cvt_pk_bf16_f32 v161, v70, v71
    v_cvt_pk_bf16_f32 v162, v72, v73
    v_cvt_pk_bf16_f32 v163, v74, v75
    v_permlane16_swap_b32 v156, v158
    v_permlane16_swap_b32 v157, v159
    v_permlane16_swap_b32 v160, v162
    v_permlane16_swap_b32 v161, v163
    s_cmp_eq_u32 s51, 1
    s_cbranch_scc0 Lslow_16
    buffer_store_dwordx4 v[156:159], v5, s[32:35], s82 offen offset:0
    buffer_store_dwordx4 v[160:163], v5, s[32:35], s83 offen offset:0
Ljoin_17:
    s_add_u32 s76, s22, 1
    v_mov_b32 v19, s76
    s_waitcnt vmcnt(0)
    s_mov_b64 exec, 1
    s_cmp_eq_u32 s51, 1
    s_cbranch_scc0 Lslow_18
    buffer_store_dword v19, off, s[32:35], s98
Ljoin_19:
    s_mov_b64 exec, -1
    s_add_u32 s76, s22, 1
Lpoll_20:
    buffer_load_dword v180, v14, s[32:35], s54 offen sc1
    s_waitcnt vmcnt(0)
Lpc_22:
    v_subrev_u32 v180, s76, v180
    v_cmp_gt_u32 vcc, 15, v180
    s_nop 1
    s_cmp_eq_u64 vcc, exec
    s_cbranch_scc1 Lpd_21
    s_sub_u32 s61, s61, 1
    s_cmp_lg_u32 s61, 0
    s_cbranch_scc1 Lpoll_20
    s_branch L_end
Lpd_21:
    s_add_u32 m0, s99, 0x0
    s_add_u32 s101, s56, 0xa00000
    buffer_load_dwordx4 v181, s[32:35], s101 offen offset:0 sc1 lds
    buffer_load_dwordx4 v181, s[32:35], s101 offen offset:1024 sc1 lds
    s_add_u32 m0, s99, 0x2000
    s_add_u32 s101, s56, 0xa02000
    buffer_load_dwordx4 v181, s[32:35], s101 offen offset:0 sc1 lds
    buffer_load_dwordx4 v181, s[32:35], s101 offen offset:1024 sc1 lds
    s_add_u32 m0, s99, 0x4000
    s_add_u32 s101, s56, 0xa04000
    buffer_load_dwordx4 v181, s[32:35], s101 offen offset:0 sc1 lds
    buffer_load_dwordx4 v181, s[32:35], s101 offen offset:1024 sc1 lds
    s_add_u32 m0, s99, 0x6000
    s_add_u32 s101, s56, 0xa06000
    buffer_load_dwordx4 v181, s[32:35], s101 offen offset:0 sc1 lds
    buffer_load_dwordx4 v181, s[32:35], s101 offen offset:1024 sc1 lds
    s_add_u32 m0, s99, 0x8000
    s_add_u32 s101, s56, 0xa16000
    buffer_load_dwordx4 v181, s[32:35], s101 offen offset:0 sc1 lds
    buffer_load_dwordx4 v181, s[32:35], s101 offen offset:1024 sc1 lds
    s_waitcnt vmcnt(8)
    s_barrier
    ds_read_b128 v[108:111], v1 offset:0
    ds_read_b128 v[112:115], v1 offset:2048
    ds_read_b128 v[116:119], v1 offset:1024
    ds_read_b128 v[120:123], v1 offset:3072
    ds_read_b128 v[124:127], v1 offset:4096
    ds_read_b128 v[128:131], v1 offset:6144
    ds_read_b128 v[132:135], v1 offset:5120
    ds_read_b128 v[136:139], v1 offset:7168
    s_waitcnt vmcnt(6)
    s_barrier
    ds_read_b128 v[140:143], v1 offset:8192
    s_waitcnt lgkmcnt(7)
    v_mfma_f32_16x16x32_bf16 v[20:23], a[128:131], v[108:111], v[20:23]
    ds_read_b128 v[144:147], v1 offset:10240
    s_add_u32 m0, s99, 0xa000
    v_mfma_f32_16x16x32_bf16 v[24:27], a[128:131], v[112:115], v[24:27]
    ds_read_b128 v[108:111], v1 offset:9216
    s_add_u32 s101, s56, 0xa18000
    s_waitcnt lgkmcnt(7)
    v_mfma_f32_16x16x32_bf16 v[20:23], a[132:135], v[116:119], v[20:23]
    buffer_load_dwordx4 v181, s[32:35], s101 offen offset:0 sc1 lds
    v_mfma_f32_16x16x32_bf16 v[24:27], a[132:135], v[120:123], v[24:27]
    ds_read_b128 v[112:115], v1 offset:11264
    ds_read_b128 v[116:119], v1 offset:12288
    s_waitcnt lgkmcnt(7)
    v_mfma_f32_16x16x32_bf16 v[20:23], a[136:139], v[124:127], v[20:23]
    buffer_load_dwordx4 v181, s[32:35], s101 offen offset:1024 sc1 lds
    v_mfma_f32_16x16x32_bf16 v[24:27], a[136:139], v[128:131], v[24:27]
    ds_read_b128 v[120:123], v1 offset:14336
    ds_read_b128 v[124:127], v1 offset:13312
    s_waitcnt lgkmcnt(7)
    v_mfma_f32_16x16x32_bf16 v[20:23], a[140:143], v[132:135], v[20:23]
    ds_read_b128 v[128:131], v1 offset:15360
    s_add_u32 m0, s99, 0xc000
    v_mfma_f32_16x16x32_bf16 v[24:27], a[140:143], v[136:139], v[24:27]
    s_waitcnt vmcnt(4)
    s_barrier
    ds_read_b128 v[132:135], v1 offset:16384
    s_add_u32 s101, s56, 0xa1a000
    s_waitcnt lgkmcnt(7)
    v_mfma_f32_16x16x32_bf16 v[20:23], a[144:147], v[140:143], v[20:23]
    buffer_load_dwordx4 v181, s[32:35], s101 offen offset:0 sc1 lds
    v_mfma_f32_16x16x32_bf16 v[24:27], a[144:147], v[144:147], v[24:27]
    ds_read_b128 v[136:139], v1 offset:18432
    ds_read_b128 v[140:143], v1 offset:17408
    s_waitcnt lgkmcnt(7)
    v_mfma_f32_16x16x32_bf16 v[20:23], a[148:151], v[108:111], v[20:23]
    buffer_load_dwordx4 v181, s[32:35], s101 offen offset:1024 sc1 lds
    v_mfma_f32_16x16x32_bf16 v[24:27], a[148:151], v[112:115], v[24:27]
    ds_read_b128 v[144:147], v1 offset:19456
    ds_read_b128 v[108:111], v1 offset:20480
    s_waitcnt lgkmcnt(7)
    v_mfma_f32_16x16x32_bf16 v[20:23], a[152:155], v[116:119], v[20:23]
    ds_read_b128 v[112:115], v1 offset:22528
    s_add_u32 m0, s99, 0xe000
    v_mfma_f32_16x16x32_bf16 v[24:27], a[152:155], v[120:123], v[24:27]
    ds_read_b128 v[116:119], v1 offset:21504
    s_add_u32 s101, s56, 0xa1c000
    s_waitcnt lgkmcnt(7)
    v_mfma_f32_16x16x32_bf16 v[20:23], a[156:159], v[124:127], v[20:23]
    buffer_load_dwordx4 v181, s[32:35], s101 offen offset:0 sc1 lds
    v_mfma_f32_16x16x32_bf16 v[24:27], a[156:159], v[128:131], v[24:27]
    ds_read_b128 v[120:123], v1 offset:23552
    ds_read_b128 v[124:127], v1 offset:24576
    s_waitcnt lgkmcnt(7)
    v_mfma_f32_16x16x32_bf16 v[20:23], a[160:163], v[132:135], v[20:23]
    buffer_load_dwordx4 v181, s[32:35], s101 offen offset:1024 sc1 lds
    v_mfma_f32_16x16x32_bf16 v[24:27], a[160:163], v[136:139], v[24:27]
    ds_read_b128 v[128:131], v1 offset:26624
    ds_read_b128 v[132:135], v1 offset:25600
    s_waitcnt lgkmcnt(7)
    v_mfma_f32_16x16x32_bf16 v[20:23], a[164:167], v[140:143], v[20:23]
    ds_read_b128 v[136:139], v1 offset:27648
    v_mfma_f32_16x16x32_bf16 v[24:27], a[164:167], v[144:147], v[24:27]
    buffer_load_dwordx4 v[244:247], v192, s[32:35], s96 offen offset:3072 sc1
    s_waitcnt lgkmcnt(6)
    v_mfma_f32_16x16x32_bf16 v[20:23], a[168:171], v[108:111], v[20:23]
    ds_read_b128 v[140:143], v1 offset:28672
    ds_read_b128 v[144:147], v1 offset:30720
    v_mfma_f32_16x16x32_bf16 v[24:27], a[168:171], v[112:115], v[24:27]
    ds_read_b128 v[108:111], v1 offset:29696
    s_add_u32 s96, s52, 0xb000
    s_waitcnt lgkmcnt(7)
    v_mfma_f32_16x16x32_bf16 v[20:23], a[172:175], v[116:119], v[20:23]
    buffer_load_dwordx4 v[240:243], v193, s[32:35], s96 offen offset:0 sc1
    v_mfma_f32_16x16x32_bf16 v[24:27], a[172:175], v[120:123], v[24:27]
    ds_read_b128 v[112:115], v1 offset:31744
    s_waitcnt vmcnt(6)
    s_barrier
    ds_read_b128 v[116:119], v1 offset:32768
    s_waitcnt lgkmcnt(7)
    v_mfma_f32_16x16x32_bf16 v[20:23], a[176:179], v[124:127], v[20:23]
    ds_read_b128 v[120:123], v1 offset:34816
    v_mfma_f32_16x16x32_bf16 v[24:27], a[176:179], v[128:131], v[24:27]
    buffer_load_dwordx4 v[236:239], v194, s[32:35], s96 offen offset:1024 sc1
    s_waitcnt lgkmcnt(6)
    v_mfma_f32_16x16x32_bf16 v[20:23], a[180:183], v[132:135], v[20:23]
    ds_read_b128 v[124:127], v1 offset:33792
    ds_read_b128 v[128:131], v1 offset:35840
    v_mfma_f32_16x16x32_bf16 v[24:27], a[180:183], v[136:139], v[24:27]
    ds_read_b128 v[132:135], v1 offset:36864
    s_waitcnt lgkmcnt(7)
    v_mfma_f32_16x16x32_bf16 v[20:23], a[184:187], v[140:143], v[20:23]
    buffer_load_dwordx4 v[232:235], v192, s[32:35], s96 offen offset:2048 sc1
    v_mfma_f32_16x16x32_bf16 v[24:27], a[184:187], v[144:147], v[24:27]
    ds_read_b128 v[136:139], v1 offset:38912
    ds_read_b128 v[140:143], v1 offset:37888
    s_waitcnt lgkmcnt(7)
    v_mfma_f32_16x16x32_bf16 v[20:23], a[188:191], v[108:111], v[20:23]
    ds_read_b128 v[144:147], v1 offset:39936
    v_mfma_f32_16x16x32_bf16 v[24:27], a[188:191], v[112:115], v[24:27]
    ds_read_b128 v[108:111], v1 offset:40960
    s_waitcnt lgkmcnt(7)
    v_mfma_f32_16x16x32_bf16 v[28:31], a[128:131], v[116:119], v[28:31]
    ds_read_b128 v[112:115], v1 offset:43008
    v_mfma_f32_16x16x32_bf16 v[32:35], a[128:131], v[120:123], v[32:35]
    ds_read_b128 v[116:119], v1 offset:41984
    s_add_u32 s82, s55, s57
    s_add_u32 s82, s82, 0x800000
    v_cvt_pk_bf16_f32 v158, v20, v21
    v_cvt_pk_bf16_f32 v159, v22, v23
    v_cvt_pk_bf16_f32 v160, v24, v25
    v_cvt_pk_bf16_f32 v161, v26, v27
    s_nop 0
    v_permlane16_swap_b32 v158, v160
    v_permlane16_swap_b32 v159, v161
    s_cmp_eq_u32 s51, 1
    s_cbranch_scc0 Lslow_23
    buffer_store_dwordx4 v[158:161], v5, s[32:35], s82 offen offset:0
Ljoin_24:
    s_waitcnt lgkmcnt(7)
    v_mfma_f32_16x16x32_bf16 v[28:31], a[132:135], v[124:127], v[28:31]
    buffer_load_dwordx4 a[128:131], v193, s[32:35], s96 offen offset:3072 sc1
    v_mfma_f32_16x16x32_bf16 v[32:35], a[132:135], v[128:131], v[32:35]
    ds_read_b128 v[120:123], v1 offset:44032
    ds_read_b128 v[124:127], v1 offset:45056
    s_waitcnt lgkmcnt(7)
    v_mfma_f32_16x16x32_bf16 v[28:31], a[136:139], v[132:135], v[28:31]
    ds_read_b128 v[128:131], v1 offset:47104
    s_add_u32 s96, s52, 0xc000
    v_mfma_f32_16x16x32_bf16 v[32:35], a[136:139], v[136:139], v[32:35]
    buffer_load_dwordx4 a[132:135], v194, s[32:35], s96 offen offset:0 sc1
    s_waitcnt lgkmcnt(6)
    v_mfma_f32_16x16x32_bf16 v[28:31], a[140:143], v[140:143], v[28:31]
    ds_read_b128 v[132:135], v1 offset:46080
    ds_read_b128 v[136:139], v1 offset:48128
    v_mfma_f32_16x16x32_bf16 v[32:35], a[140:143], v[144:147], v[32:35]
    s_waitcnt vmcnt(7)
    s_barrier
    ds_read_b128 v[140:143], v1 offset:49152
    s_waitcnt lgkmcnt(7)
    v_mfma_f32_16x16x32_bf16 v[28:31], a[144:147], v[108:111], v[28:31]
    buffer_load_dwordx4 a[136:139], v192, s[32:35], s96 offen offset:1024 sc1
    v_mfma_f32_16x16x32_bf16 v[32:35], a[144:147], v[112:115], v[32:35]
    ds_read_b128 v[144:147], v1 offset:51200
    ds_read_b128 v[108:111], v1 offset:50176
    s_waitcnt lgkmcnt(7)
    v_mfma_f32_16x16x32_bf16 v[28:31], a[148:151], v[116:119], v[28:31]
    ds_read_b128 v[112:115], v1 offset:52224
    v_mfma_f32_16x16x32_bf16 v[32:35], a[148:151], v[120:123], v[32:35]
    buffer_load_dwordx4 a[140:143], v193, s[32:35], s96 offen offset:2048 sc1
    s_waitcnt lgkmcnt(6)
    v_mfma_f32_16x16x32_bf16 v[28:31], a[152:155], v[124:127], v[28:31]
    ds_read_b128 v[116:119], v1 offset:53248
    ds_read_b128 v[120:123], v1 offset:55296
    v_mfma_f32_16x16x32_bf16 v[32:35], a[152:155], v[128:131], v[32:35]
    ds_read_b128 v[124:127], v1 offset:54272
    s_waitcnt lgkmcnt(7)
    v_mfma_f32_16x16x32_bf16 v[28:31], a[156:159], v[132:135], v[28:31]
    buffer_load_dwordx4 a[144:147], v194, s[32:35], s96 offen offset:3072 sc1
    v_mfma_f32_16x16x32_bf16 v[32:35], a[156:159], v[136:139], v[32:35]
    ds_read_b128 v[128:131], v1 offset:56320
    ds_read_b128 v[132:135], v1 offset:57344
    s_waitcnt lgkmcnt(7)
    v_mfma_f32_16x16x32_bf16 v[28:31], a[160:163], v[140:143], v[28:31]
    ds_read_b128 v[136:139], v1 offset:59392
    s_add_u32 s96, s52, 0xd000
    v_mfma_f32_16x16x32_bf16 v[32:35], a[160:163], v[144:147], v[32:35]
    buffer_load_dwordx4 a[148:151], v192, s[32:35], s96 offen offset:0 sc1
    s_waitcnt lgkmcnt(6)
    v_mfma_f32_16x16x32_bf16 v[28:31], a[164:167], v[108:111], v[28:31]
    ds_read_b128 v[140:143], v1 offset:58368
    ds_read_b128 v[144:147], v1 offset:60416
    v_mfma_f32_16x16x32_bf16 v[32:35], a[164:167], v[112:115], v[32:35]
    ds_read_b128 v[108:111], v1 offset:61440
    s_waitcnt lgkmcnt(7)
    v_mfma_f32_16x16x32_bf16 v[28:31], a[168:171], v[116:119], v[28:31]
    buffer_load_dwordx4 a[152:155], v193, s[32:35], s96 offen offset:1024 sc1
    v_mfma_f32_16x16x32_bf16 v[32:35], a[168:171], v[120:123], v[32:35]
    ds_read_b128 v[112:115], v1 offset:63488
    ds_read_b128 v[116:119], v1 offset:62464
    s_add_u32 s76, s22, 2
    v_mov_b32 v19, s76
    s_waitcnt vmcnt(7)
    s_mov_b64 exec, 1
    s_cmp_eq_u32 s51, 1
    s_cbranch_scc0 Lslow_25
    buffer_store_dword v19, off, s[32:35], s98
Ljoin_26:
    s_mov_b64 exec, -1
    s_waitcnt lgkmcnt(7)
    v_mfma_f32_16x16x32_bf16 v[28:31], a[172:175], v[124:127], v[28:31]
    ds_read_b128 v[120:123], v1 offset:64512
    v_mfma_f32_16x16x32_bf16 v[32:35], a[172:175], v[128:131], v[32:35]
    buffer_load_dwordx4 a[156:159], v194, s[32:35], s96 offen offset:2048 sc1
    s_waitcnt lgkmcnt(6)
    v_mfma_f32_16x16x32_bf16 v[28:31], a[176:179], v[132:135], v[28:31]
    v_mfma_f32_16x16x32_bf16 v[32:35], a[176:179], v[136:139], v[32:35]
    s_waitcnt lgkmcnt(4)
    v_mfma_f32_16x16x32_bf16 v[28:31], a[180:183], v[140:143], v[28:31]
    v_mfma_f32_16x16x32_bf16 v[32:35], a[180:183], v[144:147], v[32:35]
    s_waitcnt lgkmcnt(2)
    v_mfma_f32_16x16x32_bf16 v[28:31], a[184:187], v[108:111], v[28:31]
    v_mfma_f32_16x16x32_bf16 v[32:35], a[184:187], v[112:115], v[32:35]
    s_waitcnt lgkmcnt(0)
    v_mfma_f32_16x16x32_bf16 v[28:31], a[188:191], v[116:119], v[28:31]
    v_mfma_f32_16x16x32_bf16 v[32:35], a[188:191], v[120:123], v[32:35]
    s_add_u32 s82, s55, s57
    s_add_u32 s82, s82, 0x808000
    s_nop 4
    v_cvt_pk_bf16_f32 v162, v28, v29
    v_cvt_pk_bf16_f32 v163, v30, v31
    v_cvt_pk_bf16_f32 v164, v32, v33
    v_cvt_pk_bf16_f32 v165, v34, v35
    s_nop 0
    v_permlane16_swap_b32 v162, v164
    v_permlane16_swap_b32 v163, v165
    s_cmp_eq_u32 s51, 1
    s_cbranch_scc0 Lslow_27
    buffer_store_dwordx4 v[162:165], v5, s[32:35], s82 offen offset:0
Ljoin_28:
    s_add_u32 s84, s41, 8192
    v_cvt_pk_bf16_f32 v124, v20, v21
    v_cvt_pk_bf16_f32 v125, v22, v23
    v_cvt_pk_bf16_f32 v126, v24, v25
    v_cvt_pk_bf16_f32 v127, v26, v27
    v_cvt_pk_bf16_f32 v128, v28, v29
    v_cvt_pk_bf16_f32 v129, v30, v31
    v_cvt_pk_bf16_f32 v130, v32, v33
    v_cvt_pk_bf16_f32 v131, v34, v35
    v_lshlrev_b32 v132, 16, v124
    v_and_b32 v133, 0xffff0000, v124
    v_lshlrev_b32 v134, 16, v125
    v_and_b32 v135, 0xffff0000, v125
    v_lshlrev_b32 v136, 16, v126
    v_and_b32 v137, 0xffff0000, v126
    v_lshlrev_b32 v138, 16, v127
    v_and_b32 v139, 0xffff0000, v127
    v_lshlrev_b32 v140, 16, v128
    v_and_b32 v141, 0xffff0000, v128
    v_lshlrev_b32 v142, 16, v129
    v_and_b32 v143, 0xffff0000, v129
    v_lshlrev_b32 v144, 16, v130
    v_and_b32 v145, 0xffff0000, v130
    v_lshlrev_b32 v146, 16, v131
    v_and_b32 v147, 0xffff0000, v131
    v_pk_add_f32 v[108:109], v[132:133], v[134:135]
    v_pk_mul_f32 v[110:111], v[132:133], v[132:133]
    v_pk_add_f32 v[112:113], v[136:137], v[138:139]
    v_pk_mul_f32 v[114:115], v[136:137], v[136:137]
    v_pk_add_f32 v[116:117], v[140:141], v[142:143]
    v_pk_mul_f32 v[118:119], v[140:141], v[140:141]
    v_pk_add_f32 v[120:121], v[144:145], v[146:147]
    v_pk_mul_f32 v[122:123], v[144:145], v[144:145]
    v_pk_fma_f32 v[110:111], v[134:135], v[134:135], v[110:111]
    v_pk_fma_f32 v[114:115], v[138:139], v[138:139], v[114:115]
    v_pk_fma_f32 v[118:119], v[142:143], v[142:143], v[118:119]
    v_pk_fma_f32 v[122:123], v[146:147], v[146:147], v[122:123]
    v_add_f32 v108, v108, v109
    v_add_f32 v110, v110, v111
    v_add_f32 v112, v112, v113
    v_add_f32 v114, v114, v115
    v_add_f32 v116, v116, v117
    v_add_f32 v118, v118, v119
    v_add_f32 v120, v120, v121
    v_add_f32 v122, v122, v123
    v_permlane32_swap_b32 v108, v112
    v_permlane32_swap_b32 v110, v114
    v_permlane32_swap_b32 v116, v120
    v_permlane32_swap_b32 v118, v122
    v_add_f32 v108, v108, v112
    v_add_f32 v110, v110, v114
    v_add_f32 v116, v116, v120
    v_add_f32 v118, v118, v122
    v_permlane16_swap_b32 v108, v110
    s_nop 0
    v_permlane16_swap_b32 v116, v118
    v_add_f32 v108, v108, v110
    v_add_f32 v116, v116, v118
    s_cmp_eq_u32 s51, 1
    s_cbranch_scc0 Lslow_29
    buffer_store_dword v108, v15, s[32:35], s41 offen
    buffer_store_dword v116, v15, s[32:35], s84 offen
Ljoin_30:
    s_add_u32 s76, s22, 2
Lpoll_31:
    buffer_load_dword v180, v14, s[32:35], s54 offen sc1
    s_waitcnt vmcnt(0)
Lpc_33:
    v_subrev_u32 v180, s76, v180
    v_cmp_gt_u32 vcc, 14, v180
    s_nop 1
    s_cmp_eq_u64 vcc, exec
    s_cbranch_scc1 Lpd_32
    s_sub_u32 s61, s61, 1
    s_cmp_lg_u32 s61, 0
    s_cbranch_scc1 Lpoll_31
    s_branch L_end
Lpd_32:
    s_add_u32 s76, s22, 3
    v_mov_b32 v19, s76
    s_mov_b64 exec, 1
    s_cmp_eq_u32 s51, 1
    s_cbranch_scc0 Lslow_34
    buffer_store_dword v19, off, s[32:35], s98
Ljoin_35:
    s_mov_b64 exec, -1
    s_add_u32 m0, s99, 0x10000
    s_add_u32 s101, s55, 0x800000
    buffer_load_dwordx4 v181, s[32:35], s101 offen offset:0 sc1 lds
    buffer_load_dwordx4 v181, s[32:35], s101 offen offset:1024 sc1 lds
    s_add_u32 m0, s99, 0x12000
    s_add_u32 s101, s55, 0x802000
    buffer_load_dwordx4 v181, s[32:35], s101 offen offset:0 sc1 lds
    buffer_load_dwordx4 v181, s[32:35], s101 offen offset:1024 sc1 lds
    s_add_u32 m0, s99, 0x0
    s_add_u32 s101, s55, 0x804000
    buffer_load_dwordx4 v181, s[32:35], s101 offen offset:0 sc1 lds
    buffer_load_dwordx4 v181, s[32:35], s101 offen offset:1024 sc1 lds
    s_waitcnt vmcnt(4)
    s_barrier
    ds_read_b128 v[108:111], v2 offset:0
    ds_read_b128 v[112:115], v2 offset:2048
    ds_read_b128 v[116:119], v2 offset:1024
    ds_read_b128 v[120:123], v2 offset:3072
    ds_read_b128 v[124:127], v2 offset:4096
    ds_read_b128 v[128:131], v2 offset:6144
    s_waitcnt lgkmcnt(4)
    v_mfma_f32_16x16x32_bf16 v[60:63], a[192:195], v[108:111], 0
    ds_read_b128 v[132:135], v2 offset:5120
    s_add_u32 m0, s99, 0x2000
    v_mfma_f32_16x16x32_bf16 v[44:47], a[192:195], v[56:59], 0
    s_add_u32 s101, s55, 0x806000
    v_mfma_f32_16x16x32_bf16 v[68:71], a[196:199], v[108:111], 0
    buffer_load_dwordx4 v181, s[32:35], s101 offen offset:0 sc1 lds
    v_mfma_f32_16x16x32_bf16 v[48:51], a[196:199], v[56:59], 0
    v_mfma_f32_16x16x32_bf16 v[76:79], a[200:203], v[108:111], 0
    buffer_load_dwordx4 v181, s[32:35], s101 offen offset:1024 sc1 lds
    v_mfma_f32_16x16x32_bf16 v[52:55], a[200:203], v[56:59], 0
    v_mfma_f32_16x16x32_bf16 v[64:67], a[192:195], v[112:115], 0
    ds_read_b128 v[136:139], v2 offset:7168
    v_mfma_f32_16x16x32_bf16 v[72:75], a[196:199], v[112:115], 0
    v_mfma_f32_16x16x32_bf16 v[80:83], a[200:203], v[112:115], 0
    buffer_load_dword v180, v14, s[32:35], s54 offen sc1
    buffer_load_dwordx4 a[160:163], v192, s[32:35], s96 offen offset:3072 sc1
    s_add_u32 s96, s52, 0xe000
    buffer_load_dwordx4 a[164:167], v193, s[32:35], s96 offen offset:0 sc1
    buffer_load_dwordx4 a[168:171], v194, s[32:35], s96 offen offset:1024 sc1
    buffer_load_dwordx4 a[172:175], v192, s[32:35], s96 offen offset:2048 sc1
    buffer_load_dwordx4 a[176:179], v193, s[32:35], s96 offen offset:3072 sc1
    s_waitcnt lgkmcnt(4)
    v_mfma_f32_16x16x32_bf16 v[60:63], a[204:207], v[116:119], v[60:63]
    s_waitcnt vmcnt(10)
    s_barrier
    ds_read_b128 v[140:143], v2 offset:8192
    v_mfma_f32_16x16x32_bf16 v[44:47], a[204:207], v[56:59], v[44:47]
    v_mfma_f32_16x16x32_bf16 v[68:71], a[208:211], v[116:119], v[68:71]
    v_mfma_f32_16x16x32_bf16 v[48:51], a[208:211], v[56:59], v[48:51]
    v_mfma_f32_16x16x32_bf16 v[76:79], a[212:215], v[116:119], v[76:79]
    v_mfma_f32_16x16x32_bf16 v[52:55], a[212:215], v[56:59], v[52:55]
    v_mfma_f32_16x16x32_bf16 v[64:67], a[204:207], v[120:123], v[64:67]
    ds_read_b128 v[144:147], v2 offset:10240
    v_mfma_f32_16x16x32_bf16 v[72:75], a[208:211], v[120:123], v[72:75]
    v_mfma_f32_16x16x32_bf16 v[80:83], a[212:215], v[120:123], v[80:83]
    s_waitcnt lgkmcnt(4)
    v_mfma_f32_16x16x32_bf16 v[60:63], a[216:219], v[124:127], v[60:63]
    ds_read_b128 v[108:111], v2 offset:9216
    v_mfma_f32_16x16x32_bf16 v[44:47], a[216:219], v[56:59], v[44:47]
    v_mfma_f32_16x16x32_bf16 v[68:71], a[220:223], v[124:127], v[68:71]
    v_mfma_f32_16x16x32_bf16 v[48:51], a[220:223], v[56:59], v[48:51]
    v_mfma_f32_16x16x32_bf16 v[76:79], a[224:227], v[124:127], v[76:79]
    v_mfma_f32_16x16x32_bf16 v[52:55], a[224:227], v[56:59], v[52:55]
    v_mfma_f32_16x16x32_bf16 v[64:67], a[216:219], v[128:131], v[64:67]
    ds_read_b128 v[112:115], v2 offset:11264
    v_mfma_f32_16x16x32_bf16 v[72:75], a[220:223], v[128:131], v[72:75]
    v_mfma_f32_16x16x32_bf16 v[80:83], a[224:227], v[128:131], v[80:83]
    s_waitcnt lgkmcnt(4)
    v_mfma_f32_16x16x32_bf16 v[60:63], a[228:231], v[132:135], v[60:63]
    ds_read_b128 v[116:119], v2 offset:12288
    v_mfma_f32_16x16x32_bf16 v[44:47], a[228:231], v[56:59], v[44:47]
    v_mfma_f32_16x16x32_bf16 v[68:71], a[232:235], v[132:135], v[68:71]
    v_mfma_f32_16x16x32_bf16 v[48:51], a[232:235], v[56:59], v[48:51]
    v_mfma_f32_16x16x32_bf16 v[76:79], a[236:239], v[132:135], v[76:79]
    v_mfma_f32_16x16x32_bf16 v[52:55], a[236:239], v[56:59], v[52:55]
    v_mfma_f32_16x16x32_bf16 v[64:67], a[228:231], v[136:139], v[64:67]
    ds_read_b128 v[120:123], v2 offset:14336
    v_mfma_f32_16x16x32_bf16 v[72:75], a[232:235], v[136:139], v[72:75]
    v_mfma_f32_16x16x32_bf16 v[80:83], a[236:239], v[136:139], v[80:83]
    s_add_u32 s76, s22, 3
    s_waitcnt vmcnt(5)
    s_branch Lpc_38
Lpoll_36:
    buffer_load_dword v180, v14, s[32:35], s54 offen sc1
    s_waitcnt vmcnt(0)
Lpc_38:
    v_subrev_u32 v180, s76, v180
    v_cmp_gt_u32 vcc, 13, v180
    s_nop 1
    s_cmp_eq_u64 vcc, exec
    s_cbranch_scc1 Lpd_37
    s_sub_u32 s61, s61, 1
    s_cmp_lg_u32 s61, 0
    s_cbranch_scc1 Lpoll_36
    s_branch L_end
Lpd_37:
    s_add_u32 m0, s99, 0x4000
    s_add_u32 s101, s55, 0x808000
    buffer_load_dwordx4 v181, s[32:35], s101 offen offset:0 sc1 lds
    buffer_load_dwordx4 v181, s[32:35], s101 offen offset:1024 sc1 lds
    s_add_u32 m0, s99, 0x6000
    s_add_u32 s101, s55, 0x80a000
    buffer_load_dwordx4 v181, s[32:35], s101 offen offset:0 sc1 lds
    buffer_load_dwordx4 v181, s[32:35], s101 offen offset:1024 sc1 lds
    s_waitcnt lgkmcnt(4)
    v_mfma_f32_16x16x32_bf16 v[60:63], a[240:243], v[140:143], v[60:63]
    ds_read_b128 v[124:127], v2 offset:13312
    s_add_u32 m0, s99, 0x8000
    v_mfma_f32_16x16x32_bf16 v[44:47], a[240:243], v[56:59], v[44:47]
    s_add_u32 s101, s55, 0x80c000
    v_mfma_f32_16x16x32_bf16 v[68:71], a[244:247], v[140:143], v[68:71]
    buffer_load_dwordx4 v181, s[32:35], s101 offen offset:0 sc1 lds
    v_mfma_f32_16x16x32_bf16 v[48:51], a[244:247], v[56:59], v[48:51]
    v_mfma_f32_16x16x32_bf16 v[76:79], a[248:251], v[140:143], v[76:79]
    buffer_load_dwordx4 v181, s[32:35], s101 offen offset:1024 sc1 lds
    v_mfma_f32_16x16x32_bf16 v[52:55], a[248:251], v[56:59], v[52:55]
    s_add_u32 m0, s99, 0xa000
    s_add_u32 s101, s55, 0x80e000
    v_mfma_f32_16x16x32_bf16 v[64:67], a[240:243], v[144:147], v[64:67]
    buffer_load_dwordx4 v181, s[32:35], s101 offen offset:0 sc1 lds
    v_mfma_f32_16x16x32_bf16 v[72:75], a[244:247], v[144:147], v[72:75]
    ds_read_b128 v[128:131], v2 offset:15360
    v_mfma_f32_16x16x32_bf16 v[80:83], a[248:251], v[144:147], v[80:83]
    buffer_load_dwordx4 v181, s[32:35], s101 offen offset:1024 sc1 lds
    s_waitcnt lgkmcnt(4)
    v_mfma_f32_16x16x32_bf16 v[60:63], a[252:255], v[108:111], v[60:63]
    s_waitcnt vmcnt(6)
    s_barrier
    ds_read_b128 v[132:135], v1 offset:16384
    s_add_u32 m0, s99, 0xc000
    v_mfma_f32_16x16x32_bf16 v[44:47], a[252:255], v[56:59], v[44:47]
    s_add_u32 s101, s42, 0x0
    v_mfma_f32_16x16x32_bf16 v[68:71], v[196:199], v[108:111], v[68:71]
    buffer_load_dwordx4 v1, s[32:35], s101 offen offset:0 sc1 lds
    v_mfma_f32_16x16x32_bf16 v[48:51], v[196:199], v[56:59], v[48:51]
    buffer_load_dwordx4 v1, s[32:35], s101 offen offset:1024 sc1 lds
    v_mfma_f32_16x16x32_bf16 v[76:79], v[200:203], v[108:111], v[76:79]
    s_add_u32 m0, s99, 0xe000
    s_add_u32 s101, s42, 0x2000
    v_mfma_f32_16x16x32_bf16 v[52:55], v[200:203], v[56:59], v[52:55]
    buffer_load_dwordx4 v1, s[32:35], s101 offen offset:0 sc1 lds
    v_mfma_f32_16x16x32_bf16 v[64:67], a[252:255], v[112:115], v[64:67]
    buffer_load_dwordx4 v1, s[32:35], s101 offen offset:1024 sc1 lds
    v_mfma_f32_16x16x32_bf16 v[72:75], v[196:199], v[112:115], v[72:75]
    s_lshr_b32 s77, s50, 1
    s_mul_i32 s77, s77, 77824
    s_mul_i32 s78, s50, 6144
    s_add_u32 s77, s77, s78
    s_mul_i32 s78, s49, 12288
    s_add_u32 s77, s77, s78
    s_add_u32 s77, s77, s56
    s_add_u32 s77, s77, 0xa00000
    s_cmp_lt_u32 s49, 7
    s_cselect_b32 s77, s77, 0x1000000
    s_mov_b32 exec_hi, 0xffff
    buffer_load_dword v178, v179, s[32:35], s77 offen sc1
    s_mov_b32 exec_hi, -1
    v_mfma_f32_16x16x32_bf16 v[80:83], v[200:203], v[112:115], v[80:83]
    ds_read_b128 v[136:139], v1 offset:18432
    s_add_u32 s96, s52, 0xf000
    s_waitcnt lgkmcnt(4)
    v_mfma_f32_16x16x32_bf16 v[60:63], v[204:207], v[116:119], v[60:63]
    ds_read_b128 v[140:143], v1 offset:17408
    v_mfma_f32_16x16x32_bf16 v[44:47], v[204:207], v[56:59], v[44:47]
    v_mfma_f32_16x16x32_bf16 v[68:71], v[208:211], v[116:119], v[68:71]
    buffer_load_dwordx4 a[180:183], v194, s[32:35], s96 offen offset:0 sc1
    v_mfma_f32_16x16x32_bf16 v[48:51], v[208:211], v[56:59], v[48:51]
    v_mfma_f32_16x16x32_bf16 v[76:79], v[212:215], v[116:119], v[76:79]
    v_mfma_f32_16x16x32_bf16 v[52:55], v[212:215], v[56:59], v[52:55]
    v_mfma_f32_16x16x32_bf16 v[64:67], v[204:207], v[120:123], v[64:67]
    buffer_load_dwordx4 a[184:187], v192, s[32:35], s96 offen offset:1024 sc1
    v_mfma_f32_16x16x32_bf16 v[72:75], v[208:211], v[120:123], v[72:75]
    ds_read_b128 v[144:147], v1 offset:19456
    v_mfma_f32_16x16x32_bf16 v[80:83], v[212:215], v[120:123], v[80:83]
    s_waitcnt lgkmcnt(4)
    v_mfma_f32_16x16x32_bf16 v[60:63], v[216:219], v[124:127], v[60:63]
    ds_read_b128 v[108:111], v1 offset:20480
    v_mfma_f32_16x16x32_bf16 v[44:47], v[216:219], v[56:59], v[44:47]
    buffer_load_dwordx4 a[188:191], v193, s[32:35], s96 offen offset:2048 sc1
    v_mfma_f32_16x16x32_bf16 v[68:71], v[220:223], v[124:127], v[68:71]
    v_mfma_f32_16x16x32_bf16 v[48:51], v[220:223], v[56:59], v[48:51]
    v_mfma_f32_16x16x32_bf16 v[76:79], v[224:227], v[124:127], v[76:79]
    v_mfma_f32_16x16x32_bf16 v[52:55], v[224:227], v[56:59], v[52:55]
    v_mfma_f32_16x16x32_bf16 v[64:67], v[216:219], v[128:131], v[64:67]
    ds_read_b128 v[112:115], v1 offset:22528
    v_mfma_f32_16x16x32_bf16 v[72:75], v[220:223], v[128:131], v[72:75]
    v_mfma_f32_16x16x32_bf16 v[80:83], v[224:227], v[128:131], v[80:83]
    s_waitcnt lgkmcnt(4)
    v_mfma_f32_16x16x32_bf16 v[84:87], a[192:195], v[132:135], 0
    ds_read_b128 v[116:119], v1 offset:21504
    v_mfma_f32_16x16x32_bf16 v[92:95], a[196:199], v[132:135], 0
    v_mfma_f32_16x16x32_bf16 v[100:103], a[200:203], v[132:135], 0
    v_mfma_f32_16x16x32_bf16 v[88:91], a[192:195], v[136:139], 0
    ds_read_b128 v[120:123], v1 offset:23552
    v_mfma_f32_16x16x32_bf16 v[96:99], a[196:199], v[136:139], 0
    v_mfma_f32_16x16x32_bf16 v[104:107], a[200:203], v[136:139], 0
    s_waitcnt lgkmcnt(4)
    v_mfma_f32_16x16x32_bf16 v[84:87], a[204:207], v[140:143], v[84:87]
    buffer_load_dwordx4 a[192:195], v194, s[32:35], s96 offen offset:3072 sc1
    v_mfma_f32_16x16x32_bf16 v[92:95], a[208:211], v[140:143], v[92:95]
    s_waitcnt vmcnt(13)
    s_barrier
    ds_read_b128 v[124:127], v1 offset:24576
    s_add_u32 s96, s52, 0x10000
    v_mfma_f32_16x16x32_bf16 v[100:103], a[212:215], v[140:143], v[100:103]
    v_mfma_f32_16x16x32_bf16 v[88:91], a[204:207], v[144:147], v[88:91]
    ds_read_b128 v[128:131], v1 offset:26624
    v_mfma_f32_16x16x32_bf16 v[96:99], a[208:211], v[144:147], v[96:99]
    buffer_load_dwordx4 a[196:199], v1, s[32:35], s96 offen offset:0 sc1
    v_mfma_f32_16x16x32_bf16 v[104:107], a[212:215], v[144:147], v[104:107]
    s_waitcnt lgkmcnt(4)
    v_mfma_f32_16x16x32_bf16 v[84:87], a[216:219], v[108:111], v[84:87]
    ds_read_b128 v[132:135], v1 offset:25600
    v_mfma_f32_16x16x32_bf16 v[92:95], a[220:223], v[108:111], v[92:95]
    v_mfma_f32_16x16x32_bf16 v[100:103], a[224:227], v[108:111], v[100:103]
    buffer_load_dwordx4 a[200:203], v1, s[32:35], s96 offen offset:1024 sc1
    v_mfma_f32_16x16x32_bf16 v[88:91], a[216:219], v[112:115], v[88:91]
    ds_read_b128 v[136:139], v1 offset:27648
    v_mfma_f32_16x16x32_bf16 v[96:99], a[220:223], v[112:115], v[96:99]
    v_mfma_f32_16x16x32_bf16 v[104:107], a[224:227], v[112:115], v[104:107]
    s_waitcnt lgkmcnt(4)
    v_mfma_f32_16x16x32_bf16 v[84:87], a[228:231], v[116:119], v[84:87]
    buffer_load_dwordx4 a[204:207], v1, s[32:35], s96 offen offset:2048 sc1
    v_mfma_f32_16x16x32_bf16 v[92:95], a[232:235], v[116:119], v[92:95]
    ds_read_b128 v[140:143], v1 offset:28672
    v_mfma_f32_16x16x32_bf16 v[100:103], a[236:239], v[116:119], v[100:103]
    v_mfma_f32_16x16x32_bf16 v[88:91], a[228:231], v[120:123], v[88:91]
    ds_read_b128 v[144:147], v1 offset:30720
    v_mfma_f32_16x16x32_bf16 v[96:99], a[232:235], v[120:123], v[96:99]
    buffer_load_dwordx4 a[208:211], v1, s[32:35], s96 offen offset:3072 sc1
    v_mfma_f32_16x16x32_bf16 v[104:107], a[236:239], v[120:123], v[104:107]
    s_add_u32 s96, s52, 0x11000
    s_waitcnt lgkmcnt(4)
    v_mfma_f32_16x16x32_bf16 v[84:87], a[240:243], v[124:127], v[84:87]
    ds_read_b128 v[108:111], v1 offset:29696
    v_mfma_f32_16x16x32_bf16 v[92:95], a[244:247], v[124:127], v[92:95]
    v_mfma_f32_16x16x32_bf16 v[100:103], a[248:251], v[124:127], v[100:103]
    buffer_load_dwordx4 a[212:215], v1, s[32:35], s96 offen offset:0 sc1
    v_mfma_f32_16x16x32_bf16 v[88:91], a[240:243], v[128:131], v[88:91]
    ds_read_b128 v[112:115], v1 offset:31744
    v_mfma_f32_16x16x32_bf16 v[96:99], a[244:247], v[128:131], v[96:99]
    v_mfma_f32_16x16x32_bf16 v[104:107], a[248:251], v[128:131], v[104:107]
    s_waitcnt lgkmcnt(4)
    v_mfma_f32_16x16x32_bf16 v[84:87], a[252:255], v[132:135], v[84:87]
    buffer_load_dwordx4 a[216:219], v1, s[32:35], s96 offen offset:1024 sc1
    v_mfma_f32_16x16x32_bf16 v[92:95], v[196:199], v[132:135], v[92:95]
    s_waitcnt vmcnt(15)
    s_barrier
    ds_read_b128 v[116:119], v1 offset:0
    v_mfma_f32_16x16x32_bf16 v[100:103], v[200:203], v[132:135], v[100:103]
    v_mfma_f32_16x16x32_bf16 v[88:91], a[252:255], v[136:139], v[88:91]
    ds_read_b128 v[120:123], v1 offset:2048
    v_mfma_f32_16x16x32_bf16 v[96:99], v[196:199], v[136:139], v[96:99]
    buffer_load_dwordx4 a[220:223], v1, s[32:35], s96 offen offset:2048 sc1
    v_mfma_f32_16x16x32_bf16 v[104:107], v[200:203], v[136:139], v[104:107]
    s_waitcnt lgkmcnt(4)
    v_mfma_f32_16x16x32_bf16 v[84:87], v[204:207], v[140:143], v[84:87]
    ds_read_b128 v[124:127], v1 offset:32768
    v_mfma_f32_16x16x32_bf16 v[92:95], v[208:211], v[140:143], v[92:95]
    v_mfma_f32_16x16x32_bf16 v[100:103], v[212:215], v[140:143], v[100:103]
    buffer_load_dwordx4 a[224:227], v1, s[32:35], s96 offen offset:3072 sc1
    v_mfma_f32_16x16x32_bf16 v[88:91], v[204:207], v[144:147], v[88:91]
    ds_read_b128 v[128:131], v1 offset:34816
    s_add_u32 s96, s52, 0x12000
    v_add_u32 v156, 0xc000, v8
    v_mfma_f32_16x16x32_bf16 v[96:99], v[208:211], v[144:147], v[96:99]
    s_waitcnt vmcnt(15)
    ds_read2st64_b32 v[184:185], v156 offset0:0 offset1:1
    v_mfma_f32_16x16x32_bf16 v[104:107], v[212:215], v[144:147], v[104:107]
    ds_read2st64_b32 v[186:187], v156 offset0:2 offset1:3
    ds_read2st64_b32 v[188:189], v156 offset0:4 offset1:5
    s_waitcnt lgkmcnt(7)
    v_mfma_f32_16x16x32_bf16 v[84:87], v[216:219], v[108:111], v[84:87]
    buffer_load_dwordx4 a[228:231], v1, s[32:35], s96 offen offset:0 sc1
    v_mfma_f32_16x16x32_bf16 v[92:95], v[220:223], v[108:111], v[92:95]
    ds_read_b128 v[132:135], v1 offset:1024
    ds_read2st64_b32 v[190:191], v156 offset0:6 offset1:7
    v_mfma_f32_16x16x32_bf16 v[100:103], v[224:227], v[108:111], v[100:103]
    v_mfma_f32_16x16x32_bf16 v[88:91], v[216:219], v[112:115], v[88:91]
    ds_read_b128 v[136:139], v1 offset:3072
    v_mfma_f32_16x16x32_bf16 v[96:99], v[220:223], v[112:115], v[96:99]
    buffer_load_dwordx4 a[232:235], v1, s[32:35], s96 offen offset:1024 sc1
    v_mfma_f32_16x16x32_bf16 v[104:107], v[224:227], v[112:115], v[104:107]
    s_waitcnt lgkmcnt(8)
    v_mfma_f32_16x16x32_bf16 v[60:63], v[228:231], v[116:119], v[60:63]
    ds_read_b128 v[140:143], v1 offset:33792
    v_mfma_f32_16x16x32_bf16 v[44:47], v[228:231], v[56:59], v[44:47]
    v_mfma_f32_16x16x32_bf16 v[68:71], v[252:255], v[116:119], v[68:71]
    buffer_load_dwordx4 a[236:239], v1, s[32:35], s96 offen offset:2048 sc1
    v_mfma_f32_16x16x32_bf16 v[48:51], v[252:255], v[56:59], v[48:51]
    v_mfma_f32_16x16x32_bf16 v[76:79], v[248:251], v[116:119], v[76:79]
    s_waitcnt lgkmcnt(2)
    v_add_f32 v184, v184, v188
    v_mfma_f32_16x16x32_bf16 v[52:55], v[248:251], v[56:59], v[52:55]
    v_add_f32 v185, v185, v189
    v_add_f32 v186, v186, v190
    v_mfma_f32_16x16x32_bf16 v[64:67], v[228:231], v[120:123], v[64:67]
    buffer_load_dwordx4 a[240:243], v1, s[32:35], s96 offen offset:3072 sc1
    v_mfma_f32_16x16x32_bf16 v[72:75], v[252:255], v[120:123], v[72:75]
    ds_read_b128 v[144:147], v1 offset:35840
    s_add_u32 s96, s52, 0x13000
    v_add_f32 v187, v187, v191
    v_mfma_f32_16x16x32_bf16 v[80:83], v[248:251], v[120:123], v[80:83]
    v_add_f32 v184, v184, v186
    v_add_f32 v185, v185, v187
    v_mfma_f32_16x16x32_bf16 v[84:87], v[228:231], v[124:127], v[84:87]
    ds_read_b128 v[108:111], v1 offset:4096
    v_add_f32 v184, v184, v185
    v_mfma_f32_16x16x32_bf16 v[92:95], v[252:255], v[124:127], v[92:95]
    buffer_load_dwordx4 a[244:247], v1, s[32:35], s96 offen offset:0 sc1
    v_mfma_f32_16x16x32_bf16 v[100:103], v[248:251], v[124:127], v[100:103]
    ds_write_b32 v177, v184 offset:0
    v_add_u32 v156, 0xe000, v8
    v_mfma_f32_16x16x32_bf16 v[88:91], v[228:231], v[128:131], v[88:91]
    ds_read_b128 v[112:115], v1 offset:6144
    s_waitcnt vmcnt(18)
    v_mfma_f32_16x16x32_bf16 v[96:99], v[252:255], v[128:131], v[96:99]
    ds_read2st64_b32 v[184:185], v156 offset0:0 offset1:1
    ds_read2st64_b32 v[186:187], v156 offset0:2 offset1:3
    v_mfma_f32_16x16x32_bf16 v[104:107], v[248:251], v[128:131], v[104:107]
    buffer_load_dwordx4 a[248:251], v1, s[32:35], s96 offen offset:1024 sc1
    s_waitcnt lgkmcnt(7)
    v_mfma_f32_16x16x32_bf16 v[60:63], v[244:247], v[132:135], v[60:63]
    ds_read_b128 v[116:119], v1 offset:36864
    ds_read2st64_b32 v[188:189], v156 offset0:4 offset1:5
    v_mfma_f32_16x16x32_bf16 v[44:47], v[244:247], v[56:59], v[44:47]
    ds_read2st64_b32 v[190:191], v156 offset0:6 offset1:7
    v_mfma_f32_16x16x32_bf16 v[68:71], v[240:243], v[132:135], v[68:71]
    v_mfma_f32_16x16x32_bf16 v[48:51], v[240:243], v[56:59], v[48:51]
    buffer_load_dwordx4 a[252:255], v1, s[32:35], s96 offen offset:2048 sc1
    v_mfma_f32_16x16x32_bf16 v[76:79], v[236:239], v[132:135], v[76:79]
    v_mfma_f32_16x16x32_bf16 v[52:55], v[236:239], v[56:59], v[52:55]
    v_mfma_f32_16x16x32_bf16 v[64:67], v[244:247], v[136:139], v[64:67]
    ds_read_b128 v[120:123], v1 offset:38912
    v_mfma_f32_16x16x32_bf16 v[72:75], v[240:243], v[136:139], v[72:75]
    buffer_load_dwordx4 v[196:199], v1, s[32:35], s96 offen offset:3072 sc1
    v_mfma_f32_16x16x32_bf16 v[80:83], v[236:239], v[136:139], v[80:83]
    s_add_u32 s96, s52, 0x14000
    s_waitcnt lgkmcnt(9)
    v_mfma_f32_16x16x32_bf16 v[84:87], v[244:247], v[140:143], v[84:87]
    ds_read_b128 v[124:127], v1 offset:5120
    s_waitcnt lgkmcnt(2)
    v_mfma_f32_16x16x32_bf16 v[92:95], v[240:243], v[140:143], v[92:95]
    v_add_f32 v184, v184, v188
    v_add_f32 v185, v185, v189
    v_mfma_f32_16x16x32_bf16 v[100:103], v[236:239], v[140:143], v[100:103]
    buffer_load_dwordx4 v[200:203], v1, s[32:35], s96 offen offset:0 sc1
    v_mfma_f32_16x16x32_bf16 v[88:91], v[244:247], v[144:147], v[88:91]
    ds_read_b128 v[128:131], v1 offset:7168
    v_add_f32 v186, v186, v190
    v_mfma_f32_16x16x32_bf16 v[96:99], v[240:243], v[144:147], v[96:99]
    v_add_f32 v187, v187, v191
    v_add_f32 v184, v184, v186
    v_mfma_f32_16x16x32_bf16 v[104:107], v[236:239], v[144:147], v[104:107]
    v_add_f32 v185, v185, v187
    v_add_f32 v184, v184, v185
    v_mfma_f32_16x16x32_bf16 v[60:63], v[232:235], v[108:111], v[60:63]
    buffer_load_dwordx4 v[204:207], v1, s[32:35], s96 offen offset:1024 sc1
    v_mfma_f32_16x16x32_bf16 v[44:47], v[232:235], v[56:59], v[44:47]
    ds_read_b128 v[132:135], v1 offset:37888
    ds_write_b32 v177, v184 offset:1024
    v_mfma_f32_16x16x32_bf16 v[68:71], a[128:131], v[108:111], v[68:71]
    v_mfma_f32_16x16x32_bf16 v[48:51], a[128:131], v[56:59], v[48:51]
    v_mfma_f32_16x16x32_bf16 v[76:79], a[132:135], v[108:111], v[76:79]
    buffer_load_dwordx4 v[208:211], v1, s[32:35], s96 offen offset:2048 sc1
    v_mfma_f32_16x16x32_bf16 v[52:55], a[132:135], v[56:59], v[52:55]
    v_mfma_f32_16x16x32_bf16 v[64:67], v[232:235], v[112:115], v[64:67]
    ds_read_b128 v[136:139], v1 offset:39936
    v_mfma_f32_16x16x32_bf16 v[72:75], a[128:131], v[112:115], v[72:75]
    v_mfma_f32_16x16x32_bf16 v[80:83], a[132:135], v[112:115], v[80:83]
    buffer_load_dwordx4 v[212:215], v1, s[32:35], s96 offen offset:3072 sc1
    s_waitcnt lgkmcnt(5)
    v_mfma_f32_16x16x32_bf16 v[84:87], v[232:235], v[116:119], v[84:87]
    ds_read_b128 v[140:143], v1 offset:8192
    s_add_u32 s96, s52, 0x15000
    v_mfma_f32_16x16x32_bf16 v[92:95], a[128:131], v[116:119], v[92:95]
    v_mfma_f32_16x16x32_bf16 v[100:103], a[132:135], v[116:119], v[100:103]
    v_mfma_f32_16x16x32_bf16 v[88:91], v[232:235], v[120:123], v[88:91]
    buffer_load_dwordx4 v[216:219], v1, s[32:35], s96 offen offset:0 sc1
    v_mfma_f32_16x16x32_bf16 v[96:99], a[128:131], v[120:123], v[96:99]
    ds_read_b128 v[144:147], v1 offset:10240
    v_mfma_f32_16x16x32_bf16 v[104:107], a[132:135], v[120:123], v[104:107]
    s_waitcnt lgkmcnt(5)
    v_mfma_f32_16x16x32_bf16 v[60:63], a[136:139], v[124:127], v[60:63]
    ds_read_b128 v[108:111], v1 offset:40960
    v_mfma_f32_16x16x32_bf16 v[44:47], a[136:139], v[56:59], v[44:47]
    buffer_load_dwordx4 v[220:223], v1, s[32:35], s96 offen offset:1024 sc1
    v_mfma_f32_16x16x32_bf16 v[68:71], a[140:143], v[124:127], v[68:71]
    v_mfma_f32_16x16x32_bf16 v[48:51], a[140:143], v[56:59], v[48:51]
    v_mfma_f32_16x16x32_bf16 v[76:79], a[144:147], v[124:127], v[76:79]
    v_mfma_f32_16x16x32_bf16 v[52:55], a[144:147], v[56:59], v[52:55]
    buffer_load_dwordx4 v[224:227], v1, s[32:35], s96 offen offset:2048 sc1
    v_mfma_f32_16x16x32_bf16 v[64:67], a[136:139], v[128:131], v[64:67]
    ds_read_b128 v[112:115], v1 offset:43008
    v_mfma_f32_16x16x32_bf16 v[72:75], a[140:143], v[128:131], v[72:75]
    v_mfma_f32_16x16x32_bf16 v[80:83], a[144:147], v[128:131], v[80:83]
    s_waitcnt lgkmcnt(4)
    v_mfma_f32_16x16x32_bf16 v[84:87], a[136:139], v[132:135], v[84:87]
    buffer_load_dwordx4 v[228:231], v1, s[32:35], s96 offen offset:3072 sc1
    v_mfma_f32_16x16x32_bf16 v[92:95], a[140:143], v[132:135], v[92:95]
    ds_read_b128 v[116:119], v1 offset:9216
    s_add_u32 s96, s52, 0x16000
    v_mfma_f32_16x16x32_bf16 v[100:103], a[144:147], v[132:135], v[100:103]
    v_mfma_f32_16x16x32_bf16 v[88:91], a[136:139], v[136:139], v[88:91]
    ds_read_b128 v[120:123], v1 offset:11264
    v_mfma_f32_16x16x32_bf16 v[96:99], a[140:143], v[136:139], v[96:99]
    buffer_load_dwordx4 v[252:255], v1, s[32:35], s96 offen offset:0 sc1
    v_mfma_f32_16x16x32_bf16 v[104:107], a[144:147], v[136:139], v[104:107]
    s_waitcnt lgkmcnt(4)
    v_mfma_f32_16x16x32_bf16 v[60:63], a[148:151], v[140:143], v[60:63]
    ds_read_b128 v[124:127], v1 offset:41984
    v_mfma_f32_16x16x32_bf16 v[44:47], a[148:151], v[56:59], v[44:47]
    v_mfma_f32_16x16x32_bf16 v[68:71], a[152:155], v[140:143], v[68:71]
    buffer_load_dwordx4 v[248:251], v1, s[32:35], s96 offen offset:1024 sc1
    v_mfma_f32_16x16x32_bf16 v[48:51], a[152:155], v[56:59], v[48:51]
    v_mfma_f32_16x16x32_bf16 v[76:79], a[156:159], v[140:143], v[76:79]
    v_mfma_f32_16x16x32_bf16 v[52:55], a[156:159], v[56:59], v[52:55]
    s_barrier
    v_mfma_f32_16x16x32_bf16 v[64:67], a[148:151], v[144:147], v[64:67]
    buffer_load_dwordx4 v[244:247], v1, s[32:35], s96 offen offset:2048 sc1
    v_mfma_f32_16x16x32_bf16 v[72:75], a[152:155], v[144:147], v[72:75]
    ds_read_b128 v[128:131], v1 offset:44032
    ds_read2st64_b32 v[184:185], v9 offset0:0 offset1:1
    v_mfma_f32_16x16x32_bf16 v[80:83], a[156:159], v[144:147], v[80:83]
    ds_read2st64_b32 v[186:187], v9 offset0:2 offset1:3
    s_waitcnt lgkmcnt(6)
    v_mfma_f32_16x16x32_bf16 v[84:87], a[148:151], v[108:111], v[84:87]
    ds_read_b128 v[132:135], v1 offset:12288
    v_mfma_f32_16x16x32_bf16 v[92:95], a[152:155], v[108:111], v[92:95]
    buffer_load_dwordx4 v[240:243], v1, s[32:35], s96 offen offset:3072 sc1
    v_mfma_f32_16x16x32_bf16 v[100:103], a[156:159], v[108:111], v[100:103]
    s_add_u32 s96, s52, 0x17000
    v_mfma_f32_16x16x32_bf16 v[88:91], a[148:151], v[112:115], v[88:91]
    ds_read_b128 v[136:139], v1 offset:14336
    v_mfma_f32_16x16x32_bf16 v[96:99], a[152:155], v[112:115], v[96:99]
    v_mfma_f32_16x16x32_bf16 v[104:107], a[156:159], v[112:115], v[104:107]
    buffer_load_dwordx4 v[236:239], v1, s[32:35], s96 offen offset:0 sc1
    s_waitcnt lgkmcnt(6)
    v_mfma_f32_16x16x32_bf16 v[60:63], a[160:163], v[116:119], v[60:63]
    ds_read_b128 v[140:143], v1 offset:45056
    v_mfma_f32_16x16x32_bf16 v[44:47], a[160:163], v[56:59], v[44:47]
    s_waitcnt lgkmcnt(3)
    v_add_f32 v184, v184, v186
    v_mfma_f32_16x16x32_bf16 v[68:71], a[164:167], v[116:119], v[68:71]
    v_add_f32 v185, v185, v187
    v_add_f32 v184, v184, v185
    v_mfma_f32_16x16x32_bf16 v[48:51], a[164:167], v[56:59], v[48:51]
    buffer_load_dwordx4 v[232:235], v1, s[32:35], s96 offen offset:1024 sc1
    v_mfma_f32_16x16x32_bf16 v[76:79], a[168:171], v[116:119], v[76:79]
    v_mul_f32 v184, 0x3b000000, v184
    v_mov_b32 v185, v184
    v_mfma_f32_16x16x32_bf16 v[52:55], a[168:171], v[56:59], v[52:55]
    v_mfma_f32_16x16x32_bf16 v[64:67], a[160:163], v[120:123], v[64:67]
    ds_read_b128 v[144:147], v1 offset:47104
    v_permlane16_swap_b32 v184, v185
    v_mfma_f32_16x16x32_bf16 v[72:75], a[164:167], v[120:123], v[72:75]
    buffer_load_dwordx4 a[128:131], v1, s[32:35], s96 offen offset:2048 sc1
    v_mfma_f32_16x16x32_bf16 v[80:83], a[168:171], v[120:123], v[80:83]
    v_mfma_f32_16x16x32_bf16 v[84:87], a[160:163], v[124:127], v[84:87]
    ds_read_b128 v[108:111], v1 offset:13312
    v_fma_f32 v185, -v184, v184, v185
    v_mfma_f32_16x16x32_bf16 v[92:95], a[164:167], v[124:127], v[92:95]
    v_max_f32 v185, 0, v185
    v_add_f32 v185, 0x3727c5ac, v185
    v_mfma_f32_16x16x32_bf16 v[100:103], a[168:171], v[124:127], v[100:103]
    buffer_load_dwordx4 a[132:135], v1, s[32:35], s96 offen offset:3072 sc1
    v_mfma_f32_16x16x32_bf16 v[88:91], a[160:163], v[128:131], v[88:91]
    ds_read_b128 v[112:115], v1 offset:15360
    s_add_u32 s96, s52, 0x18000
    v_rsq_f32 v148, v185
    v_mfma_f32_16x16x32_bf16 v[96:99], a[164:167], v[128:131], v[96:99]
    v_mfma_f32_16x16x32_bf16 v[104:107], a[168:171], v[128:131], v[104:107]
    v_mul_f32_e64 v148, -v148, v182
    v_mul_f32_e64 v149, -v184, v148
    s_waitcnt vmcnt(35)
    s_waitcnt lgkmcnt(4)
    v_mfma_f32_16x16x32_bf16 v[60:63], a[172:175], v[132:135], v[60:63]
    buffer_load_dwordx4 a[136:139], v1, s[32:35], s96 offen offset:0 sc1
    v_mfma_f32_16x16x32_bf16 v[44:47], a[172:175], v[56:59], v[44:47]
    ds_read_b128 v[116:119], v1 offset:46080
    v_mov_b32 v150, v148
    v_mfma_f32_16x16x32_bf16 v[68:71], a[176:179], v[132:135], v[68:71]
    v_mov_b32 v151, v149
    v_mfma_f32_16x16x32_bf16 v[48:51], a[176:179], v[56:59], v[48:51]
    v_permlane32_swap_b32 v148, v150
    v_permlane32_swap_b32 v149, v151
    v_mfma_f32_16x16x32_bf16 v[76:79], a[180:183], v[132:135], v[76:79]
    buffer_load_dwordx4 a[140:143], v1, s[32:35], s96 offen offset:1024 sc1
    v_mfma_f32_16x16x32_bf16 v[52:55], a[180:183], v[56:59], v[52:55]
    ds_read2st64_b32 v[184:185], v9 offset0:4 offset1:5
    ds_read2st64_b32 v[186:187], v9 offset0:6 offset1:7
    v_mfma_f32_16x16x32_bf16 v[64:67], a[172:175], v[136:139], v[64:67]
    ds_read_b128 v[120:123], v1 offset:48128
    v_mfma_f32_16x16x32_bf16 v[72:75], a[176:179], v[136:139], v[72:75]
    v_mfma_f32_16x16x32_bf16 v[80:83], a[180:183], v[136:139], v[80:83]
    buffer_load_dwordx4 a[144:147], v1, s[32:35], s96 offen offset:2048 sc1
    s_waitcnt lgkmcnt(6)
    v_mfma_f32_16x16x32_bf16 v[84:87], a[172:175], v[140:143], v[84:87]
    v_mfma_f32_16x16x32_bf16 v[92:95], a[176:179], v[140:143], v[92:95]
    v_mfma_f32_16x16x32_bf16 v[100:103], a[180:183], v[140:143], v[100:103]
    v_mfma_f32_16x16x32_bf16 v[88:91], a[172:175], v[144:147], v[88:91]
    buffer_load_dwordx4 a[148:151], v1, s[32:35], s96 offen offset:3072 sc1
    v_mfma_f32_16x16x32_bf16 v[96:99], a[176:179], v[144:147], v[96:99]
    s_add_u32 s96, s52, 0x19000
    v_mfma_f32_16x16x32_bf16 v[104:107], a[180:183], v[144:147], v[104:107]
    s_waitcnt lgkmcnt(1)
    v_add_f32 v184, v184, v186
    s_waitcnt vmcnt(38)
    s_waitcnt vmcnt(37)
    s_waitcnt vmcnt(36)
    v_mfma_f32_16x16x32_bf16 v[60:63], a[184:187], v[108:111], v[60:63]
    v_add_f32 v185, v185, v187
    v_add_f32 v184, v184, v185
    v_mfma_f32_16x16x32_bf16 v[44:47], a[184:187], v[56:59], v[44:47]
    buffer_load_dwordx4 a[152:155], v1, s[32:35], s96 offen offset:0 sc1
    v_mfma_f32_16x16x32_bf16 v[68:71], a[188:191], v[108:111], v[68:71]
    v_mul_f32 v184, 0x3b000000, v184
    v_mov_b32 v185, v184
    v_mfma_f32_16x16x32_bf16 v[48:51], a[188:191], v[56:59], v[48:51]
    v_mfma_f32_16x16x32_bf16 v[76:79], a[192:195], v[108:111], v[76:79]
    v_permlane16_swap_b32 v184, v185
    v_mfma_f32_16x16x32_bf16 v[52:55], a[192:195], v[56:59], v[52:55]
    buffer_load_dwordx4 a[156:159], v1, s[32:35], s96 offen offset:1024 sc1
    v_mfma_f32_16x16x32_bf16 v[64:67], a[184:187], v[112:115], v[64:67]
    v_fma_f32 v185, -v184, v184, v185
    v_max_f32 v185, 0, v185
    v_mfma_f32_16x16x32_bf16 v[72:75], a[188:191], v[112:115], v[72:75]
    v_add_f32 v185, 0x3727c5ac, v185
    v_rsq_f32 v152, v185
    v_mfma_f32_16x16x32_bf16 v[80:83], a[192:195], v[112:115], v[80:83]
    s_waitcnt lgkmcnt(0)
    v_mfma_f32_16x16x32_bf16 v[84:87], a[184:187], v[116:119], v[84:87]
    buffer_load_dwordx4 a[160:163], v1, s[32:35], s96 offen offset:2048 sc1
    v_mfma_f32_16x16x32_bf16 v[92:95], a[188:191], v[116:119], v[92:95]
    v_mul_f32_e64 v152, -v152, v182
    v_mul_f32_e64 v153, -v184, v152
    v_mfma_f32_16x16x32_bf16 v[100:103], a[192:195], v[116:119], v[100:103]
    v_mov_b32 v154, v152
    v_mov_b32 v155, v153
    v_mfma_f32_16x16x32_bf16 v[88:91], a[184:187], v[120:123], v[88:91]
    v_mfma_f32_16x16x32_bf16 v[96:99], a[188:191], v[120:123], v[96:99]
    buffer_load_dwordx4 a[164:167], v1, s[32:35], s96 offen offset:3072 sc1
    v_mfma_f32_16x16x32_bf16 v[104:107], a[192:195], v[120:123], v[104:107]
    s_add_u32 s96, s52, 0x1a000
    v_permlane32_swap_b32 v152, v154
    v_permlane32_swap_b32 v153, v155
    s_add_u32 s82, s58, 0xa00000
    s_add_u32 s83, s59, 0xa00000
    s_add_u32 s84, s60, 0xa00000
    v_pk_mul_f32 v[156:157], v[44:45], v[148:149] op_sel:[0,1] op_sel_hi:[1,1]
    v_pk_mul_f32 v[158:159], v[46:47], v[148:149] op_sel:[0,1] op_sel_hi:[1,1]
    v_pk_mul_f32 v[160:161], v[44:45], v[150:151] op_sel:[0,1] op_sel_hi:[1,1]
    v_pk_mul_f32 v[162:163], v[46:47], v[150:151] op_sel:[0,1] op_sel_hi:[1,1]
    v_pk_fma_f32 v[60:61], v[60:61], v[148:149], v[156:157] op_sel:[0,0,0] op_sel_hi:[1,0,1]
    v_pk_fma_f32 v[62:63], v[62:63], v[148:149], v[158:159] op_sel:[0,0,0] op_sel_hi:[1,0,1]
    v_pk_fma_f32 v[64:65], v[64:65], v[150:151], v[160:161] op_sel:[0,0,0] op_sel_hi:[1,0,1]
    v_pk_fma_f32 v[66:67], v[66:67], v[150:151], v[162:163] op_sel:[0,0,0] op_sel_hi:[1,0,1]
    v_exp_f32 v156, v60
    v_exp_f32 v157, v61
    v_exp_f32 v158, v62
    v_exp_f32 v159, v63
    v_exp_f32 v160, v64
    v_exp_f32 v161, v65
    v_exp_f32 v162, v66
    v_exp_f32 v163, v67
    v_pk_fma_f32 v[156:157], v[156:157], v[182:183], v[182:183] op_sel:[0,0,0] op_sel_hi:[1,0,0] neg_lo:[0,1,1] neg_hi:[0,1,1]
    v_pk_fma_f32 v[158:159], v[158:159], v[182:183], v[182:183] op_sel:[0,0,0] op_sel_hi:[1,0,0] neg_lo:[0,1,1] neg_hi:[0,1,1]
    v_pk_fma_f32 v[160:161], v[160:161], v[182:183], v[182:183] op_sel:[0,0,0] op_sel_hi:[1,0,0] neg_lo:[0,1,1] neg_hi:[0,1,1]
    v_pk_fma_f32 v[162:163], v[162:163], v[182:183], v[182:183] op_sel:[0,0,0] op_sel_hi:[1,0,0] neg_lo:[0,1,1] neg_hi:[0,1,1]
    v_rcp_f32 v156, v156
    v_rcp_f32 v157, v157
    v_rcp_f32 v158, v158
    v_rcp_f32 v159, v159
    v_rcp_f32 v160, v160
    v_rcp_f32 v161, v161
    v_rcp_f32 v162, v162
    v_rcp_f32 v163, v163
    v_pk_mul_f32 v[60:61], v[60:61], v[156:157]
    v_pk_mul_f32 v[62:63], v[62:63], v[158:159]
    v_pk_mul_f32 v[64:65], v[64:65], v[160:161]
    v_pk_mul_f32 v[66:67], v[66:67], v[162:163]
    v_cvt_pk_bf16_f32 v60, v60, v61
    v_cvt_pk_bf16_f32 v61, v62, v63
    v_cvt_pk_bf16_f32 v62, v64, v65
    v_cvt_pk_bf16_f32 v63, v66, v67
    s_nop 0
    v_permlane16_swap_b32 v60, v62
    v_permlane16_swap_b32 v61, v63
    s_cmp_eq_u32 s51, 1
    s_cbranch_scc0 Lslow_39
    buffer_store_dwordx4 v[60:63], v5, s[32:35], s82 offen offset:0
Ljoin_40:
    v_pk_mul_f32 v[164:165], v[48:49], v[148:149] op_sel:[0,1] op_sel_hi:[1,1]
    v_pk_mul_f32 v[166:167], v[50:51], v[148:149] op_sel:[0,1] op_sel_hi:[1,1]
    v_pk_mul_f32 v[168:169], v[48:49], v[150:151] op_sel:[0,1] op_sel_hi:[1,1]
    v_pk_mul_f32 v[170:171], v[50:51], v[150:151] op_sel:[0,1] op_sel_hi:[1,1]
    v_pk_fma_f32 v[68:69], v[68:69], v[148:149], v[164:165] op_sel:[0,0,0] op_sel_hi:[1,0,1]
    v_pk_fma_f32 v[70:71], v[70:71], v[148:149], v[166:167] op_sel:[0,0,0] op_sel_hi:[1,0,1]
    v_pk_fma_f32 v[72:73], v[72:73], v[150:151], v[168:169] op_sel:[0,0,0] op_sel_hi:[1,0,1]
    v_pk_fma_f32 v[74:75], v[74:75], v[150:151], v[170:171] op_sel:[0,0,0] op_sel_hi:[1,0,1]
    v_exp_f32 v164, v68
    v_exp_f32 v165, v69
    v_exp_f32 v166, v70
    v_exp_f32 v167, v71
    v_exp_f32 v168, v72
    v_exp_f32 v169, v73
    v_exp_f32 v170, v74
    v_exp_f32 v171, v75
    v_pk_fma_f32 v[164:165], v[164:165], v[182:183], v[182:183] op_sel:[0,0,0] op_sel_hi:[1,0,0] neg_lo:[0,1,1] neg_hi:[0,1,1]
    v_pk_fma_f32 v[166:167], v[166:167], v[182:183], v[182:183] op_sel:[0,0,0] op_sel_hi:[1,0,0] neg_lo:[0,1,1] neg_hi:[0,1,1]
    v_pk_fma_f32 v[168:169], v[168:169], v[182:183], v[182:183] op_sel:[0,0,0] op_sel_hi:[1,0,0] neg_lo:[0,1,1] neg_hi:[0,1,1]
    v_pk_fma_f32 v[170:171], v[170:171], v[182:183], v[182:183] op_sel:[0,0,0] op_sel_hi:[1,0,0] neg_lo:[0,1,1] neg_hi:[0,1,1]
    v_rcp_f32 v164, v164
    v_rcp_f32 v165, v165
    v_rcp_f32 v166, v166
    v_rcp_f32 v167, v167
    v_rcp_f32 v168, v168
    v_rcp_f32 v169, v169
    v_rcp_f32 v170, v170
    v_rcp_f32 v171, v171
    v_pk_mul_f32 v[68:69], v[68:69], v[164:165]
    v_pk_mul_f32 v[70:71], v[70:71], v[166:167]
    v_pk_mul_f32 v[72:73], v[72:73], v[168:169]
    v_pk_mul_f32 v[74:75], v[74:75], v[170:171]
    v_cvt_pk_bf16_f32 v68, v68, v69
    v_cvt_pk_bf16_f32 v69, v70, v71
    v_cvt_pk_bf16_f32 v70, v72, v73
    v_cvt_pk_bf16_f32 v71, v74, v75
    s_nop 0
    v_permlane16_swap_b32 v68, v70
    v_permlane16_swap_b32 v69, v71
    s_cmp_eq_u32 s51, 1
    s_cbranch_scc0 Lslow_41
    buffer_store_dwordx4 v[68:71], v5, s[32:35], s83 offen offset:0
Ljoin_42:
    v_pk_mul_f32 v[156:157], v[52:53], v[148:149] op_sel:[0,1] op_sel_hi:[1,1]
    v_pk_mul_f32 v[158:159], v[54:55], v[148:149] op_sel:[0,1] op_sel_hi:[1,1]
    v_pk_mul_f32 v[160:161], v[52:53], v[150:151] op_sel:[0,1] op_sel_hi:[1,1]
    v_pk_mul_f32 v[162:163], v[54:55], v[150:151] op_sel:[0,1] op_sel_hi:[1,1]
    v_pk_fma_f32 v[76:77], v[76:77], v[148:149], v[156:157] op_sel:[0,0,0] op_sel_hi:[1,0,1]
    v_pk_fma_f32 v[78:79], v[78:79], v[148:149], v[158:159] op_sel:[0,0,0] op_sel_hi:[1,0,1]
    v_pk_fma_f32 v[80:81], v[80:81], v[150:151], v[160:161] op_sel:[0,0,0] op_sel_hi:[1,0,1]
    v_pk_fma_f32 v[82:83], v[82:83], v[150:151], v[162:163] op_sel:[0,0,0] op_sel_hi:[1,0,1]
    v_exp_f32 v156, v76
    v_exp_f32 v157, v77
    v_exp_f32 v158, v78
    v_exp_f32 v159, v79
    v_exp_f32 v160, v80
    v_exp_f32 v161, v81
    v_exp_f32 v162, v82
    v_exp_f32 v163, v83
    v_pk_fma_f32 v[156:157], v[156:157], v[182:183], v[182:183] op_sel:[0,0,0] op_sel_hi:[1,0,0] neg_lo:[0,1,1] neg_hi:[0,1,1]
    v_pk_fma_f32 v[158:159], v[158:159], v[182:183], v[182:183] op_sel:[0,0,0] op_sel_hi:[1,0,0] neg_lo:[0,1,1] neg_hi:[0,1,1]
    v_pk_fma_f32 v[160:161], v[160:161], v[182:183], v[182:183] op_sel:[0,0,0] op_sel_hi:[1,0,0] neg_lo:[0,1,1] neg_hi:[0,1,1]
    v_pk_fma_f32 v[162:163], v[162:163], v[182:183], v[182:183] op_sel:[0,0,0] op_sel_hi:[1,0,0] neg_lo:[0,1,1] neg_hi:[0,1,1]
    v_rcp_f32 v156, v156
    v_rcp_f32 v157, v157
    v_rcp_f32 v158, v158
    v_rcp_f32 v159, v159
    v_rcp_f32 v160, v160
    v_rcp_f32 v161, v161
    v_rcp_f32 v162, v162
    v_rcp_f32 v163, v163
    v_pk_mul_f32 v[76:77], v[76:77], v[156:157]
    v_pk_mul_f32 v[78:79], v[78:79], v[158:159]
    v_pk_mul_f32 v[80:81], v[80:81], v[160:161]
    v_pk_mul_f32 v[82:83], v[82:83], v[162:163]
    v_cvt_pk_bf16_f32 v76, v76, v77
    v_cvt_pk_bf16_f32 v77, v78, v79
    v_cvt_pk_bf16_f32 v78, v80, v81
    v_cvt_pk_bf16_f32 v79, v82, v83
    s_nop 0
    v_permlane16_swap_b32 v76, v78
    v_permlane16_swap_b32 v77, v79
    s_cmp_eq_u32 s51, 1
    s_cbranch_scc0 Lslow_43
    buffer_store_dwordx4 v[76:79], v5, s[32:35], s84 offen offset:0
Ljoin_44:
    s_add_u32 s82, s58, 0xa16000
    s_add_u32 s83, s59, 0xa16000
    s_add_u32 s84, s60, 0xa16000
    v_pk_mul_f32 v[156:157], v[44:45], v[152:153] op_sel:[0,1] op_sel_hi:[1,1]
    v_pk_mul_f32 v[158:159], v[46:47], v[152:153] op_sel:[0,1] op_sel_hi:[1,1]
    v_pk_mul_f32 v[160:161], v[44:45], v[154:155] op_sel:[0,1] op_sel_hi:[1,1]
    v_pk_mul_f32 v[162:163], v[46:47], v[154:155] op_sel:[0,1] op_sel_hi:[1,1]
    v_pk_fma_f32 v[84:85], v[84:85], v[152:153], v[156:157] op_sel:[0,0,0] op_sel_hi:[1,0,1]
    v_pk_fma_f32 v[86:87], v[86:87], v[152:153], v[158:159] op_sel:[0,0,0] op_sel_hi:[1,0,1]
    v_pk_fma_f32 v[88:89], v[88:89], v[154:155], v[160:161] op_sel:[0,0,0] op_sel_hi:[1,0,1]
    v_pk_fma_f32 v[90:91], v[90:91], v[154:155], v[162:163] op_sel:[0,0,0] op_sel_hi:[1,0,1]
    v_exp_f32 v156, v84
    v_exp_f32 v157, v85
    v_exp_f32 v158, v86
    v_exp_f32 v159, v87
    v_exp_f32 v160, v88
    v_exp_f32 v161, v89
    v_exp_f32 v162, v90
    v_exp_f32 v163, v91
    v_pk_fma_f32 v[156:157], v[156:157], v[182:183], v[182:183] op_sel:[0,0,0] op_sel_hi:[1,0,0] neg_lo:[0,1,1] neg_hi:[0,1,1]
    v_pk_fma_f32 v[158:159], v[158:159], v[182:183], v[182:183] op_sel:[0,0,0] op_sel_hi:[1,0,0] neg_lo:[0,1,1] neg_hi:[0,1,1]
    v_pk_fma_f32 v[160:161], v[160:161], v[182:183], v[182:183] op_sel:[0,0,0] op_sel_hi:[1,0,0] neg_lo:[0,1,1] neg_hi:[0,1,1]
    v_pk_fma_f32 v[162:163], v[162:163], v[182:183], v[182:183] op_sel:[0,0,0] op_sel_hi:[1,0,0] neg_lo:[0,1,1] neg_hi:[0,1,1]
    v_rcp_f32 v156, v156
    v_rcp_f32 v157, v157
    v_rcp_f32 v158, v158
    v_rcp_f32 v159, v159
    v_rcp_f32 v160, v160
    v_rcp_f32 v161, v161
    v_rcp_f32 v162, v162
    v_rcp_f32 v163, v163
    v_pk_mul_f32 v[84:85], v[84:85], v[156:157]
    v_pk_mul_f32 v[86:87], v[86:87], v[158:159]
    v_pk_mul_f32 v[88:89], v[88:89], v[160:161]
    v_pk_mul_f32 v[90:91], v[90:91], v[162:163]
    v_cvt_pk_bf16_f32 v84, v84, v85
    v_cvt_pk_bf16_f32 v85, v86, v87
    v_cvt_pk_bf16_f32 v86, v88, v89
    v_cvt_pk_bf16_f32 v87, v90, v91
    s_nop 0
    v_permlane16_swap_b32 v84, v86
    v_permlane16_swap_b32 v85, v87
    s_cmp_eq_u32 s51, 1
    s_cbranch_scc0 Lslow_45
    buffer_store_dwordx4 v[84:87], v5, s[32:35], s82 offen offset:0
Ljoin_46:
    s_add_u32 s76, s22, 4
    v_mov_b32 v19, s76
    s_waitcnt vmcnt(1)
    s_mov_b64 exec, 1
    s_cmp_eq_u32 s51, 1
    s_cbranch_scc0 Lslow_47
    buffer_store_dword v19, off, s[32:35], s98
Ljoin_48:
    s_mov_b64 exec, -1
    v_pk_mul_f32 v[164:165], v[48:49], v[152:153] op_sel:[0,1] op_sel_hi:[1,1]
    v_pk_mul_f32 v[166:167], v[50:51], v[152:153] op_sel:[0,1] op_sel_hi:[1,1]
    v_pk_mul_f32 v[168:169], v[48:49], v[154:155] op_sel:[0,1] op_sel_hi:[1,1]
    v_pk_mul_f32 v[170:171], v[50:51], v[154:155] op_sel:[0,1] op_sel_hi:[1,1]
    v_pk_fma_f32 v[92:93], v[92:93], v[152:153], v[164:165] op_sel:[0,0,0] op_sel_hi:[1,0,1]
    v_pk_fma_f32 v[94:95], v[94:95], v[152:153], v[166:167] op_sel:[0,0,0] op_sel_hi:[1,0,1]
    v_pk_fma_f32 v[96:97], v[96:97], v[154:155], v[168:169] op_sel:[0,0,0] op_sel_hi:[1,0,1]
    v_pk_fma_f32 v[98:99], v[98:99], v[154:155], v[170:171] op_sel:[0,0,0] op_sel_hi:[1,0,1]
    v_exp_f32 v164, v92
    v_exp_f32 v165, v93
    v_exp_f32 v166, v94
    v_exp_f32 v167, v95
    v_exp_f32 v168, v96
    v_exp_f32 v169, v97
    v_exp_f32 v170, v98
    v_exp_f32 v171, v99
    v_pk_fma_f32 v[164:165], v[164:165], v[182:183], v[182:183] op_sel:[0,0,0] op_sel_hi:[1,0,0] neg_lo:[0,1,1] neg_hi:[0,1,1]
    v_pk_fma_f32 v[166:167], v[166:167], v[182:183], v[182:183] op_sel:[0,0,0] op_sel_hi:[1,0,0] neg_lo:[0,1,1] neg_hi:[0,1,1]
    v_pk_fma_f32 v[168:169], v[168:169], v[182:183], v[182:183] op_sel:[0,0,0] op_sel_hi:[1,0,0] neg_lo:[0,1,1] neg_hi:[0,1,1]
    v_pk_fma_f32 v[170:171], v[170:171], v[182:183], v[182:183] op_sel:[0,0,0] op_sel_hi:[1,0,0] neg_lo:[0,1,1] neg_hi:[0,1,1]
    v_rcp_f32 v164, v164
    v_rcp_f32 v165, v165
    v_rcp_f32 v166, v166
    v_rcp_f32 v167, v167
    v_rcp_f32 v168, v168
    v_rcp_f32 v169, v169
    v_rcp_f32 v170, v170
    v_rcp_f32 v171, v171
    v_pk_mul_f32 v[92:93], v[92:93], v[164:165]
    v_pk_mul_f32 v[94:95], v[94:95], v[166:167]
    v_pk_mul_f32 v[96:97], v[96:97], v[168:169]
    v_pk_mul_f32 v[98:99], v[98:99], v[170:171]
    v_cvt_pk_bf16_f32 v92, v92, v93
    v_cvt_pk_bf16_f32 v93, v94, v95
    v_cvt_pk_bf16_f32 v94, v96, v97
    v_cvt_pk_bf16_f32 v95, v98, v99
    s_nop 0
    v_permlane16_swap_b32 v92, v94
    v_permlane16_swap_b32 v93, v95
    s_cmp_eq_u32 s51, 1
    s_cbranch_scc0 Lslow_49
    buffer_store_dwordx4 v[92:95], v5, s[32:35], s83 offen offset:0
Ljoin_50:
    v_pk_mul_f32 v[156:157], v[52:53], v[152:153] op_sel:[0,1] op_sel_hi:[1,1]
    v_pk_mul_f32 v[158:159], v[54:55], v[152:153] op_sel:[0,1] op_sel_hi:[1,1]
    v_pk_mul_f32 v[160:161], v[52:53], v[154:155] op_sel:[0,1] op_sel_hi:[1,1]
    v_pk_mul_f32 v[162:163], v[54:55], v[154:155] op_sel:[0,1] op_sel_hi:[1,1]
    v_pk_fma_f32 v[100:101], v[100:101], v[152:153], v[156:157] op_sel:[0,0,0] op_sel_hi:[1,0,1]
    v_pk_fma_f32 v[102:103], v[102:103], v[152:153], v[158:159] op_sel:[0,0,0] op_sel_hi:[1,0,1]
    v_pk_fma_f32 v[104:105], v[104:105], v[154:155], v[160:161] op_sel:[0,0,0] op_sel_hi:[1,0,1]
    v_pk_fma_f32 v[106:107], v[106:107], v[154:155], v[162:163] op_sel:[0,0,0] op_sel_hi:[1,0,1]
    v_exp_f32 v156, v100
    v_exp_f32 v157, v101
    v_exp_f32 v158, v102
    v_exp_f32 v159, v103
    v_exp_f32 v160, v104
    v_exp_f32 v161, v105
    v_exp_f32 v162, v106
    v_exp_f32 v163, v107
    v_pk_fma_f32 v[156:157], v[156:157], v[182:183], v[182:183] op_sel:[0,0,0] op_sel_hi:[1,0,0] neg_lo:[0,1,1] neg_hi:[0,1,1]
    v_pk_fma_f32 v[158:159], v[158:159], v[182:183], v[182:183] op_sel:[0,0,0] op_sel_hi:[1,0,0] neg_lo:[0,1,1] neg_hi:[0,1,1]
    v_pk_fma_f32 v[160:161], v[160:161], v[182:183], v[182:183] op_sel:[0,0,0] op_sel_hi:[1,0,0] neg_lo:[0,1,1] neg_hi:[0,1,1]
    v_pk_fma_f32 v[162:163], v[162:163], v[182:183], v[182:183] op_sel:[0,0,0] op_sel_hi:[1,0,0] neg_lo:[0,1,1] neg_hi:[0,1,1]
    v_rcp_f32 v156, v156
    v_rcp_f32 v157, v157
    v_rcp_f32 v158, v158
    v_rcp_f32 v159, v159
    v_rcp_f32 v160, v160
    v_rcp_f32 v161, v161
    v_rcp_f32 v162, v162
    v_rcp_f32 v163, v163
    v_pk_mul_f32 v[100:101], v[100:101], v[156:157]
    v_pk_mul_f32 v[102:103], v[102:103], v[158:159]
    v_pk_mul_f32 v[104:105], v[104:105], v[160:161]
    v_pk_mul_f32 v[106:107], v[106:107], v[162:163]
    v_cvt_pk_bf16_f32 v100, v100, v101
    v_cvt_pk_bf16_f32 v101, v102, v103
    v_cvt_pk_bf16_f32 v102, v104, v105
    v_cvt_pk_bf16_f32 v103, v106, v107
    s_nop 0
    v_permlane16_swap_b32 v100, v102
    v_permlane16_swap_b32 v101, v103
    s_cmp_eq_u32 s51, 1
    s_cbranch_scc0 Lslow_51
    buffer_store_dwordx4 v[100:103], v5, s[32:35], s84 offen offset:0
Ljoin_52:
    s_add_u32 s76, s22, 4
Lpoll_53:
    buffer_load_dword v180, v14, s[32:35], s54 offen sc1
    s_waitcnt vmcnt(0)
Lpc_55:
    v_subrev_u32 v180, s76, v180
    v_cmp_gt_u32 vcc, 12, v180
    s_nop 1
    s_cmp_eq_u64 vcc, exec
    s_cbranch_scc1 Lpd_54
    s_sub_u32 s61, s61, 1
    s_cmp_lg_u32 s61, 0
    s_cbranch_scc1 Lpoll_53
    s_branch L_end
Lpd_54:
    s_add_u32 m0, s99, 0x10000
    s_add_u32 s101, s56, 0xa00000
    buffer_load_dwordx4 v181, s[32:35], s101 offen offset:0 sc1 lds
    buffer_load_dwordx4 v181, s[32:35], s101 offen offset:1024 sc1 lds
    s_add_u32 m0, s99, 0x12000
    s_add_u32 s101, s56, 0xa02000
    buffer_load_dwordx4 v181, s[32:35], s101 offen offset:0 sc1 lds
    buffer_load_dwordx4 v181, s[32:35], s101 offen offset:1024 sc1 lds
    s_add_u32 s76, s22, 5
    v_mov_b32 v19, s76
    s_mov_b64 exec, 1
    s_cmp_eq_u32 s51, 1
    s_cbranch_scc0 Lslow_56
    buffer_store_dword v19, off, s[32:35], s98
Ljoin_57:
    s_mov_b64 exec, -1
    s_add_u32 m0, s99, 0x0
    s_add_u32 s101, s56, 0xa04000
    buffer_load_dwordx4 v181, s[32:35], s101 offen offset:0 sc1 lds
    buffer_load_dwordx4 v181, s[32:35], s101 offen offset:1024 sc1 lds
    s_add_u32 m0, s99, 0x2000
    s_add_u32 s101, s56, 0xa06000
    buffer_load_dwordx4 v181, s[32:35], s101 offen offset:0 sc1 lds
    buffer_load_dwordx4 v181, s[32:35], s101 offen offset:1024 sc1 lds
    s_add_u32 m0, s99, 0x4000
    s_add_u32 s101, s56, 0xa08000
    buffer_load_dwordx4 v181, s[32:35], s101 offen offset:0 sc1 lds
    buffer_load_dwordx4 v181, s[32:35], s101 offen offset:1024 sc1 lds
    s_add_u32 m0, s99, 0x6000
    s_add_u32 s101, s56, 0xa0a000
    buffer_load_dwordx4 v181, s[32:35], s101 offen offset:0 sc1 lds
    s_waitcnt vmcnt(10)
    s_barrier
    ds_read_b128 v[108:111], v2 offset:0
    ds_read_b128 v[112:115], v2 offset:2048
    ds_read_b128 v[116:119], v2 offset:1024
    ds_read_b128 v[120:123], v2 offset:3072
    ds_read_b128 v[124:127], v2 offset:4096
    ds_read_b128 v[128:131], v2 offset:6144
    ds_read_b128 v[132:135], v2 offset:5120
    ds_read_b128 v[136:139], v2 offset:7168
    s_waitcnt vmcnt(8)
    s_barrier
    ds_read_b128 v[140:143], v2 offset:8192
    s_waitcnt lgkmcnt(7)
    v_mfma_f32_16x16x32_bf16 v[20:23], a[196:199], v[108:111], v[20:23]
    buffer_load_dwordx4 v181, s[32:35], s101 offen offset:1024 sc1 lds
    v_mfma_f32_16x16x32_bf16 v[24:27], a[196:199], v[112:115], v[24:27]
    ds_read_b128 v[144:147], v2 offset:10240
    ds_read_b128 v[108:111], v2 offset:9216
    s_waitcnt lgkmcnt(7)
    v_mfma_f32_16x16x32_bf16 v[20:23], a[200:203], v[116:119], v[20:23]
    ds_read_b128 v[112:115], v2 offset:11264
    s_add_u32 m0, s99, 0x8000
    v_mfma_f32_16x16x32_bf16 v[24:27], a[200:203], v[120:123], v[24:27]
    ds_read_b128 v[116:119], v2 offset:12288
    s_add_u32 s101, s56, 0xa0c000
    s_waitcnt lgkmcnt(7)
    v_mfma_f32_16x16x32_bf16 v[20:23], a[204:207], v[124:127], v[20:23]
    buffer_load_dwordx4 v181, s[32:35], s101 offen offset:0 sc1 lds
    v_mfma_f32_16x16x32_bf16 v[24:27], a[204:207], v[128:131], v[24:27]
    ds_read_b128 v[120:123], v2 offset:14336
    ds_read_b128 v[124:127], v2 offset:13312
    s_waitcnt lgkmcnt(7)
    v_mfma_f32_16x16x32_bf16 v[20:23], a[208:211], v[132:135], v[20:23]
    buffer_load_dwordx4 v181, s[32:35], s101 offen offset:1024 sc1 lds
    v_mfma_f32_16x16x32_bf16 v[24:27], a[208:211], v[136:139], v[24:27]
    ds_read_b128 v[128:131], v2 offset:15360
    s_waitcnt vmcnt(6)
    s_barrier
    ds_read_b128 v[132:135], v1 offset:0
    s_waitcnt lgkmcnt(7)
    v_mfma_f32_16x16x32_bf16 v[20:23], a[212:215], v[140:143], v[20:23]
    ds_read_b128 v[136:139], v1 offset:2048
    s_add_u32 m0, s99, 0xa000
    v_mfma_f32_16x16x32_bf16 v[24:27], a[212:215], v[144:147], v[24:27]
    ds_read_b128 v[140:143], v1 offset:1024
    s_add_u32 s101, s56, 0xa0e000
    s_waitcnt lgkmcnt(7)
    v_mfma_f32_16x16x32_bf16 v[20:23], a[216:219], v[108:111], v[20:23]
    buffer_load_dwordx4 v181, s[32:35], s101 offen offset:0 sc1 lds
    v_mfma_f32_16x16x32_bf16 v[24:27], a[216:219], v[112:115], v[24:27]
    ds_read_b128 v[144:147], v1 offset:3072
    ds_read_b128 v[108:111], v1 offset:4096
    s_waitcnt lgkmcnt(7)
    v_mfma_f32_16x16x32_bf16 v[20:23], a[220:223], v[116:119], v[20:23]
    buffer_load_dwordx4 v181, s[32:35], s101 offen offset:1024 sc1 lds
    v_mfma_f32_16x16x32_bf16 v[24:27], a[220:223], v[120:123], v[24:27]
    ds_read_b128 v[112:115], v1 offset:6144
    ds_read_b128 v[116:119], v1 offset:5120
    s_waitcnt lgkmcnt(7)
    v_mfma_f32_16x16x32_bf16 v[20:23], a[224:227], v[124:127], v[20:23]
    ds_read_b128 v[120:123], v1 offset:7168
    s_add_u32 m0, s99, 0xc000
    v_mfma_f32_16x16x32_bf16 v[24:27], a[224:227], v[128:131], v[24:27]
    ds_read_b128 v[124:127], v1 offset:8192
    s_add_u32 s101, s56, 0xa10000
    s_waitcnt lgkmcnt(7)
    v_mfma_f32_16x16x32_bf16 v[20:23], a[228:231], v[132:135], v[20:23]
    buffer_load_dwordx4 v181, s[32:35], s101 offen offset:0 sc1 lds
    v_mfma_f32_16x16x32_bf16 v[24:27], a[228:231], v[136:139], v[24:27]
    ds_read_b128 v[128:131], v1 offset:10240
    ds_read_b128 v[132:135], v1 offset:9216
    s_waitcnt lgkmcnt(7)
    v_mfma_f32_16x16x32_bf16 v[20:23], a[232:235], v[140:143], v[20:23]
    buffer_load_dwordx4 v181, s[32:35], s101 offen offset:1024 sc1 lds
    v_mfma_f32_16x16x32_bf16 v[24:27], a[232:235], v[144:147], v[24:27]
    ds_read_b128 v[136:139], v1 offset:11264
    ds_read_b128 v[140:143], v1 offset:12288
    s_waitcnt lgkmcnt(7)
    v_mfma_f32_16x16x32_bf16 v[20:23], a[236:239], v[108:111], v[20:23]
    ds_read_b128 v[144:147], v1 offset:14336
    s_add_u32 m0, s99, 0xe000
    v_mfma_f32_16x16x32_bf16 v[24:27], a[236:239], v[112:115], v[24:27]
    ds_read_b128 v[108:111], v1 offset:13312
    s_add_u32 s101, s56, 0xa12000
    s_waitcnt lgkmcnt(7)
    v_mfma_f32_16x16x32_bf16 v[20:23], a[240:243], v[116:119], v[20:23]
    buffer_load_dwordx4 v181, s[32:35], s101 offen offset:0 sc1 lds
    v_mfma_f32_16x16x32_bf16 v[24:27], a[240:243], v[120:123], v[24:27]
    ds_read_b128 v[112:115], v1 offset:15360
    s_waitcnt vmcnt(7)
    s_barrier
    ds_read_b128 v[116:119], v1 offset:16384
    s_waitcnt lgkmcnt(7)
    v_mfma_f32_16x16x32_bf16 v[20:23], a[244:247], v[124:127], v[20:23]
    buffer_load_dwordx4 v181, s[32:35], s101 offen offset:1024 sc1 lds
    buffer_load_dword v180, v14, s[32:35], s54 offen sc1
    v_mfma_f32_16x16x32_bf16 v[24:27], a[244:247], v[128:131], v[24:27]
    ds_read_b128 v[120:123], v1 offset:18432
    ds_read_b128 v[124:127], v1 offset:17408
    s_waitcnt lgkmcnt(7)
    v_mfma_f32_16x16x32_bf16 v[20:23], a[248:251], v[132:135], v[20:23]
    ds_read_b128 v[128:131], v1 offset:19456
    s_add_u32 m0, s99, 0x10000
    v_mfma_f32_16x16x32_bf16 v[24:27], a[248:251], v[136:139], v[24:27]
    ds_read_b128 v[132:135], v1 offset:20480
    s_add_u32 s101, s56, 0xa14000
    s_waitcnt lgkmcnt(7)
    v_mfma_f32_16x16x32_bf16 v[20:23], a[252:255], v[140:143], v[20:23]
    buffer_load_dwordx4 v181, s[32:35], s101 offen offset:0 sc1 lds
    v_mfma_f32_16x16x32_bf16 v[24:27], a[252:255], v[144:147], v[24:27]
    ds_read_b128 v[136:139], v1 offset:22528
    ds_read_b128 v[140:143], v1 offset:21504
    s_waitcnt lgkmcnt(7)
    v_mfma_f32_16x16x32_bf16 v[20:23], v[196:199], v[108:111], v[20:23]
    buffer_load_dwordx4 v181, s[32:35], s101 offen offset:1024 sc1 lds
    v_mfma_f32_16x16x32_bf16 v[24:27], v[196:199], v[112:115], v[24:27]
    ds_read_b128 v[144:147], v1 offset:23552
    ds_read_b128 v[108:111], v1 offset:24576
    s_waitcnt lgkmcnt(7)
    v_mfma_f32_16x16x32_bf16 v[20:23], v[200:203], v[116:119], v[20:23]
    ds_read_b128 v[112:115], v1 offset:26624
    v_mfma_f32_16x16x32_bf16 v[24:27], v[200:203], v[120:123], v[24:27]
    buffer_load_dwordx4 a[168:171], v1, s[32:35], s96 offen offset:0 sc1
    s_waitcnt lgkmcnt(6)
    v_mfma_f32_16x16x32_bf16 v[20:23], v[204:207], v[124:127], v[20:23]
    ds_read_b128 v[116:119], v1 offset:25600
    ds_read_b128 v[120:123], v1 offset:27648
    v_mfma_f32_16x16x32_bf16 v[24:27], v[204:207], v[128:131], v[24:27]
    ds_read_b128 v[124:127], v1 offset:28672
    s_waitcnt lgkmcnt(7)
    v_mfma_f32_16x16x32_bf16 v[20:23], v[208:211], v[132:135], v[20:23]
    buffer_load_dwordx4 a[172:175], v1, s[32:35], s96 offen offset:1024 sc1
    s_add_u32 s76, s22, 5
    s_waitcnt vmcnt(4)
    s_branch Lpc_60
Lpoll_58:
    buffer_load_dword v180, v14, s[32:35], s54 offen sc1
    s_waitcnt vmcnt(0)
Lpc_60:
    v_subrev_u32 v180, s76, v180
    v_cmp_gt_u32 vcc, 11, v180
    s_nop 1
    s_cmp_eq_u64 vcc, exec
    s_cbranch_scc1 Lpd_59
    s_sub_u32 s61, s61, 1
    s_cmp_lg_u32 s61, 0
    s_cbranch_scc1 Lpoll_58
    s_branch L_end
Lpd_59:
    s_add_u32 m0, s99, 0x12000
    s_add_u32 s101, s56, 0xa16000
    buffer_load_dwordx4 v181, s[32:35], s101 offen offset:0 sc1 lds
    buffer_load_dwordx4 v181, s[32:35], s101 offen offset:1024 sc1 lds
    v_mfma_f32_16x16x32_bf16 v[24:27], v[208:211], v[136:139], v[24:27]
    ds_read_b128 v[128:131], v1 offset:30720
    ds_read_b128 v[132:135], v1 offset:29696
    s_waitcnt lgkmcnt(7)
    v_mfma_f32_16x16x32_bf16 v[20:23], v[212:215], v[140:143], v[20:23]
    ds_read_b128 v[136:139], v1 offset:31744
    v_mfma_f32_16x16x32_bf16 v[24:27], v[212:215], v[144:147], v[24:27]
    s_barrier
    ds_read_b128 v[140:143], v1 offset:32768
    s_waitcnt lgkmcnt(7)
    v_mfma_f32_16x16x32_bf16 v[20:23], v[216:219], v[108:111], v[20:23]
    ds_read_b128 v[144:147], v1 offset:34816
    s_add_u32 m0, s99, 0x0
    v_mfma_f32_16x16x32_bf16 v[24:27], v[216:219], v[112:115], v[24:27]
    ds_read_b128 v[108:111], v1 offset:33792
    s_add_u32 s101, s56, 0xa18000
    s_waitcnt lgkmcnt(7)
    v_mfma_f32_16x16x32_bf16 v[20:23], v[220:223], v[116:119], v[20:23]
    buffer_load_dwordx4 v181, s[32:35], s101 offen offset:0 sc1 lds
    v_mfma_f32_16x16x32_bf16 v[24:27], v[220:223], v[120:123], v[24:27]
    ds_read_b128 v[112:115], v1 offset:35840
    ds_read_b128 v[116:119], v1 offset:36864
    s_waitcnt lgkmcnt(7)
    v_mfma_f32_16x16x32_bf16 v[20:23], v[224:227], v[124:127], v[20:23]
    buffer_load_dwordx4 v181, s[32:35], s101 offen offset:1024 sc1 lds
    v_mfma_f32_16x16x32_bf16 v[24:27], v[224:227], v[128:131], v[24:27]
    ds_read_b128 v[120:123], v1 offset:38912
    ds_read_b128 v[124:127], v1 offset:37888
    s_waitcnt lgkmcnt(7)
    v_mfma_f32_16x16x32_bf16 v[20:23], v[228:231], v[132:135], v[20:23]
    buffer_load_dwordx4 a[176:179], v1, s[32:35], s96 offen offset:2048 sc1
    v_mfma_f32_16x16x32_bf16 v[24:27], v[228:231], v[136:139], v[24:27]
    ds_read_b128 v[128:131], v1 offset:39936
    ds_read_b128 v[132:135], v1 offset:40960
    s_waitcnt lgkmcnt(7)
    v_mfma_f32_16x16x32_bf16 v[20:23], v[252:255], v[140:143], v[20:23]
    ds_read_b128 v[136:139], v1 offset:43008
    s_add_u32 m0, s99, 0x2000
    v_mfma_f32_16x16x32_bf16 v[24:27], v[252:255], v[144:147], v[24:27]
    ds_read_b128 v[140:143], v1 offset:41984
    s_add_u32 s101, s56, 0xa1a000
    s_waitcnt lgkmcnt(7)
    v_mfma_f32_16x16x32_bf16 v[20:23], v[248:251], v[108:111], v[20:23]
    buffer_load_dwordx4 v181, s[32:35], s101 offen offset:0 sc1 lds
    v_mfma_f32_16x16x32_bf16 v[24:27], v[248:251], v[112:115], v[24:27]
    ds_read_b128 v[144:147], v1 offset:44032
    ds_read_b128 v[108:111], v1 offset:45056
    s_waitcnt lgkmcnt(7)
    v_mfma_f32_16x16x32_bf16 v[20:23], v[244:247], v[116:119], v[20:23]
    buffer_load_dwordx4 v181, s[32:35], s101 offen offset:1024 sc1 lds
    v_mfma_f32_16x16x32_bf16 v[24:27], v[244:247], v[120:123], v[24:27]
    ds_read_b128 v[112:115], v1 offset:47104
    ds_read_b128 v[116:119], v1 offset:46080
    s_waitcnt lgkmcnt(7)
    v_mfma_f32_16x16x32_bf16 v[20:23], v[240:243], v[124:127], v[20:23]
    ds_read_b128 v[120:123], v1 offset:48128
    v_mfma_f32_16x16x32_bf16 v[24:27], v[240:243], v[128:131], v[24:27]
    s_waitcnt vmcnt(9)
    s_barrier
    ds_read_b128 v[124:127], v1 offset:49152
    s_waitcnt lgkmcnt(7)
    v_mfma_f32_16x16x32_bf16 v[20:23], v[236:239], v[132:135], v[20:23]
    ds_read_b128 v[128:131], v1 offset:51200
    s_add_u32 m0, s99, 0x4000
    v_mfma_f32_16x16x32_bf16 v[24:27], v[236:239], v[136:139], v[24:27]
    ds_read_b128 v[132:135], v1 offset:50176
    s_add_u32 s101, s56, 0xa1c000
    s_waitcnt lgkmcnt(7)
    v_mfma_f32_16x16x32_bf16 v[20:23], v[232:235], v[140:143], v[20:23]
    buffer_load_dwordx4 v181, s[32:35], s101 offen offset:0 sc1 lds
    v_mfma_f32_16x16x32_bf16 v[24:27], v[232:235], v[144:147], v[24:27]
    ds_read_b128 v[136:139], v1 offset:52224
    ds_read_b128 v[140:143], v1 offset:53248
    s_waitcnt lgkmcnt(7)
    v_mfma_f32_16x16x32_bf16 v[20:23], a[128:131], v[108:111], v[20:23]
    buffer_load_dwordx4 v181, s[32:35], s101 offen offset:1024 sc1 lds
    v_mfma_f32_16x16x32_bf16 v[24:27], a[128:131], v[112:115], v[24:27]
    ds_read_b128 v[144:147], v1 offset:55296
    ds_read_b128 v[108:111], v1 offset:54272
    s_waitcnt lgkmcnt(7)
    v_mfma_f32_16x16x32_bf16 v[20:23], a[132:135], v[116:119], v[20:23]
    ds_read_b128 v[112:115], v1 offset:56320
    s_add_u32 m0, s99, 0x6000
    v_mfma_f32_16x16x32_bf16 v[24:27], a[132:135], v[120:123], v[24:27]
    ds_read_b128 v[116:119], v1 offset:57344
    s_add_u32 s101, s56, 0xa1e000
    s_waitcnt lgkmcnt(7)
    v_mfma_f32_16x16x32_bf16 v[20:23], a[136:139], v[124:127], v[20:23]
    buffer_load_dwordx4 v181, s[32:35], s101 offen offset:0 sc1 lds
    v_mfma_f32_16x16x32_bf16 v[24:27], a[136:139], v[128:131], v[24:27]
    ds_read_b128 v[120:123], v1 offset:59392
    ds_read_b128 v[124:127], v1 offset:58368
    s_waitcnt lgkmcnt(7)
    v_mfma_f32_16x16x32_bf16 v[20:23], a[140:143], v[132:135], v[20:23]
    buffer_load_dwordx4 v181, s[32:35], s101 offen offset:1024 sc1 lds
    v_mfma_f32_16x16x32_bf16 v[24:27], a[140:143], v[136:139], v[24:27]
    ds_read_b128 v[128:131], v1 offset:60416
    ds_read_b128 v[132:135], v1 offset:61440
    s_waitcnt lgkmcnt(7)
    v_mfma_f32_16x16x32_bf16 v[20:23], a[144:147], v[140:143], v[20:23]
    ds_read_b128 v[136:139], v1 offset:63488
    v_mfma_f32_16x16x32_bf16 v[24:27], a[144:147], v[144:147], v[24:27]
    ds_read_b128 v[140:143], v1 offset:62464
    s_waitcnt lgkmcnt(7)
    v_mfma_f32_16x16x32_bf16 v[20:23], a[148:151], v[108:111], v[20:23]
    ds_read_b128 v[144:147], v1 offset:64512
    v_mfma_f32_16x16x32_bf16 v[24:27], a[148:151], v[112:115], v[24:27]
    ds_read_b128 v[108:111], v2 offset:0
    s_waitcnt lgkmcnt(7)
    v_mfma_f32_16x16x32_bf16 v[20:23], a[152:155], v[116:119], v[20:23]
    ds_read_b128 v[112:115], v2 offset:2048
    v_mfma_f32_16x16x32_bf16 v[24:27], a[152:155], v[120:123], v[24:27]
    ds_read_b128 v[116:119], v2 offset:1024
    s_waitcnt lgkmcnt(7)
    v_mfma_f32_16x16x32_bf16 v[20:23], a[156:159], v[124:127], v[20:23]
    ds_read_b128 v[120:123], v2 offset:3072
    v_mfma_f32_16x16x32_bf16 v[24:27], a[156:159], v[128:131], v[24:27]
    ds_read_b128 v[124:127], v2 offset:4096
    s_waitcnt lgkmcnt(7)
    v_mfma_f32_16x16x32_bf16 v[20:23], a[160:163], v[132:135], v[20:23]
    ds_read_b128 v[128:131], v2 offset:6144
    v_mfma_f32_16x16x32_bf16 v[24:27], a[160:163], v[136:139], v[24:27]
    s_waitcnt vmcnt(9)
    s_barrier
    ds_read_b128 v[132:135], v2 offset:8192
    s_waitcnt lgkmcnt(7)
    v_mfma_f32_16x16x32_bf16 v[20:23], a[164:167], v[140:143], v[20:23]
    ds_read_b128 v[136:139], v2 offset:10240
    s_add_u32 m0, s99, 0x8000
    v_mfma_f32_16x16x32_bf16 v[24:27], a[164:167], v[144:147], v[24:27]
    ds_read_b128 v[140:143], v2 offset:9216
    s_add_u32 s101, s56, 0xa20000
    s_waitcnt lgkmcnt(7)
    v_mfma_f32_16x16x32_bf16 v[20:23], a[168:171], v[108:111], v[20:23]
    buffer_load_dwordx4 v181, s[32:35], s101 offen offset:0 sc1 lds
    v_mfma_f32_16x16x32_bf16 v[24:27], a[168:171], v[112:115], v[24:27]
    ds_read_b128 v[144:147], v2 offset:11264
    ds_read_b128 v[108:111], v2 offset:12288
    s_waitcnt lgkmcnt(7)
    v_mfma_f32_16x16x32_bf16 v[20:23], a[172:175], v[116:119], v[20:23]
    buffer_load_dwordx4 v181, s[32:35], s101 offen offset:1024 sc1 lds
    v_mfma_f32_16x16x32_bf16 v[24:27], a[172:175], v[120:123], v[24:27]
    ds_read_b128 v[112:115], v2 offset:14336
    ds_read_b128 v[116:119], v2 offset:13312
    s_waitcnt vmcnt(8)
    s_waitcnt lgkmcnt(7)
    v_mfma_f32_16x16x32_bf16 v[20:23], a[176:179], v[124:127], v[20:23]
    ds_read_b128 v[120:123], v2 offset:15360
    s_add_u32 m0, s99, 0xa000
    v_mfma_f32_16x16x32_bf16 v[24:27], a[176:179], v[128:131], v[24:27]
    s_barrier
    ds_read_b128 v[124:127], v1 offset:0
    s_add_u32 s101, s56, 0xa22000
    s_waitcnt lgkmcnt(7)
    v_mfma_f32_16x16x32_bf16 v[28:31], a[196:199], v[132:135], v[28:31]
    buffer_load_dwordx4 v181, s[32:35], s101 offen offset:0 sc1 lds
    v_mfma_f32_16x16x32_bf16 v[32:35], a[196:199], v[136:139], v[32:35]
    ds_read_b128 v[128:131], v1 offset:2048
    ds_read_b128 v[132:135], v1 offset:1024
    s_add_u32 s82, s55, s57
    s_add_u32 s82, s82, 0x800000
    s_add_u32 s83, s41, 0
    v_cvt_pk_bf16_f32 v158, v20, v21
    v_cvt_pk_bf16_f32 v159, v22, v23
    v_cvt_pk_bf16_f32 v160, v24, v25
    v_cvt_pk_bf16_f32 v161, v26, v27
    v_lshlrev_b32 v184, 16, v158
    v_and_b32 v185, 0xffff0000, v158
    v_lshlrev_b32 v186, 16, v159
    v_and_b32 v187, 0xffff0000, v159
    v_lshlrev_b32 v188, 16, v160
    v_and_b32 v189, 0xffff0000, v160
    v_lshlrev_b32 v190, 16, v161
    v_and_b32 v191, 0xffff0000, v161
    v_permlane16_swap_b32 v158, v160
    v_permlane16_swap_b32 v159, v161
    s_cmp_eq_u32 s51, 1
    s_cbranch_scc0 Lslow_61
    buffer_store_dwordx4 v[158:161], v5, s[32:35], s82 offen offset:0
Ljoin_62:
    v_pk_add_f32 v[162:163], v[184:185], v[186:187]
    v_pk_mul_f32 v[164:165], v[184:185], v[184:185]
    v_pk_add_f32 v[166:167], v[188:189], v[190:191]
    v_pk_mul_f32 v[168:169], v[188:189], v[188:189]
    v_pk_fma_f32 v[164:165], v[186:187], v[186:187], v[164:165]
    v_add_f32 v162, v162, v163
    v_pk_fma_f32 v[168:169], v[190:191], v[190:191], v[168:169]
    v_add_f32 v166, v166, v167
    v_add_f32 v164, v164, v165
    v_add_f32 v168, v168, v169
    v_permlane32_swap_b32 v162, v166
    s_nop 0
    v_permlane32_swap_b32 v164, v168
    v_add_f32 v162, v162, v166
    v_add_f32 v164, v164, v168
    s_nop 1
    v_permlane16_swap_b32 v162, v164
    v_add_f32 v162, v162, v164
    s_cmp_eq_u32 s51, 1
    s_cbranch_scc0 Lslow_63
    buffer_store_dword v162, v15, s[32:35], s83 offen
Ljoin_64:
    s_waitcnt lgkmcnt(7)
    v_mfma_f32_16x16x32_bf16 v[28:31], a[200:203], v[140:143], v[28:31]
    buffer_load_dwordx4 v181, s[32:35], s101 offen offset:1024 sc1 lds
    v_mfma_f32_16x16x32_bf16 v[32:35], a[200:203], v[144:147], v[32:35]
    ds_read_b128 v[136:139], v1 offset:3072
    ds_read_b128 v[140:143], v1 offset:4096
    s_waitcnt lgkmcnt(7)
    v_mfma_f32_16x16x32_bf16 v[28:31], a[204:207], v[108:111], v[28:31]
    ds_read_b128 v[144:147], v1 offset:6144
    s_add_u32 m0, s99, 0xc000
    v_mfma_f32_16x16x32_bf16 v[32:35], a[204:207], v[112:115], v[32:35]
    ds_read_b128 v[108:111], v1 offset:5120
    s_add_u32 s101, s56, 0xa24000
    s_waitcnt lgkmcnt(7)
    v_mfma_f32_16x16x32_bf16 v[28:31], a[208:211], v[116:119], v[28:31]
    buffer_load_dwordx4 v181, s[32:35], s101 offen offset:0 sc1 lds
    v_mfma_f32_16x16x32_bf16 v[32:35], a[208:211], v[120:123], v[32:35]
    ds_read_b128 v[112:115], v1 offset:7168
    s_waitcnt vmcnt(11)
    s_barrier
    ds_read_b128 v[116:119], v1 offset:8192
    s_waitcnt lgkmcnt(7)
    v_mfma_f32_16x16x32_bf16 v[28:31], a[212:215], v[124:127], v[28:31]
    buffer_load_dwordx4 v181, s[32:35], s101 offen offset:1024 sc1 lds
    v_mfma_f32_16x16x32_bf16 v[32:35], a[212:215], v[128:131], v[32:35]
    ds_read_b128 v[120:123], v1 offset:10240
    ds_read_b128 v[124:127], v1 offset:9216
    s_waitcnt lgkmcnt(7)
    v_mfma_f32_16x16x32_bf16 v[28:31], a[216:219], v[132:135], v[28:31]
    ds_read_b128 v[128:131], v1 offset:11264
    s_add_u32 m0, s99, 0xe000
    v_mfma_f32_16x16x32_bf16 v[32:35], a[216:219], v[136:139], v[32:35]
    ds_read_b128 v[132:135], v1 offset:12288
    s_add_u32 s101, s56, 0xa26000
    s_waitcnt lgkmcnt(7)
    v_mfma_f32_16x16x32_bf16 v[28:31], a[220:223], v[140:143], v[28:31]
    buffer_load_dwordx4 v181, s[32:35], s101 offen offset:0 sc1 lds
    v_mfma_f32_16x16x32_bf16 v[32:35], a[220:223], v[144:147], v[32:35]
    ds_read_b128 v[136:139], v1 offset:14336
    ds_read_b128 v[140:143], v1 offset:13312
    s_waitcnt lgkmcnt(7)
    v_mfma_f32_16x16x32_bf16 v[28:31], a[224:227], v[108:111], v[28:31]
    buffer_load_dwordx4 v181, s[32:35], s101 offen offset:1024 sc1 lds
    v_mfma_f32_16x16x32_bf16 v[32:35], a[224:227], v[112:115], v[32:35]
    ds_read_b128 v[144:147], v1 offset:15360
    s_waitcnt vmcnt(12)
    s_barrier
    ds_read_b128 v[108:111], v1 offset:16384
    s_waitcnt lgkmcnt(7)
    v_mfma_f32_16x16x32_bf16 v[28:31], a[228:231], v[116:119], v[28:31]
    ds_read_b128 v[112:115], v1 offset:18432
    s_add_u32 m0, s99, 0x10000
    v_mfma_f32_16x16x32_bf16 v[32:35], a[228:231], v[120:123], v[32:35]
    ds_read_b128 v[116:119], v1 offset:17408
    s_add_u32 s101, s56, 0xa28000
    s_waitcnt lgkmcnt(7)
    v_mfma_f32_16x16x32_bf16 v[28:31], a[232:235], v[124:127], v[28:31]
    buffer_load_dwordx4 v181, s[32:35], s101 offen offset:0 sc1 lds
    v_mfma_f32_16x16x32_bf16 v[32:35], a[232:235], v[128:131], v[32:35]
    ds_read_b128 v[120:123], v1 offset:19456
    ds_read_b128 v[124:127], v1 offset:20480
    s_waitcnt lgkmcnt(7)
    v_mfma_f32_16x16x32_bf16 v[28:31], a[236:239], v[132:135], v[28:31]
    buffer_load_dwordx4 v181, s[32:35], s101 offen offset:1024 sc1 lds
    v_mfma_f32_16x16x32_bf16 v[32:35], a[236:239], v[136:139], v[32:35]
    ds_read_b128 v[128:131], v1 offset:22528
    ds_read_b128 v[132:135], v1 offset:21504
    s_add_u32 s76, s22, 6
    v_mov_b32 v19, s76
    s_waitcnt vmcnt(7)
    s_mov_b64 exec, 1
    s_cmp_eq_u32 s51, 1
    s_cbranch_scc0 Lslow_65
    buffer_store_dword v19, off, s[32:35], s98
Ljoin_66:
    s_mov_b64 exec, -1
    s_waitcnt lgkmcnt(7)
    v_mfma_f32_16x16x32_bf16 v[28:31], a[240:243], v[140:143], v[28:31]
    ds_read_b128 v[136:139], v1 offset:23552
    s_add_u32 m0, s99, 0x12000
    v_mfma_f32_16x16x32_bf16 v[32:35], a[240:243], v[144:147], v[32:35]
    s_barrier
    ds_read_b128 v[140:143], v1 offset:24576
    s_add_u32 s101, s56, 0xa2a000
    s_waitcnt lgkmcnt(7)
    v_mfma_f32_16x16x32_bf16 v[28:31], a[244:247], v[108:111], v[28:31]
    buffer_load_dwordx4 v181, s[32:35], s101 offen offset:0 sc1 lds
    v_mfma_f32_16x16x32_bf16 v[32:35], a[244:247], v[112:115], v[32:35]
    ds_read_b128 v[144:147], v1 offset:26624
    ds_read_b128 v[108:111], v1 offset:25600
    s_waitcnt lgkmcnt(7)
    v_mfma_f32_16x16x32_bf16 v[28:31], a[248:251], v[116:119], v[28:31]
    buffer_load_dwordx4 v181, s[32:35], s101 offen offset:1024 sc1 lds
    v_mfma_f32_16x16x32_bf16 v[32:35], a[248:251], v[120:123], v[32:35]
    ds_read_b128 v[112:115], v1 offset:27648
    ds_read_b128 v[116:119], v1 offset:28672
    s_waitcnt lgkmcnt(7)
    v_mfma_f32_16x16x32_bf16 v[28:31], a[252:255], v[124:127], v[28:31]
    ds_read_b128 v[120:123], v1 offset:30720
    v_mfma_f32_16x16x32_bf16 v[32:35], a[252:255], v[128:131], v[32:35]
    ds_read_b128 v[124:127], v1 offset:29696
    s_waitcnt lgkmcnt(7)
    v_mfma_f32_16x16x32_bf16 v[28:31], v[196:199], v[132:135], v[28:31]
    ds_read_b128 v[128:131], v1 offset:31744
    v_mfma_f32_16x16x32_bf16 v[32:35], v[196:199], v[136:139], v[32:35]
    s_waitcnt vmcnt(9)
    s_barrier
    ds_read_b128 v[132:135], v1 offset:32768
    s_waitcnt lgkmcnt(7)
    v_mfma_f32_16x16x32_bf16 v[28:31], v[200:203], v[140:143], v[28:31]
    ds_read_b128 v[136:139], v1 offset:34816
    v_mfma_f32_16x16x32_bf16 v[32:35], v[200:203], v[144:147], v[32:35]
    ds_read_b128 v[140:143], v1 offset:33792
    s_waitcnt lgkmcnt(7)
    v_mfma_f32_16x16x32_bf16 v[28:31], v[204:207], v[108:111], v[28:31]
    ds_read_b128 v[144:147], v1 offset:35840
    v_mfma_f32_16x16x32_bf16 v[32:35], v[204:207], v[112:115], v[32:35]
    ds_read_b128 v[108:111], v1 offset:36864
    s_waitcnt lgkmcnt(7)
    v_mfma_f32_16x16x32_bf16 v[28:31], v[208:211], v[116:119], v[28:31]
    ds_read_b128 v[112:115], v1 offset:38912
    v_mfma_f32_16x16x32_bf16 v[32:35], v[208:211], v[120:123], v[32:35]
    ds_read_b128 v[116:119], v1 offset:37888
    s_waitcnt lgkmcnt(7)
    v_mfma_f32_16x16x32_bf16 v[28:31], v[212:215], v[124:127], v[28:31]
    ds_read_b128 v[120:123], v1 offset:39936
    v_mfma_f32_16x16x32_bf16 v[32:35], v[212:215], v[128:131], v[32:35]
    ds_read_b128 v[124:127], v1 offset:40960
    s_waitcnt lgkmcnt(7)
    v_mfma_f32_16x16x32_bf16 v[28:31], v[216:219], v[132:135], v[28:31]
    ds_read_b128 v[128:131], v1 offset:43008
    buffer_load_dword v180, v14, s[32:35], s54 offen sc1
    v_mfma_f32_16x16x32_bf16 v[32:35], v[216:219], v[136:139], v[32:35]
    ds_read_b128 v[132:135], v1 offset:41984
    s_waitcnt lgkmcnt(7)
    v_mfma_f32_16x16x32_bf16 v[28:31], v[220:223], v[140:143], v[28:31]
    ds_read_b128 v[136:139], v1 offset:44032
    v_mfma_f32_16x16x32_bf16 v[32:35], v[220:223], v[144:147], v[32:35]
    ds_read_b128 v[140:143], v1 offset:45056
    s_waitcnt lgkmcnt(7)
    v_mfma_f32_16x16x32_bf16 v[28:31], v[224:227], v[108:111], v[28:31]
    ds_read_b128 v[144:147], v1 offset:47104
    v_mfma_f32_16x16x32_bf16 v[32:35], v[224:227], v[112:115], v[32:35]
    ds_read_b128 v[108:111], v1 offset:46080
    s_waitcnt lgkmcnt(7)
    v_mfma_f32_16x16x32_bf16 v[28:31], v[228:231], v[116:119], v[28:31]
    ds_read_b128 v[112:115], v1 offset:48128
    v_mfma_f32_16x16x32_bf16 v[32:35], v[228:231], v[120:123], v[32:35]
    s_waitcnt vmcnt(6)
    s_barrier
    ds_read_b128 v[116:119], v1 offset:49152
    s_waitcnt lgkmcnt(7)
    v_mfma_f32_16x16x32_bf16 v[28:31], v[252:255], v[124:127], v[28:31]
    ds_read_b128 v[120:123], v1 offset:51200
    v_mfma_f32_16x16x32_bf16 v[32:35], v[252:255], v[128:131], v[32:35]
    ds_read_b128 v[124:127], v1 offset:50176
    s_waitcnt lgkmcnt(7)
    v_mfma_f32_16x16x32_bf16 v[28:31], v[248:251], v[132:135], v[28:31]
    ds_read_b128 v[128:131], v1 offset:52224
    v_mfma_f32_16x16x32_bf16 v[32:35], v[248:251], v[136:139], v[32:35]
    ds_read_b128 v[132:135], v1 offset:53248
    s_waitcnt lgkmcnt(7)
    v_mfma_f32_16x16x32_bf16 v[28:31], v[244:247], v[140:143], v[28:31]
    ds_read_b128 v[136:139], v1 offset:55296
    s_add_u32 s76, s22, 6
    s_waitcnt vmcnt(0)
    s_branch Lpc_69
Lpoll_67:
    buffer_load_dword v180, v14, s[32:35], s54 offen sc1
    s_waitcnt vmcnt(0)
Lpc_69:
    v_subrev_u32 v180, s76, v180
    v_cmp_gt_u32 vcc, 10, v180
    s_nop 1
    s_cmp_eq_u64 vcc, exec
    s_cbranch_scc1 Lpd_68
    s_sub_u32 s61, s61, 1
    s_cmp_lg_u32 s61, 0
    s_cbranch_scc1 Lpoll_67
    s_branch L_end
Lpd_68:
    s_add_u32 m0, s99, 0x0
    s_add_u32 s101, s42, 0x0
    buffer_load_dwordx4 v1, s[32:35], s101 offen offset:0 sc1 lds
    buffer_load_dwordx4 v1, s[32:35], s101 offen offset:1024 sc1 lds
    s_add_u32 s100, s65, 0x800000
    s_mov_b32 s64, s66
    s_add_u32 m0, s99, 0x2000
    s_add_u32 s101, s100, s64
    buffer_load_dwordx4 v181, s[32:35], s101 offen offset:0 sc1 lds
    buffer_load_dwordx4 v181, s[32:35], s101 offen offset:1024 sc1 lds
    s_add_u32 s64, s64, 0x2000
    s_and_b32 s64, s64, 0x7fff
    s_add_u32 m0, s99, 0x4000
    s_add_u32 s101, s100, s64
    buffer_load_dwordx4 v181, s[32:35], s101 offen offset:0 sc1 lds
    buffer_load_dwordx4 v181, s[32:35], s101 offen offset:1024 sc1 lds
    v_mfma_f32_16x16x32_bf16 v[32:35], v[244:247], v[144:147], v[32:35]
    ds_read_b128 v[140:143], v1 offset:54272
    s_add_u32 s64, s64, 0x2000
    s_waitcnt lgkmcnt(7)
    v_mfma_f32_16x16x32_bf16 v[28:31], v[240:243], v[108:111], v[28:31]
    ds_read_b128 v[144:147], v1 offset:56320
    s_and_b32 s64, s64, 0x7fff
    v_mfma_f32_16x16x32_bf16 v[32:35], v[240:243], v[112:115], v[32:35]
    ds_read_b128 v[108:111], v1 offset:57344
    s_add_u32 m0, s99, 0x6000
    s_waitcnt lgkmcnt(7)
    v_mfma_f32_16x16x32_bf16 v[28:31], v[236:239], v[116:119], v[28:31]
    ds_read_b128 v[112:115], v1 offset:59392
    s_add_u32 s101, s100, s64
    v_mfma_f32_16x16x32_bf16 v[32:35], v[236:239], v[120:123], v[32:35]
    buffer_load_dwordx4 v181, s[32:35], s101 offen offset:0 sc1 lds
    s_waitcnt lgkmcnt(6)
    v_mfma_f32_16x16x32_bf16 v[28:31], v[232:235], v[124:127], v[28:31]
    ds_read_b128 v[116:119], v1 offset:58368
    ds_read_b128 v[120:123], v1 offset:60416
    v_mfma_f32_16x16x32_bf16 v[32:35], v[232:235], v[128:131], v[32:35]
    buffer_load_dwordx4 v181, s[32:35], s101 offen offset:1024 sc1 lds
    s_waitcnt lgkmcnt(6)
    v_mfma_f32_16x16x32_bf16 v[28:31], a[128:131], v[132:135], v[28:31]
    ds_read_b128 v[124:127], v1 offset:61440
    ds_read_b128 v[128:131], v1 offset:63488
    v_mfma_f32_16x16x32_bf16 v[32:35], a[128:131], v[136:139], v[32:35]
    ds_read_b128 v[132:135], v1 offset:62464
    s_waitcnt lgkmcnt(7)
    v_mfma_f32_16x16x32_bf16 v[28:31], a[132:135], v[140:143], v[28:31]
    ds_read_b128 v[136:139], v1 offset:64512
    v_mfma_f32_16x16x32_bf16 v[32:35], a[132:135], v[144:147], v[32:35]
    s_barrier
    ds_read_b128 v[140:143], v2 offset:0
    s_waitcnt lgkmcnt(7)
    v_mfma_f32_16x16x32_bf16 v[28:31], a[136:139], v[108:111], v[28:31]
    ds_read_b128 v[144:147], v2 offset:2048
    s_add_u32 s64, s64, 0x2000
    v_mfma_f32_16x16x32_bf16 v[32:35], a[136:139], v[112:115], v[32:35]
    ds_read_b128 v[108:111], v2 offset:1024
    s_and_b32 s64, s64, 0x7fff
    s_waitcnt lgkmcnt(7)
    v_mfma_f32_16x16x32_bf16 v[28:31], a[140:143], v[116:119], v[28:31]
    ds_read_b128 v[112:115], v2 offset:3072
    s_add_u32 m0, s99, 0x8000
    v_mfma_f32_16x16x32_bf16 v[32:35], a[140:143], v[120:123], v[32:35]
    ds_read_b128 v[116:119], v2 offset:4096
    s_add_u32 s101, s100, s64
    s_waitcnt lgkmcnt(7)
    v_mfma_f32_16x16x32_bf16 v[28:31], a[144:147], v[124:127], v[28:31]
    buffer_load_dwordx4 v181, s[32:35], s101 offen offset:0 sc1 lds
    v_mfma_f32_16x16x32_bf16 v[32:35], a[144:147], v[128:131], v[32:35]
    ds_read_b128 v[120:123], v2 offset:6144
    ds_read_b128 v[124:127], v2 offset:5120
    s_waitcnt lgkmcnt(7)
    v_mfma_f32_16x16x32_bf16 v[28:31], a[148:151], v[132:135], v[28:31]
    buffer_load_dwordx4 v181, s[32:35], s101 offen offset:1024 sc1 lds
    v_mfma_f32_16x16x32_bf16 v[32:35], a[148:151], v[136:139], v[32:35]
    ds_read_b128 v[128:131], v2 offset:7168
    ds_read_b128 v[132:135], v2 offset:8192
    s_waitcnt lgkmcnt(7)
    v_mfma_f32_16x16x32_bf16 v[28:31], a[152:155], v[140:143], v[28:31]
    ds_read_b128 v[136:139], v2 offset:10240
    v_mfma_f32_16x16x32_bf16 v[32:35], a[152:155], v[144:147], v[32:35]
    ds_read_b128 v[140:143], v2 offset:9216
    s_waitcnt lgkmcnt(7)
    v_mfma_f32_16x16x32_bf16 v[28:31], a[156:159], v[108:111], v[28:31]
    ds_read_b128 v[144:147], v2 offset:11264
    v_mfma_f32_16x16x32_bf16 v[32:35], a[156:159], v[112:115], v[32:35]
    ds_read_b128 v[108:111], v2 offset:12288
    s_waitcnt lgkmcnt(7)
    v_mfma_f32_16x16x32_bf16 v[28:31], a[160:163], v[116:119], v[28:31]
    ds_read_b128 v[112:115], v2 offset:14336
    v_mfma_f32_16x16x32_bf16 v[32:35], a[160:163], v[120:123], v[32:35]
    s_waitcnt vmcnt(6)
    s_barrier
    ds_read_b128 v[116:119], v1 offset:8192
    s_waitcnt lgkmcnt(7)
    v_mfma_f32_16x16x32_bf16 v[28:31], a[164:167], v[124:127], v[28:31]
    ds_read_b128 v[120:123], v1 offset:10240
    v_mfma_f32_16x16x32_bf16 v[32:35], a[164:167], v[128:131], v[32:35]
    ds_read_b128 v[124:127], v1 offset:9216
    s_waitcnt lgkmcnt(7)
    v_mfma_f32_16x16x32_bf16 v[28:31], a[168:171], v[132:135], v[28:31]
    ds_read_b128 v[128:131], v1 offset:11264
    v_mfma_f32_16x16x32_bf16 v[32:35], a[168:171], v[136:139], v[32:35]
    ds_read_b128 v[132:135], v1 offset:12288
    s_waitcnt lgkmcnt(7)
    v_mfma_f32_16x16x32_bf16 v[28:31], a[172:175], v[140:143], v[28:31]
    ds_read_b128 v[136:139], v1 offset:14336
    v_mfma_f32_16x16x32_bf16 v[32:35], a[172:175], v[144:147], v[32:35]
    ds_read_b128 v[140:143], v1 offset:13312
    s_waitcnt lgkmcnt(7)
    v_mfma_f32_16x16x32_bf16 v[28:31], a[176:179], v[108:111], v[28:31]
    ds_read_b128 v[144:147], v1 offset:15360
    v_mfma_f32_16x16x32_bf16 v[32:35], a[176:179], v[112:115], v[32:35]
    s_waitcnt vmcnt(2)
    s_barrier
    ds_read_b128 v[108:111], v1 offset:16384
    s_waitcnt lgkmcnt(7)
    v_mfma_f32_16x16x32_bf16 v[60:63], v[116:119], a[0:3], 0
    ds_read_b128 v[112:115], v1 offset:18432
    v_mfma_f32_16x16x32_bf16 v[76:79], v[116:119], a[4:7], 0
    s_add_u32 s82, s55, s57
    s_add_u32 s82, s82, 0x808000
    s_add_u32 s83, s41, 8192
    v_cvt_pk_bf16_f32 v158, v28, v29
    v_cvt_pk_bf16_f32 v159, v30, v31
    v_cvt_pk_bf16_f32 v160, v32, v33
    v_cvt_pk_bf16_f32 v161, v34, v35
    v_lshlrev_b32 v184, 16, v158
    v_and_b32 v185, 0xffff0000, v158
    v_lshlrev_b32 v186, 16, v159
    v_and_b32 v187, 0xffff0000, v159
    v_lshlrev_b32 v188, 16, v160
    v_and_b32 v189, 0xffff0000, v160
    v_lshlrev_b32 v190, 16, v161
    v_and_b32 v191, 0xffff0000, v161
    v_permlane16_swap_b32 v158, v160
    v_permlane16_swap_b32 v159, v161
    s_cmp_eq_u32 s51, 1
    s_cbranch_scc0 Lslow_70
    buffer_store_dwordx4 v[158:161], v5, s[32:35], s82 offen offset:0
Ljoin_71:
    v_pk_add_f32 v[162:163], v[184:185], v[186:187]
    v_pk_mul_f32 v[164:165], v[184:185], v[184:185]
    v_pk_add_f32 v[166:167], v[188:189], v[190:191]
    v_pk_mul_f32 v[168:169], v[188:189], v[188:189]
    v_pk_fma_f32 v[164:165], v[186:187], v[186:187], v[164:165]
    v_add_f32 v162, v162, v163
    v_pk_fma_f32 v[168:169], v[190:191], v[190:191], v[168:169]
    v_add_f32 v166, v166, v167
    v_add_f32 v164, v164, v165
    v_add_f32 v168, v168, v169
    v_permlane32_swap_b32 v162, v166
    s_nop 0
    v_permlane32_swap_b32 v164, v168
    v_add_f32 v162, v162, v166
    v_add_f32 v164, v164, v168
    s_nop 1
    v_permlane16_swap_b32 v162, v164
    v_add_f32 v162, v162, v164
    s_cmp_eq_u32 s51, 1
    s_cbranch_scc0 Lslow_72
    buffer_store_dword v162, v15, s[32:35], s83 offen
Ljoin_73:
    v_mfma_f32_16x16x32_bf16 v[64:67], v[120:123], a[0:3], 0
    ds_read_b128 v[116:119], v1 offset:17408
    v_mfma_f32_16x16x32_bf16 v[80:83], v[120:123], a[4:7], 0
    s_waitcnt lgkmcnt(7)
    v_mfma_f32_16x16x32_bf16 v[60:63], v[124:127], a[8:11], v[60:63]
    ds_read_b128 v[120:123], v1 offset:19456
    v_add_u32 v156, 0x0, v8
    v_mfma_f32_16x16x32_bf16 v[76:79], v[124:127], a[12:15], v[76:79]
    ds_read2st64_b32 v[184:185], v156 offset0:0 offset1:1
    v_mfma_f32_16x16x32_bf16 v[64:67], v[128:131], a[8:11], v[64:67]
    ds_read_b128 v[124:127], v1 offset:20480
    ds_read2st64_b32 v[186:187], v156 offset0:2 offset1:3
    v_mfma_f32_16x16x32_bf16 v[80:83], v[128:131], a[12:15], v[80:83]
    ds_read2st64_b32 v[188:189], v156 offset0:4 offset1:5
    ds_read2st64_b32 v[190:191], v156 offset0:6 offset1:7
    s_waitcnt lgkmcnt(11)
    v_mfma_f32_16x16x32_bf16 v[60:63], v[132:135], a[16:19], v[60:63]
    ds_read_b128 v[128:131], v1 offset:22528
    v_mfma_f32_16x16x32_bf16 v[76:79], v[132:135], a[20:23], v[76:79]
    v_mfma_f32_16x16x32_bf16 v[64:67], v[136:139], a[16:19], v[64:67]
    ds_read_b128 v[132:135], v1 offset:21504
    v_mfma_f32_16x16x32_bf16 v[80:83], v[136:139], a[20:23], v[80:83]
    s_waitcnt lgkmcnt(11)
    v_mfma_f32_16x16x32_bf16 v[60:63], v[140:143], a[24:27], v[60:63]
    ds_read_b128 v[136:139], v1 offset:23552
    v_mfma_f32_16x16x32_bf16 v[76:79], v[140:143], a[28:31], v[76:79]
    v_mfma_f32_16x16x32_bf16 v[64:67], v[144:147], a[24:27], v[64:67]
    ds_read_b128 v[140:143], v1 offset:24576
    s_waitcnt lgkmcnt(4)
    v_mfma_f32_16x16x32_bf16 v[80:83], v[144:147], a[28:31], v[80:83]
    v_add_f32 v184, v184, v188
    v_add_f32 v185, v185, v189
    v_mfma_f32_16x16x32_bf16 v[60:63], v[108:111], a[32:35], v[60:63]
    ds_read_b128 v[144:147], v1 offset:26624
    v_add_f32 v186, v186, v190
    v_mfma_f32_16x16x32_bf16 v[76:79], v[108:111], a[36:39], v[76:79]
    v_add_f32 v187, v187, v191
    v_add_f32 v184, v184, v186
    v_mfma_f32_16x16x32_bf16 v[64:67], v[112:115], a[32:35], v[64:67]
    ds_read_b128 v[108:111], v1 offset:25600
    v_add_f32 v185, v185, v187
    v_mfma_f32_16x16x32_bf16 v[80:83], v[112:115], a[36:39], v[80:83]
    v_add_f32 v184, v184, v185
    ds_write_b32 v177, v184 offset:0
    v_mfma_f32_16x16x32_bf16 v[60:63], v[116:119], a[40:43], v[60:63]
    ds_read_b128 v[112:115], v1 offset:27648
    v_mfma_f32_16x16x32_bf16 v[76:79], v[116:119], a[44:47], v[76:79]
    s_add_u32 s76, s22, 7
    v_mov_b32 v19, s76
    s_waitcnt vmcnt(0)
    s_mov_b64 exec, 1
    s_cmp_eq_u32 s51, 1
    s_cbranch_scc0 Lslow_74
    buffer_store_dword v19, off, s[32:35], s98
Ljoin_75:
    s_mov_b64 exec, -1
    v_mfma_f32_16x16x32_bf16 v[64:67], v[120:123], a[40:43], v[64:67]
    ds_read_b128 v[116:119], v1 offset:28672
    v_mfma_f32_16x16x32_bf16 v[80:83], v[120:123], a[44:47], v[80:83]
    s_waitcnt lgkmcnt(8)
    v_mfma_f32_16x16x32_bf16 v[60:63], v[124:127], a[48:51], v[60:63]
    ds_read_b128 v[120:123], v1 offset:30720
    v_mfma_f32_16x16x32_bf16 v[76:79], v[124:127], a[52:55], v[76:79]
    v_mfma_f32_16x16x32_bf16 v[64:67], v[128:131], a[48:51], v[64:67]
    ds_read_b128 v[124:127], v1 offset:29696
    v_mfma_f32_16x16x32_bf16 v[80:83], v[128:131], a[52:55], v[80:83]
    s_waitcnt lgkmcnt(8)
    v_mfma_f32_16x16x32_bf16 v[60:63], v[132:135], a[56:59], v[60:63]
    ds_read_b128 v[128:131], v1 offset:31744
    v_mfma_f32_16x16x32_bf16 v[76:79], v[132:135], a[60:63], v[76:79]
    v_mfma_f32_16x16x32_bf16 v[64:67], v[136:139], a[56:59], v[64:67]
    s_waitcnt lgkmcnt(5)
    s_barrier
    ds_read_b128 v[132:135], v1 offset:32768
    ds_read2st64_b32 v[184:185], v9 offset0:0 offset1:1
    v_mfma_f32_16x16x32_bf16 v[80:83], v[136:139], a[60:63], v[80:83]
    ds_read2st64_b32 v[186:187], v9 offset0:2 offset1:3
    v_mfma_f32_16x16x32_bf16 v[60:63], v[140:143], a[64:67], v[60:63]
    ds_read_b128 v[136:139], v1 offset:34816
    v_mfma_f32_16x16x32_bf16 v[76:79], v[140:143], a[68:71], v[76:79]
    v_mfma_f32_16x16x32_bf16 v[64:67], v[144:147], a[64:67], v[64:67]
    ds_read_b128 v[140:143], v1 offset:33792
    v_mfma_f32_16x16x32_bf16 v[80:83], v[144:147], a[68:71], v[80:83]
    s_waitcnt lgkmcnt(9)
    v_mfma_f32_16x16x32_bf16 v[60:63], v[108:111], a[72:75], v[60:63]
    ds_read_b128 v[144:147], v1 offset:35840
    v_mfma_f32_16x16x32_bf16 v[76:79], v[108:111], a[76:79], v[76:79]
    s_waitcnt lgkmcnt(3)
    v_add_f32 v184, v184, v186
    v_mfma_f32_16x16x32_bf16 v[64:67], v[112:115], a[72:75], v[64:67]
    ds_read_b128 v[108:111], v1 offset:36864
    v_add_f32 v185, v185, v187
    v_mfma_f32_16x16x32_bf16 v[80:83], v[112:115], a[76:79], v[80:83]
    v_add_f32 v184, v184, v185
    v_mul_f32 v184, 0x3b000000, v184
    v_mfma_f32_16x16x32_bf16 v[60:63], v[116:119], a[80:83], v[60:63]
    ds_read_b128 v[112:115], v1 offset:38912
    v_mov_b32 v185, v184
    v_mfma_f32_16x16x32_bf16 v[76:79], v[116:119], a[84:87], v[76:79]
    v_mfma_f32_16x16x32_bf16 v[64:67], v[120:123], a[80:83], v[64:67]
    ds_read_b128 v[116:119], v1 offset:37888
    v_permlane16_swap_b32 v184, v185
    v_mfma_f32_16x16x32_bf16 v[80:83], v[120:123], a[84:87], v[80:83]
    v_mfma_f32_16x16x32_bf16 v[60:63], v[124:127], a[88:91], v[60:63]
    ds_read_b128 v[120:123], v1 offset:39936
    v_fma_f32 v185, -v184, v184, v185
    v_mfma_f32_16x16x32_bf16 v[76:79], v[124:127], a[92:95], v[76:79]
    v_max_f32 v185, 0, v185
    v_add_f32 v185, 0x3727c5ac, v185
    v_mfma_f32_16x16x32_bf16 v[64:67], v[128:131], a[88:91], v[64:67]
    v_rsq_f32 v148, v185
    v_mfma_f32_16x16x32_bf16 v[80:83], v[128:131], a[92:95], v[80:83]
    v_mul_f32_e64 v149, -v184, v148
    s_mov_b32 exec_lo, 0xffff
    s_mov_b32 exec_hi, 0xffff
    ds_write_b32 v10, v148
    ds_write_b32 v10, v149 offset:128
    s_mov_b64 exec, -1
    s_waitcnt lgkmcnt(8)
    v_mfma_f32_16x16x32_bf16 v[60:63], v[132:135], a[96:99], v[60:63]
    v_mov_b32 v150, v148
    v_mov_b32 v151, v149
    v_mfma_f32_16x16x32_bf16 v[76:79], v[132:135], a[100:103], v[76:79]
    buffer_load_dword v180, v14, s[32:35], s54 offen sc1
    v_mfma_f32_16x16x32_bf16 v[64:67], v[136:139], a[96:99], v[64:67]
    v_permlane32_swap_b32 v148, v150
    v_permlane32_swap_b32 v149, v151
    v_mfma_f32_16x16x32_bf16 v[80:83], v[136:139], a[100:103], v[80:83]
    s_waitcnt lgkmcnt(6)
    v_mfma_f32_16x16x32_bf16 v[60:63], v[140:143], a[104:107], v[60:63]
    v_mfma_f32_16x16x32_bf16 v[76:79], v[140:143], a[108:111], v[76:79]
    v_mfma_f32_16x16x32_bf16 v[64:67], v[144:147], a[104:107], v[64:67]
    v_mfma_f32_16x16x32_bf16 v[80:83], v[144:147], a[108:111], v[80:83]
    s_waitcnt lgkmcnt(4)
    v_mfma_f32_16x16x32_bf16 v[60:63], v[108:111], a[112:115], v[60:63]
    v_mfma_f32_16x16x32_bf16 v[76:79], v[108:111], a[116:119], v[76:79]
    v_mfma_f32_16x16x32_bf16 v[64:67], v[112:115], a[112:115], v[64:67]
    v_mfma_f32_16x16x32_bf16 v[80:83], v[112:115], a[116:119], v[80:83]
    s_waitcnt lgkmcnt(2)
    v_mfma_f32_16x16x32_bf16 v[60:63], v[116:119], a[120:123], v[60:63]
    v_mfma_f32_16x16x32_bf16 v[76:79], v[116:119], a[124:127], v[76:79]
    v_mfma_f32_16x16x32_bf16 v[64:67], v[120:123], a[120:123], v[64:67]
    v_mfma_f32_16x16x32_bf16 v[80:83], v[120:123], a[124:127], v[80:83]
    ds_read_b128 v[108:111], v17 offset:0
    ds_read_b128 v[112:115], v17 offset:64
    ds_read_b128 v[116:119], v17 offset:128
    ds_read_b128 v[120:123], v17 offset:192
    s_add_u32 s76, s22, 7
    s_waitcnt vmcnt(0)
    s_branch Lpc_78
Lpoll_76:
    buffer_load_dword v180, v14, s[32:35], s54 offen sc1
    s_waitcnt vmcnt(0)
Lpc_78:
    v_subrev_u32 v180, s76, v180
    v_cmp_gt_u32 vcc, 9, v180
    s_nop 1
    s_cmp_eq_u64 vcc, exec
    s_cbranch_scc1 Lpd_77
    s_sub_u32 s61, s61, 1
    s_cmp_lg_u32 s61, 0
    s_cbranch_scc1 Lpoll_76
    s_branch L_end
Lpd_77:
    s_add_u32 s100, s65, 0x808000
    s_mov_b32 s64, s66
    s_add_u32 m0, s99, 0xc000
    s_add_u32 s101, s100, s64
    buffer_load_dwordx4 v181, s[32:35], s101 offen offset:0 sc1 lds
    buffer_load_dwordx4 v181, s[32:35], s101 offen offset:1024 sc1 lds
    s_add_u32 s64, s64, 0x2000
    s_and_b32 s64, s64, 0x7fff
    s_add_u32 m0, s99, 0xe000
    s_add_u32 s101, s100, s64
    buffer_load_dwordx4 v181, s[32:35], s101 offen offset:0 sc1 lds
    buffer_load_dwordx4 v181, s[32:35], s101 offen offset:1024 sc1 lds
    s_add_u32 m0, s99, 0xa000
    s_add_u32 s101, s42, 0x2000
    buffer_load_dwordx4 v1, s[32:35], s101 offen offset:0 sc1 lds
    buffer_load_dwordx4 v1, s[32:35], s101 offen offset:1024 sc1 lds
    s_waitcnt lgkmcnt(0)
    v_pk_fma_f32 v[156:157], v[116:117], v[40:41], v[182:183] op_sel:[0,0,1] op_sel_hi:[1,1,1]
    v_pk_mul_f32 v[164:165], v[116:117], v[42:43]
    v_pk_fma_f32 v[158:159], v[118:119], v[40:41], v[182:183] op_sel:[0,0,1] op_sel_hi:[1,1,1]
    v_pk_mul_f32 v[166:167], v[118:119], v[42:43]
    v_pk_fma_f32 v[160:161], v[120:121], v[40:41], v[182:183] op_sel:[0,0,1] op_sel_hi:[1,1,1]
    v_pk_mul_f32 v[168:169], v[120:121], v[42:43]
    v_pk_fma_f32 v[162:163], v[122:123], v[40:41], v[182:183] op_sel:[0,0,1] op_sel_hi:[1,1,1]
    v_pk_mul_f32 v[170:171], v[122:123], v[42:43]
    v_pk_fma_f32 v[60:61], v[108:109], v[60:61], v[156:157]
    v_pk_fma_f32 v[76:77], v[108:109], v[76:77], v[164:165]
    v_pk_fma_f32 v[62:63], v[110:111], v[62:63], v[158:159]
    v_pk_fma_f32 v[78:79], v[110:111], v[78:79], v[166:167]
    v_pk_fma_f32 v[64:65], v[112:113], v[64:65], v[160:161]
    v_pk_fma_f32 v[80:81], v[112:113], v[80:81], v[168:169]
    v_pk_fma_f32 v[66:67], v[114:115], v[66:67], v[162:163]
    s_add_u32 s64, s64, 0x2000
    s_and_b32 s64, s64, 0x7fff
    s_add_u32 m0, s99, 0x10000
    s_add_u32 s101, s100, s64
    buffer_load_dwordx4 v181, s[32:35], s101 offen offset:0 sc1 lds
    v_pk_fma_f32 v[82:83], v[114:115], v[82:83], v[170:171]
    v_cvt_pk_bf16_f32 v76, v76, v77
    v_cvt_pk_bf16_f32 v77, v78, v79
    v_cvt_pk_bf16_f32 v78, v80, v81
    v_cvt_pk_bf16_f32 v79, v82, v83
    v_pk_mul_f32 v[156:157], v[60:61], v[182:183] op_sel:[0,0] op_sel_hi:[1,0]
    v_pk_mul_f32 v[158:159], v[62:63], v[182:183] op_sel:[0,0] op_sel_hi:[1,0]
    v_pk_mul_f32 v[160:161], v[64:65], v[182:183] op_sel:[0,0] op_sel_hi:[1,0]
    v_pk_mul_f32 v[162:163], v[66:67], v[182:183] op_sel:[0,0] op_sel_hi:[1,0]
    v_exp_f32_e64 v156, v156 clamp
    v_max_f32 v60, v183, v60
    v_exp_f32_e64 v157, v157 clamp
    v_max_f32 v61, v183, v61
    buffer_load_dwordx4 v181, s[32:35], s101 offen offset:1024 sc1 lds
    v_exp_f32_e64 v158, v158 clamp
    v_max_f32 v62, v183, v62
    v_exp_f32_e64 v159, v159 clamp
    v_max_f32 v63, v183, v63
    v_exp_f32_e64 v160, v160 clamp
    v_max_f32 v64, v183, v64
    v_exp_f32_e64 v161, v161 clamp
    v_max_f32 v65, v183, v65
    v_exp_f32_e64 v162, v162 clamp
    v_max_f32 v66, v183, v66
    s_add_u32 s64, s64, 0x2000
    s_and_b32 s64, s64, 0x7fff
    s_add_u32 m0, s99, 0x12000
    s_add_u32 s101, s100, s64
    buffer_load_dwordx4 v181, s[32:35], s101 offen offset:0 sc1 lds
    v_exp_f32_e64 v163, v163 clamp
    v_max_f32 v67, v183, v67
    v_pk_add_f32 v[60:61], v[60:61], v[156:157]
    v_pk_add_f32 v[62:63], v[62:63], v[158:159]
    v_pk_add_f32 v[64:65], v[64:65], v[160:161]
    v_pk_add_f32 v[66:67], v[66:67], v[162:163]
    v_cvt_pk_bf16_f32 v60, v60, v61
    v_cvt_pk_bf16_f32 v61, v62, v63
    v_cvt_pk_bf16_f32 v62, v64, v65
    v_cvt_pk_bf16_f32 v63, v66, v67
    s_waitcnt vmcnt(5)
    s_barrier
    ds_read_b128 v[108:111], v1 offset:49152
    ds_read_b128 v[112:115], v1 offset:51200
    ds_read_b128 v[116:119], v1 offset:50176
    ds_read_b128 v[120:123], v1 offset:52224
    ds_read_b128 v[124:127], v1 offset:53248
    ds_read_b128 v[128:131], v1 offset:55296
    ds_read_b128 v[132:135], v1 offset:54272
    ds_read_b128 v[136:139], v1 offset:56320
    s_waitcnt lgkmcnt(6)
    v_mfma_f32_16x16x32_bf16 v[68:71], v[108:111], a[0:3], 0
    buffer_load_dwordx4 v181, s[32:35], s101 offen offset:1024 sc1 lds
    v_mfma_f32_16x16x32_bf16 v[84:87], v[108:111], a[4:7], 0
    ds_read_b128 v[140:143], v1 offset:57344
    s_add_u32 s96, s52, 0x0
    v_mfma_f32_16x16x32_bf16 v[72:75], v[112:115], a[0:3], 0
    ds_read_b128 v[144:147], v1 offset:59392
    v_add_u32 v156, 0xa000, v8
    v_mfma_f32_16x16x32_bf16 v[88:91], v[112:115], a[4:7], 0
    buffer_load_dwordx4 a[180:183], v1, s[32:35], s96 offen offset:0 sc1
    s_waitcnt lgkmcnt(6)
    v_mfma_f32_16x16x32_bf16 v[68:71], v[116:119], a[8:11], v[68:71]
    ds_read_b128 v[108:111], v1 offset:58368
    s_waitcnt vmcnt(5)
    v_mfma_f32_16x16x32_bf16 v[84:87], v[116:119], a[12:15], v[84:87]
    ds_read2st64_b32 v[184:185], v156 offset0:0 offset1:1
    ds_read2st64_b32 v[186:187], v156 offset0:2 offset1:3
    v_mfma_f32_16x16x32_bf16 v[72:75], v[120:123], a[8:11], v[72:75]
    ds_read_b128 v[112:115], v1 offset:60416
    ds_read2st64_b32 v[188:189], v156 offset0:4 offset1:5
    v_mfma_f32_16x16x32_bf16 v[88:91], v[120:123], a[12:15], v[88:91]
    buffer_load_dwordx4 a[184:187], v1, s[32:35], s96 offen offset:1024 sc1
    s_waitcnt lgkmcnt(9)
    v_mfma_f32_16x16x32_bf16 v[68:71], v[124:127], a[16:19], v[68:71]
    ds_read_b128 v[116:119], v1 offset:61440
    ds_read2st64_b32 v[190:191], v156 offset0:6 offset1:7
    v_mfma_f32_16x16x32_bf16 v[84:87], v[124:127], a[20:23], v[84:87]
    v_mfma_f32_16x16x32_bf16 v[72:75], v[128:131], a[16:19], v[72:75]
    ds_read_b128 v[120:123], v1 offset:63488
    v_mfma_f32_16x16x32_bf16 v[88:91], v[128:131], a[20:23], v[88:91]
    buffer_load_dwordx4 a[188:191], v1, s[32:35], s96 offen offset:2048 sc1
    s_waitcnt lgkmcnt(10)
    v_mfma_f32_16x16x32_bf16 v[68:71], v[132:135], a[24:27], v[68:71]
    ds_read_b128 v[124:127], v1 offset:62464
    v_mfma_f32_16x16x32_bf16 v[84:87], v[132:135], a[28:31], v[84:87]
    v_mfma_f32_16x16x32_bf16 v[72:75], v[136:139], a[24:27], v[72:75]
    ds_read_b128 v[128:131], v1 offset:64512
    v_mfma_f32_16x16x32_bf16 v[88:91], v[136:139], a[28:31], v[88:91]
    buffer_load_dwordx4 a[192:195], v1, s[32:35], s96 offen offset:3072 sc1
    s_waitcnt lgkmcnt(10)
    v_mfma_f32_16x16x32_bf16 v[68:71], v[140:143], a[32:35], v[68:71]
    s_waitcnt lgkmcnt(3)
    v_add_f32 v184, v184, v188
    v_add_f32 v185, v185, v189
    v_add_f32 v186, v186, v190
    v_add_f32 v187, v187, v191
    v_add_f32 v184, v184, v186
    v_add_f32 v185, v185, v187
    v_add_f32 v184, v184, v185
    ds_write_b32 v177, v184 offset:1024
    s_waitcnt lgkmcnt(0)
    s_waitcnt vmcnt(4)
    s_barrier
    ds_read_b128 v[132:135], v2 offset:0
    s_add_u32 s96, s52, 0x1000
    ds_read2st64_b32 v[184:185], v9 offset0:4 offset1:5
    v_mfma_f32_16x16x32_bf16 v[84:87], v[140:143], a[36:39], v[84:87]
    ds_read2st64_b32 v[186:187], v9 offset0:6 offset1:7
    v_mfma_f32_16x16x32_bf16 v[72:75], v[144:147], a[32:35], v[72:75]
    ds_read_b128 v[136:139], v2 offset:2048
    v_mfma_f32_16x16x32_bf16 v[88:91], v[144:147], a[36:39], v[88:91]
    buffer_load_dwordx4 a[0:3], v1, s[32:35], s96 offen offset:0 sc1
    v_mfma_f32_16x16x32_bf16 v[68:71], v[108:111], a[40:43], v[68:71]
    ds_read_b128 v[140:143], v2 offset:1024
    v_mfma_f32_16x16x32_bf16 v[84:87], v[108:111], a[44:47], v[84:87]
    v_mfma_f32_16x16x32_bf16 v[72:75], v[112:115], a[40:43], v[72:75]
    ds_read_b128 v[144:147], v2 offset:3072
    v_mfma_f32_16x16x32_bf16 v[88:91], v[112:115], a[44:47], v[88:91]
    buffer_load_dwordx4 a[4:7], v1, s[32:35], s96 offen offset:1024 sc1
    v_mfma_f32_16x16x32_bf16 v[68:71], v[116:119], a[48:51], v[68:71]
    ds_read_b128 v[108:111], v2 offset:4096
    v_mfma_f32_16x16x32_bf16 v[84:87], v[116:119], a[52:55], v[84:87]
    s_waitcnt lgkmcnt(4)
    v_add_f32 v184, v184, v186
    v_mfma_f32_16x16x32_bf16 v[72:75], v[120:123], a[48:51], v[72:75]
    ds_read_b128 v[112:115], v2 offset:6144
    v_add_f32 v185, v185, v187
    v_mfma_f32_16x16x32_bf16 v[88:91], v[120:123], a[52:55], v[88:91]
    buffer_load_dwordx4 a[8:11], v1, s[32:35], s96 offen offset:2048 sc1
    v_mfma_f32_16x16x32_bf16 v[68:71], v[124:127], a[56:59], v[68:71]
    ds_read_b128 v[116:119], v2 offset:5120
    v_add_f32 v184, v184, v185
    v_mfma_f32_16x16x32_bf16 v[84:87], v[124:127], a[60:63], v[84:87]
    v_mul_f32 v184, 0x3b000000, v184
    v_mov_b32 v185, v184
    v_mfma_f32_16x16x32_bf16 v[72:75], v[128:131], a[56:59], v[72:75]
    ds_read_b128 v[120:123], v2 offset:7168
    v_mfma_f32_16x16x32_bf16 v[88:91], v[128:131], a[60:63], v[88:91]
    buffer_load_dwordx4 a[12:15], v1, s[32:35], s96 offen offset:3072 sc1
    s_waitcnt lgkmcnt(6)
    v_mfma_f32_16x16x32_bf16 v[68:71], v[132:135], a[64:67], v[68:71]
    ds_read_b128 v[124:127], v2 offset:8192
    s_add_u32 s96, s52, 0x2000
    v_permlane16_swap_b32 v184, v185
    v_mfma_f32_16x16x32_bf16 v[84:87], v[132:135], a[68:71], v[84:87]
    v_mfma_f32_16x16x32_bf16 v[72:75], v[136:139], a[64:67], v[72:75]
    ds_read_b128 v[128:131], v2 offset:10240
    v_fma_f32 v185, -v184, v184, v185
    v_mfma_f32_16x16x32_bf16 v[88:91], v[136:139], a[68:71], v[88:91]
    buffer_load_dwordx4 a[16:19], v1, s[32:35], s96 offen offset:0 sc1
    s_waitcnt lgkmcnt(6)
    v_mfma_f32_16x16x32_bf16 v[68:71], v[140:143], a[72:75], v[68:71]
    ds_read_b128 v[132:135], v2 offset:9216
    v_max_f32 v185, 0, v185
    v_mfma_f32_16x16x32_bf16 v[84:87], v[140:143], a[76:79], v[84:87]
    v_add_f32 v185, 0x3727c5ac, v185
    v_rsq_f32 v152, v185
    v_mfma_f32_16x16x32_bf16 v[72:75], v[144:147], a[72:75], v[72:75]
    ds_read_b128 v[136:139], v2 offset:11264
    v_mfma_f32_16x16x32_bf16 v[88:91], v[144:147], a[76:79], v[88:91]
    buffer_load_dwordx4 a[20:23], v1, s[32:35], s96 offen offset:1024 sc1
    s_waitcnt lgkmcnt(6)
    v_mfma_f32_16x16x32_bf16 v[68:71], v[108:111], a[80:83], v[68:71]
    ds_read_b128 v[140:143], v2 offset:12288
    v_mul_f32_e64 v153, -v184, v152
    v_mfma_f32_16x16x32_bf16 v[84:87], v[108:111], a[84:87], v[84:87]
    s_mov_b32 exec_lo, 0xffff
    s_mov_b32 exec_hi, 0xffff
    ds_write_b32 v10, v152
    ds_write_b32 v10, v153 offset:128
    s_mov_b64 exec, -1
    v_mov_b32 v154, v152
    v_mfma_f32_16x16x32_bf16 v[72:75], v[112:115], a[80:83], v[72:75]
    ds_read_b128 v[144:147], v2 offset:14336
    v_mov_b32 v155, v153
    v_mfma_f32_16x16x32_bf16 v[88:91], v[112:115], a[84:87], v[88:91]
    buffer_load_dwordx4 a[24:27], v1, s[32:35], s96 offen offset:2048 sc1
    s_waitcnt lgkmcnt(8)
    v_mfma_f32_16x16x32_bf16 v[68:71], v[116:119], a[88:91], v[68:71]
    ds_read_b128 v[108:111], v2 offset:13312
    v_mfma_f32_16x16x32_bf16 v[84:87], v[116:119], a[92:95], v[84:87]
    v_permlane32_swap_b32 v152, v154
    v_permlane32_swap_b32 v153, v155
    v_mfma_f32_16x16x32_bf16 v[72:75], v[120:123], a[88:91], v[72:75]
    ds_read_b128 v[112:115], v2 offset:15360
    v_mfma_f32_16x16x32_bf16 v[88:91], v[120:123], a[92:95], v[88:91]
    buffer_load_dwordx4 a[28:31], v1, s[32:35], s96 offen offset:3072 sc1
    s_waitcnt lgkmcnt(8)
    v_mfma_f32_16x16x32_bf16 v[68:71], v[124:127], a[96:99], v[68:71]
    s_add_u32 s96, s52, 0x3000
    v_mfma_f32_16x16x32_bf16 v[84:87], v[124:127], a[100:103], v[84:87]
    v_mfma_f32_16x16x32_bf16 v[72:75], v[128:131], a[96:99], v[72:75]
    v_mfma_f32_16x16x32_bf16 v[88:91], v[128:131], a[100:103], v[88:91]
    buffer_load_dwordx4 a[32:35], v1, s[32:35], s96 offen offset:0 sc1
    s_waitcnt lgkmcnt(6)
    v_mfma_f32_16x16x32_bf16 v[68:71], v[132:135], a[104:107], v[68:71]
    v_mfma_f32_16x16x32_bf16 v[84:87], v[132:135], a[108:111], v[84:87]
    v_mfma_f32_16x16x32_bf16 v[72:75], v[136:139], a[104:107], v[72:75]
    v_mfma_f32_16x16x32_bf16 v[88:91], v[136:139], a[108:111], v[88:91]
    buffer_load_dwordx4 a[36:39], v1, s[32:35], s96 offen offset:1024 sc1
    s_waitcnt lgkmcnt(2)
    v_mfma_f32_16x16x32_bf16 v[68:71], v[140:143], a[112:115], v[68:71]
    v_mfma_f32_16x16x32_bf16 v[84:87], v[140:143], a[116:119], v[84:87]
    v_mfma_f32_16x16x32_bf16 v[72:75], v[144:147], a[112:115], v[72:75]
    v_mfma_f32_16x16x32_bf16 v[88:91], v[144:147], a[116:119], v[88:91]
    buffer_load_dwordx4 a[40:43], v1, s[32:35], s96 offen offset:2048 sc1
    s_waitcnt lgkmcnt(0)
    v_mfma_f32_16x16x32_bf16 v[68:71], v[108:111], a[120:123], v[68:71]
    v_mfma_f32_16x16x32_bf16 v[84:87], v[108:111], a[124:127], v[84:87]
    v_mfma_f32_16x16x32_bf16 v[72:75], v[112:115], a[120:123], v[72:75]
    v_mfma_f32_16x16x32_bf16 v[88:91], v[112:115], a[124:127], v[88:91]
    buffer_load_dwordx4 a[44:47], v1, s[32:35], s96 offen offset:3072 sc1
    ds_read_b128 v[108:111], v17 offset:0
    ds_read_b128 v[112:115], v17 offset:64
    ds_read_b128 v[116:119], v17 offset:128
    ds_read_b128 v[120:123], v17 offset:192
    s_waitcnt lgkmcnt(0)
    v_pk_fma_f32 v[156:157], v[116:117], v[40:41], v[182:183] op_sel:[0,0,1] op_sel_hi:[1,1,1]
    v_pk_mul_f32 v[164:165], v[116:117], v[42:43]
    v_pk_fma_f32 v[158:159], v[118:119], v[40:41], v[182:183] op_sel:[0,0,1] op_sel_hi:[1,1,1]
    v_pk_mul_f32 v[166:167], v[118:119], v[42:43]
    v_pk_fma_f32 v[160:161], v[120:121], v[40:41], v[182:183] op_sel:[0,0,1] op_sel_hi:[1,1,1]
    v_pk_mul_f32 v[168:169], v[120:121], v[42:43]
    v_pk_fma_f32 v[162:163], v[122:123], v[40:41], v[182:183] op_sel:[0,0,1] op_sel_hi:[1,1,1]
    v_pk_mul_f32 v[170:171], v[122:123], v[42:43]
    v_pk_fma_f32 v[68:69], v[108:109], v[68:69], v[156:157]
    v_pk_fma_f32 v[84:85], v[108:109], v[84:85], v[164:165]
    v_pk_fma_f32 v[70:71], v[110:111], v[70:71], v[158:159]
    v_pk_fma_f32 v[86:87], v[110:111], v[86:87], v[166:167]
    v_pk_fma_f32 v[72:73], v[112:113], v[72:73], v[160:161]
    v_pk_fma_f32 v[88:89], v[112:113], v[88:89], v[168:169]
    s_add_u32 s96, s52, 0xd000
    buffer_load_dwordx4 a[48:51], v192, s[32:35], s96 offen offset:0 sc1
    v_pk_fma_f32 v[74:75], v[114:115], v[74:75], v[162:163]
    v_pk_fma_f32 v[90:91], v[114:115], v[90:91], v[170:171]
    v_cvt_pk_bf16_f32 v84, v84, v85
    v_cvt_pk_bf16_f32 v85, v86, v87
    v_cvt_pk_bf16_f32 v86, v88, v89
    v_cvt_pk_bf16_f32 v87, v90, v91
    v_pk_mul_f32 v[156:157], v[68:69], v[182:183] op_sel:[0,0] op_sel_hi:[1,0]
    v_pk_mul_f32 v[158:159], v[70:71], v[182:183] op_sel:[0,0] op_sel_hi:[1,0]
    v_pk_mul_f32 v[160:161], v[72:73], v[182:183] op_sel:[0,0] op_sel_hi:[1,0]
    v_pk_mul_f32 v[162:163], v[74:75], v[182:183] op_sel:[0,0] op_sel_hi:[1,0]
    v_exp_f32_e64 v156, v156 clamp
    v_max_f32 v68, v183, v68
    v_exp_f32_e64 v157, v157 clamp
    v_max_f32 v69, v183, v69
    buffer_load_dwordx4 a[52:55], v193, s[32:35], s96 offen offset:1024 sc1
    v_exp_f32_e64 v158, v158 clamp
    v_max_f32 v70, v183, v70
    v_exp_f32_e64 v159, v159 clamp
    v_max_f32 v71, v183, v71
    v_exp_f32_e64 v160, v160 clamp
    v_max_f32 v72, v183, v72
    v_exp_f32_e64 v161, v161 clamp
    v_max_f32 v73, v183, v73
    v_exp_f32_e64 v162, v162 clamp
    v_max_f32 v74, v183, v74
    v_exp_f32_e64 v163, v163 clamp
    buffer_load_dwordx4 a[56:59], v194, s[32:35], s96 offen offset:2048 sc1
    v_max_f32 v75, v183, v75
    v_pk_add_f32 v[68:69], v[68:69], v[156:157]
    v_pk_add_f32 v[70:71], v[70:71], v[158:159]
    v_pk_add_f32 v[72:73], v[72:73], v[160:161]
    v_pk_add_f32 v[74:75], v[74:75], v[162:163]
    v_cvt_pk_bf16_f32 v68, v68, v69
    v_cvt_pk_bf16_f32 v69, v70, v71
    v_cvt_pk_bf16_f32 v70, v72, v73
    v_cvt_pk_bf16_f32 v71, v74, v75
    v_mfma_f32_16x16x32_bf16 v[184:187], v[60:63], v[76:79], 0
    v_mfma_f32_16x16x32_bf16 v[188:191], v[60:63], v[56:59], 0
    v_mfma_f32_16x16x32_bf16 v[184:187], v[68:71], v[84:87], v[184:187]
    v_mfma_f32_16x16x32_bf16 v[188:191], v[68:71], v[56:59], v[188:191]
    s_add_u32 s88, s53, 86016
    s_and_b32 s89, s48, 1
    s_mul_i32 s89, s89, 1344
    s_add_u32 s89, s89, s88
    s_nop 2
    ds_write_b32 v172, v184
    ds_write_b32 v173, v185
    ds_write_b32 v174, v186
    ds_write_b32 v175, v187
    s_mov_b32 exec_lo, 0x00010001
    s_mov_b32 exec_hi, 0x00010001
    ds_write_b128 v176, v[188:191]
    s_mov_b64 exec, -1
    ds_read_b32 v156, v3 offset:0
    ds_read_b32 v157, v3 offset:256
    ds_read_b32 v158, v3 offset:512
    ds_read_b32 v159, v3 offset:768
    ds_read_b32 v160, v3 offset:1024
    s_waitcnt lgkmcnt(4)
    buffer_atomic_add_f32 v156, v15, s[32:35], s89 offen offset:0
    s_waitcnt lgkmcnt(3)
    buffer_atomic_add_f32 v157, v15, s[32:35], s89 offen offset:256
    s_waitcnt lgkmcnt(2)
    buffer_atomic_add_f32 v158, v15, s[32:35], s89 offen offset:512
    s_waitcnt lgkmcnt(1)
    buffer_atomic_add_f32 v159, v15, s[32:35], s89 offen offset:768
    s_waitcnt lgkmcnt(0)
    s_mov_b32 exec_hi, 0xffff
    buffer_atomic_add_f32 v160, v15, s[32:35], s89 offen offset:1024
    s_mov_b64 exec, -1
    s_and_b32 s78, s50, 1
    s_lshl_b32 s76, s78, 15
    s_add_u32 s76, s76, s55
    s_add_u32 s76, s76, 0x800000
    s_mul_i32 s77, s78, 90112
    s_add_u32 s77, s77, s56
    s_add_u32 s77, s77, 0xa00000
    s_bitcmp1_b32 s50, 1
    s_cselect_b32 s76, s76, s77
    s_lshl_b32 s77, s49, 12
    s_add_u32 s76, s76, s77
    s_mov_b32 exec_hi, 0
    buffer_load_dword v178, v179, s[32:35], s76 offen sc1
    s_mov_b32 exec_hi, -1
    v_add_u32 v19, 0x400, v1
    v_cmp_gt_u32 vcc, 12, v0
    v_mov_b32 v164, 0x1000000
    s_nop 0
    v_cndmask_b32 v19, v164, v19, vcc
    ds_read_b64_tr_b16 v[108:109], v195 offset:49152
    ds_read_b64_tr_b16 v[110:111], v195 offset:49664
    ds_read_b128 v[112:115], v1 offset:8192
    ds_read_b128 v[116:119], v1 offset:10240
    ds_read_b128 v[120:123], v1 offset:49152
    ds_read_b128 v[124:127], v1 offset:51200
    s_waitcnt lgkmcnt(4)
    ds_read_b64_tr_b16 v[128:129], v195 offset:53248
    ds_read_b64_tr_b16 v[130:131], v195 offset:53760
    s_waitcnt lgkmcnt(5)
    v_mfma_f32_16x16x32_bf16 v[60:63], v[108:111], v[112:115], 0
    ds_read_b128 v[132:135], v1 offset:9216
    s_waitcnt lgkmcnt(5)
    v_mfma_f32_16x16x32_bf16 v[64:67], v[108:111], v[116:119], 0
    buffer_load_dwordx4 a[60:63], v192, s[32:35], s96 offen offset:3072 sc1
    s_waitcnt lgkmcnt(4)
    v_mfma_f32_16x16x32_bf16 v[68:71], v[108:111], v[120:123], 0
    ds_read_b128 v[136:139], v1 offset:11264
    ds_read_b128 v[140:143], v1 offset:50176
    s_waitcnt lgkmcnt(5)
    v_mfma_f32_16x16x32_bf16 v[72:75], v[108:111], v[124:127], 0
    ds_read_b128 v[144:147], v1 offset:52224
    s_add_u32 s96, s52, 0xe000
    s_waitcnt lgkmcnt(4)
    ds_read_b64_tr_b16 v[108:109], v195 offset:57344
    ds_read_b64_tr_b16 v[110:111], v195 offset:57856
    s_waitcnt lgkmcnt(5)
    v_mfma_f32_16x16x32_bf16 v[60:63], v[128:131], v[132:135], v[60:63]
    buffer_load_dwordx4 a[64:67], v193, s[32:35], s96 offen offset:0 sc1
    s_waitcnt lgkmcnt(4)
    v_mfma_f32_16x16x32_bf16 v[64:67], v[128:131], v[136:139], v[64:67]
    ds_read_b128 v[112:115], v1 offset:12288
    ds_read_b128 v[116:119], v1 offset:14336
    s_waitcnt lgkmcnt(5)
    v_mfma_f32_16x16x32_bf16 v[68:71], v[128:131], v[140:143], v[68:71]
    ds_read_b128 v[120:123], v1 offset:53248
    s_waitcnt lgkmcnt(5)
    v_mfma_f32_16x16x32_bf16 v[72:75], v[128:131], v[144:147], v[72:75]
    buffer_load_dwordx4 a[68:71], v194, s[32:35], s96 offen offset:1024 sc1
    s_waitcnt lgkmcnt(3)
    ds_read_b128 v[124:127], v1 offset:55296
    s_waitcnt lgkmcnt(3)
    v_mfma_f32_16x16x32_bf16 v[60:63], v[108:111], v[112:115], v[60:63]
    ds_read_b64_tr_b16 v[128:129], v195 offset:61440
    ds_read_b64_tr_b16 v[130:131], v195 offset:61952
    ds_read_b128 v[132:135], v1 offset:13312
    s_waitcnt lgkmcnt(5)
    v_mfma_f32_16x16x32_bf16 v[64:67], v[108:111], v[116:119], v[64:67]
    ds_read_b128 v[136:139], v1 offset:15360
    s_waitcnt lgkmcnt(5)
    v_mfma_f32_16x16x32_bf16 v[68:71], v[108:111], v[120:123], v[68:71]
    buffer_load_dwordx4 a[72:75], v192, s[32:35], s96 offen offset:2048 sc1
    s_waitcnt lgkmcnt(4)
    v_mfma_f32_16x16x32_bf16 v[72:75], v[108:111], v[124:127], v[72:75]
    ds_read_b128 v[140:143], v1 offset:54272
    ds_read_b128 v[144:147], v1 offset:56320
    s_waitcnt lgkmcnt(4)
    ds_read_b64_tr_b16 v[108:109], v195 offset:0
    ds_read_b64_tr_b16 v[110:111], v195 offset:512
    s_waitcnt lgkmcnt(5)
    v_mfma_f32_16x16x32_bf16 v[60:63], v[128:131], v[132:135], v[60:63]
    ds_read_b128 v[112:115], v1 offset:16384
    s_waitcnt lgkmcnt(5)
    v_mfma_f32_16x16x32_bf16 v[64:67], v[128:131], v[136:139], v[64:67]
    buffer_load_dwordx4 a[76:79], v193, s[32:35], s96 offen offset:3072 sc1
    s_waitcnt lgkmcnt(4)
    v_mfma_f32_16x16x32_bf16 v[68:71], v[128:131], v[140:143], v[68:71]
    ds_read_b128 v[116:119], v1 offset:18432
    ds_read_b128 v[120:123], v1 offset:57344
    s_waitcnt lgkmcnt(5)
    v_mfma_f32_16x16x32_bf16 v[72:75], v[128:131], v[144:147], v[72:75]
    ds_read_b128 v[124:127], v1 offset:59392
    s_add_u32 s96, s52, 0xf000
    s_waitcnt lgkmcnt(4)
    ds_read_b64_tr_b16 v[128:129], v195 offset:4096
    ds_read_b64_tr_b16 v[130:131], v195 offset:4608
    s_waitcnt lgkmcnt(5)
    v_mfma_f32_16x16x32_bf16 v[60:63], v[108:111], v[112:115], v[60:63]
    buffer_load_dwordx4 a[80:83], v194, s[32:35], s96 offen offset:0 sc1
    s_waitcnt lgkmcnt(4)
    v_mfma_f32_16x16x32_bf16 v[64:67], v[108:111], v[116:119], v[64:67]
    ds_read_b128 v[132:135], v1 offset:17408
    ds_read_b128 v[136:139], v1 offset:19456
    s_waitcnt lgkmcnt(5)
    v_mfma_f32_16x16x32_bf16 v[68:71], v[108:111], v[120:123], v[68:71]
    ds_read_b128 v[140:143], v1 offset:58368
    s_waitcnt lgkmcnt(5)
    v_mfma_f32_16x16x32_bf16 v[72:75], v[108:111], v[124:127], v[72:75]
    buffer_load_dwordx4 a[84:87], v192, s[32:35], s96 offen offset:1024 sc1
    s_waitcnt lgkmcnt(3)
    ds_read_b128 v[144:147], v1 offset:60416
    s_waitcnt lgkmcnt(3)
    v_mfma_f32_16x16x32_bf16 v[60:63], v[128:131], v[132:135], v[60:63]
    ds_read_b64_tr_b16 v[108:109], v195 offset:8192
    ds_read_b64_tr_b16 v[110:111], v195 offset:8704
    ds_read_b128 v[112:115], v1 offset:20480
    s_waitcnt lgkmcnt(5)
    v_mfma_f32_16x16x32_bf16 v[64:67], v[128:131], v[136:139], v[64:67]
    ds_read_b128 v[116:119], v1 offset:22528
    s_waitcnt lgkmcnt(5)
    v_mfma_f32_16x16x32_bf16 v[68:71], v[128:131], v[140:143], v[68:71]
    buffer_load_dwordx4 a[88:91], v193, s[32:35], s96 offen offset:2048 sc1
    s_waitcnt lgkmcnt(4)
    v_mfma_f32_16x16x32_bf16 v[72:75], v[128:131], v[144:147], v[72:75]
    ds_read_b128 v[120:123], v1 offset:61440
    ds_read_b128 v[124:127], v1 offset:63488
    s_waitcnt lgkmcnt(4)
    ds_read_b64_tr_b16 v[128:129], v195 offset:12288
    ds_read_b64_tr_b16 v[130:131], v195 offset:12800
    s_waitcnt lgkmcnt(5)
    v_mfma_f32_16x16x32_bf16 v[60:63], v[108:111], v[112:115], v[60:63]
    ds_read_b128 v[132:135], v1 offset:21504
    s_waitcnt lgkmcnt(5)
    v_mfma_f32_16x16x32_bf16 v[64:67], v[108:111], v[116:119], v[64:67]
    buffer_load_dwordx4 a[92:95], v194, s[32:35], s96 offen offset:3072 sc1
    s_waitcnt lgkmcnt(4)
    v_mfma_f32_16x16x32_bf16 v[68:71], v[108:111], v[120:123], v[68:71]
    ds_read_b128 v[136:139], v1 offset:23552
    ds_read_b128 v[140:143], v1 offset:62464
    s_waitcnt lgkmcnt(5)
    v_mfma_f32_16x16x32_bf16 v[72:75], v[108:111], v[124:127], v[72:75]
    ds_read_b128 v[144:147], v1 offset:64512
    s_add_u32 s96, s52, 0xa000
    s_waitcnt lgkmcnt(4)
    ds_read_b64_tr_b16 v[108:109], v195 offset:16384
    ds_read_b64_tr_b16 v[110:111], v195 offset:16896
    s_waitcnt lgkmcnt(5)
    v_mfma_f32_16x16x32_bf16 v[60:63], v[128:131], v[132:135], v[60:63]
    buffer_load_dwordx4 a[96:99], v192, s[32:35], s96 offen offset:0 sc1
    s_waitcnt lgkmcnt(4)
    v_mfma_f32_16x16x32_bf16 v[64:67], v[128:131], v[136:139], v[64:67]
    ds_read_b128 v[112:115], v1 offset:24576
    ds_read_b128 v[116:119], v1 offset:26624
    s_waitcnt lgkmcnt(5)
    v_mfma_f32_16x16x32_bf16 v[68:71], v[128:131], v[140:143], v[68:71]
    ds_read_b128 v[120:123], v2 offset:0
    s_waitcnt lgkmcnt(5)
    v_mfma_f32_16x16x32_bf16 v[72:75], v[128:131], v[144:147], v[72:75]
    buffer_load_dwordx4 a[100:103], v193, s[32:35], s96 offen offset:1024 sc1
    s_waitcnt lgkmcnt(3)
    ds_read_b128 v[124:127], v2 offset:2048
    s_waitcnt lgkmcnt(3)
    v_mfma_f32_16x16x32_bf16 v[60:63], v[108:111], v[112:115], v[60:63]
    ds_read_b64_tr_b16 v[128:129], v195 offset:20480
    ds_read_b64_tr_b16 v[130:131], v195 offset:20992
    ds_read_b128 v[132:135], v1 offset:25600
    s_waitcnt lgkmcnt(5)
    v_mfma_f32_16x16x32_bf16 v[64:67], v[108:111], v[116:119], v[64:67]
    ds_read_b128 v[136:139], v1 offset:27648
    s_waitcnt lgkmcnt(5)
    v_mfma_f32_16x16x32_bf16 v[68:71], v[108:111], v[120:123], v[68:71]
    buffer_load_dwordx4 a[104:107], v194, s[32:35], s96 offen offset:2048 sc1
    s_waitcnt lgkmcnt(4)
    v_mfma_f32_16x16x32_bf16 v[72:75], v[108:111], v[124:127], v[72:75]
    ds_read_b128 v[140:143], v2 offset:1024
    ds_read_b128 v[144:147], v2 offset:3072
    s_waitcnt lgkmcnt(4)
    ds_read_b64_tr_b16 v[108:109], v195 offset:24576
    ds_read_b64_tr_b16 v[110:111], v195 offset:25088
    s_waitcnt lgkmcnt(5)
    v_mfma_f32_16x16x32_bf16 v[60:63], v[128:131], v[132:135], v[60:63]
    ds_read_b128 v[112:115], v1 offset:28672
    s_waitcnt lgkmcnt(5)
    v_mfma_f32_16x16x32_bf16 v[64:67], v[128:131], v[136:139], v[64:67]
    buffer_load_dwordx4 a[108:111], v192, s[32:35], s96 offen offset:3072 sc1
    s_waitcnt lgkmcnt(4)
    v_mfma_f32_16x16x32_bf16 v[68:71], v[128:131], v[140:143], v[68:71]
    ds_read_b128 v[116:119], v1 offset:30720
    ds_read_b128 v[120:123], v2 offset:4096
    s_waitcnt lgkmcnt(5)
    v_mfma_f32_16x16x32_bf16 v[72:75], v[128:131], v[144:147], v[72:75]
    ds_read_b128 v[124:127], v2 offset:6144
    s_add_u32 s96, s52, 0xb000
    s_waitcnt lgkmcnt(4)
    ds_read_b64_tr_b16 v[128:129], v195 offset:28672
    ds_read_b64_tr_b16 v[130:131], v195 offset:29184
    s_waitcnt lgkmcnt(5)
    v_mfma_f32_16x16x32_bf16 v[60:63], v[108:111], v[112:115], v[60:63]
    buffer_load_dwordx4 a[112:115], v193, s[32:35], s96 offen offset:0 sc1
    s_waitcnt lgkmcnt(4)
    v_mfma_f32_16x16x32_bf16 v[64:67], v[108:111], v[116:119], v[64:67]
    ds_read_b128 v[132:135], v1 offset:29696
    ds_read_b128 v[136:139], v1 offset:31744
    s_waitcnt lgkmcnt(5)
    v_mfma_f32_16x16x32_bf16 v[68:71], v[108:111], v[120:123], v[68:71]
    ds_read_b128 v[140:143], v2 offset:5120
    s_waitcnt lgkmcnt(5)
    v_mfma_f32_16x16x32_bf16 v[72:75], v[108:111], v[124:127], v[72:75]
    buffer_load_dwordx4 a[116:119], v194, s[32:35], s96 offen offset:1024 sc1
    s_waitcnt lgkmcnt(3)
    ds_read_b128 v[144:147], v2 offset:7168
    s_waitcnt lgkmcnt(3)
    v_mfma_f32_16x16x32_bf16 v[60:63], v[128:131], v[132:135], v[60:63]
    ds_read_b64_tr_b16 v[108:109], v195 offset:32768
    ds_read_b64_tr_b16 v[110:111], v195 offset:33280
    ds_read_b128 v[112:115], v1 offset:32768
    s_waitcnt lgkmcnt(5)
    v_mfma_f32_16x16x32_bf16 v[64:67], v[128:131], v[136:139], v[64:67]
    ds_read_b128 v[116:119], v1 offset:34816
    s_waitcnt lgkmcnt(5)
    v_mfma_f32_16x16x32_bf16 v[68:71], v[128:131], v[140:143], v[68:71]
    buffer_load_dwordx4 a[120:123], v192, s[32:35], s96 offen offset:2048 sc1
    s_waitcnt lgkmcnt(4)
    v_mfma_f32_16x16x32_bf16 v[72:75], v[128:131], v[144:147], v[72:75]
    ds_read_b128 v[120:123], v2 offset:8192
    ds_read_b128 v[124:127], v2 offset:10240
    s_waitcnt lgkmcnt(4)
    ds_read_b64_tr_b16 v[128:129], v195 offset:36864
    ds_read_b64_tr_b16 v[130:131], v195 offset:37376
    s_waitcnt lgkmcnt(5)
    v_mfma_f32_16x16x32_bf16 v[60:63], v[108:111], v[112:115], v[60:63]
    ds_read_b128 v[132:135], v1 offset:33792
    s_waitcnt lgkmcnt(5)
    v_mfma_f32_16x16x32_bf16 v[64:67], v[108:111], v[116:119], v[64:67]
    buffer_load_dwordx4 a[124:127], v193, s[32:35], s96 offen offset:3072 sc1
    s_waitcnt lgkmcnt(4)
    v_mfma_f32_16x16x32_bf16 v[68:71], v[108:111], v[120:123], v[68:71]
    ds_read_b128 v[136:139], v1 offset:35840
    ds_read_b128 v[140:143], v2 offset:9216
    s_waitcnt lgkmcnt(5)
    v_mfma_f32_16x16x32_bf16 v[72:75], v[108:111], v[124:127], v[72:75]
    ds_read_b128 v[144:147], v2 offset:11264
    s_waitcnt lgkmcnt(4)
    ds_read_b64_tr_b16 v[108:109], v195 offset:40960
    ds_read_b64_tr_b16 v[110:111], v195 offset:41472
    s_waitcnt lgkmcnt(5)
    v_mfma_f32_16x16x32_bf16 v[60:63], v[128:131], v[132:135], v[60:63]
    ds_read_b128 v[112:115], v1 offset:36864
    s_waitcnt lgkmcnt(5)
    v_mfma_f32_16x16x32_bf16 v[64:67], v[128:131], v[136:139], v[64:67]
    ds_read_b128 v[116:119], v1 offset:38912
    s_waitcnt lgkmcnt(5)
    v_mfma_f32_16x16x32_bf16 v[68:71], v[128:131], v[140:143], v[68:71]
    ds_read_b128 v[120:123], v2 offset:12288
    s_waitcnt lgkmcnt(5)
    v_mfma_f32_16x16x32_bf16 v[72:75], v[128:131], v[144:147], v[72:75]
    ds_read_b128 v[124:127], v2 offset:14336
    s_waitcnt lgkmcnt(4)
    ds_read_b64_tr_b16 v[128:129], v195 offset:45056
    ds_read_b64_tr_b16 v[130:131], v195 offset:45568
    s_waitcnt lgkmcnt(5)
    v_mfma_f32_16x16x32_bf16 v[60:63], v[108:111], v[112:115], v[60:63]
    ds_read_b128 v[132:135], v1 offset:37888
    s_waitcnt lgkmcnt(5)
    v_mfma_f32_16x16x32_bf16 v[64:67], v[108:111], v[116:119], v[64:67]
    ds_read_b128 v[136:139], v1 offset:39936
    s_waitcnt lgkmcnt(5)
    v_mfma_f32_16x16x32_bf16 v[68:71], v[108:111], v[120:123], v[68:71]
    ds_read_b128 v[140:143], v2 offset:13312
    s_waitcnt lgkmcnt(5)
    v_mfma_f32_16x16x32_bf16 v[72:75], v[108:111], v[124:127], v[72:75]
    ds_read_b128 v[144:147], v2 offset:15360
    s_waitcnt lgkmcnt(4)
    s_waitcnt lgkmcnt(3)
    v_mfma_f32_16x16x32_bf16 v[60:63], v[128:131], v[132:135], v[60:63]
    s_waitcnt lgkmcnt(2)
    v_mfma_f32_16x16x32_bf16 v[64:67], v[128:131], v[136:139], v[64:67]
    s_waitcnt lgkmcnt(1)
    v_mfma_f32_16x16x32_bf16 v[68:71], v[128:131], v[140:143], v[68:71]
    s_waitcnt lgkmcnt(0)
    v_mfma_f32_16x16x32_bf16 v[72:75], v[128:131], v[144:147], v[72:75]
    v_pk_fma_f32 v[156:157], v[36:37], v[148:149], v[182:183] op_sel:[0,1,1] op_sel_hi:[1,1,1]
    v_pk_fma_f32 v[158:159], v[38:39], v[148:149], v[182:183] op_sel:[0,1,1] op_sel_hi:[1,1,1]
    v_pk_fma_f32 v[160:161], v[36:37], v[150:151], v[182:183] op_sel:[0,1,1] op_sel_hi:[1,1,1]
    v_pk_fma_f32 v[162:163], v[38:39], v[150:151], v[182:183] op_sel:[0,1,1] op_sel_hi:[1,1,1]
    v_pk_fma_f32 v[164:165], v[36:37], v[152:153], v[182:183] op_sel:[0,1,1] op_sel_hi:[1,1,1]
    v_pk_fma_f32 v[166:167], v[38:39], v[152:153], v[182:183] op_sel:[0,1,1] op_sel_hi:[1,1,1]
    v_pk_fma_f32 v[168:169], v[36:37], v[154:155], v[182:183] op_sel:[0,1,1] op_sel_hi:[1,1,1]
    v_pk_fma_f32 v[170:171], v[38:39], v[154:155], v[182:183] op_sel:[0,1,1] op_sel_hi:[1,1,1]
    v_pk_fma_f32 v[60:61], v[60:61], v[148:149], v[156:157] op_sel:[0,0,0] op_sel_hi:[1,0,1]
    v_pk_fma_f32 v[62:63], v[62:63], v[148:149], v[158:159] op_sel:[0,0,0] op_sel_hi:[1,0,1]
    v_pk_fma_f32 v[64:65], v[64:65], v[150:151], v[160:161] op_sel:[0,0,0] op_sel_hi:[1,0,1]
    v_pk_fma_f32 v[66:67], v[66:67], v[150:151], v[162:163] op_sel:[0,0,0] op_sel_hi:[1,0,1]
    v_pk_fma_f32 v[68:69], v[68:69], v[152:153], v[164:165] op_sel:[0,0,0] op_sel_hi:[1,0,1]
    v_pk_fma_f32 v[70:71], v[70:71], v[152:153], v[166:167] op_sel:[0,0,0] op_sel_hi:[1,0,1]
    v_pk_fma_f32 v[72:73], v[72:73], v[154:155], v[168:169] op_sel:[0,0,0] op_sel_hi:[1,0,1]
    v_pk_fma_f32 v[74:75], v[74:75], v[154:155], v[170:171] op_sel:[0,0,0] op_sel_hi:[1,0,1]
    v_pk_mul_f32 v[156:157], v[60:61], v[182:183] op_sel:[0,0] op_sel_hi:[1,0]
    v_pk_mul_f32 v[158:159], v[62:63], v[182:183] op_sel:[0,0] op_sel_hi:[1,0]
    v_pk_mul_f32 v[160:161], v[64:65], v[182:183] op_sel:[0,0] op_sel_hi:[1,0]
    v_pk_mul_f32 v[162:163], v[66:67], v[182:183] op_sel:[0,0] op_sel_hi:[1,0]
    v_exp_f32_e64 v156, v156 clamp
    v_max_f32 v60, v183, v60
    v_exp_f32_e64 v157, v157 clamp
    v_max_f32 v61, v183, v61
    v_exp_f32_e64 v158, v158 clamp
    v_max_f32 v62, v183, v62
    v_exp_f32_e64 v159, v159 clamp
    v_max_f32 v63, v183, v63
    v_exp_f32_e64 v160, v160 clamp
    v_max_f32 v64, v183, v64
    v_exp_f32_e64 v161, v161 clamp
    v_max_f32 v65, v183, v65
    v_exp_f32_e64 v162, v162 clamp
    v_max_f32 v66, v183, v66
    v_exp_f32_e64 v163, v163 clamp
    v_max_f32 v67, v183, v67
    v_pk_add_f32 v[60:61], v[60:61], v[156:157]
    v_pk_add_f32 v[62:63], v[62:63], v[158:159]
    v_pk_add_f32 v[64:65], v[64:65], v[160:161]
    v_pk_add_f32 v[66:67], v[66:67], v[162:163]
    v_cvt_pk_bf16_f32 v76, v60, v61
    v_cvt_pk_bf16_f32 v77, v62, v63
    v_cvt_pk_bf16_f32 v78, v64, v65
    v_cvt_pk_bf16_f32 v79, v66, v67
    v_pk_mul_f32 v[156:157], v[68:69], v[182:183] op_sel:[0,0] op_sel_hi:[1,0]
    v_pk_mul_f32 v[158:159], v[70:71], v[182:183] op_sel:[0,0] op_sel_hi:[1,0]
    v_pk_mul_f32 v[160:161], v[72:73], v[182:183] op_sel:[0,0] op_sel_hi:[1,0]
    v_pk_mul_f32 v[162:163], v[74:75], v[182:183] op_sel:[0,0] op_sel_hi:[1,0]
    v_exp_f32_e64 v156, v156 clamp
    v_max_f32 v68, v183, v68
    v_exp_f32_e64 v157, v157 clamp
    v_max_f32 v69, v183, v69
    v_exp_f32_e64 v158, v158 clamp
    v_max_f32 v70, v183, v70
    v_exp_f32_e64 v159, v159 clamp
    v_max_f32 v71, v183, v71
    v_exp_f32_e64 v160, v160 clamp
    v_max_f32 v72, v183, v72
    v_exp_f32_e64 v161, v161 clamp
    v_max_f32 v73, v183, v73
    v_exp_f32_e64 v162, v162 clamp
    v_max_f32 v74, v183, v74
    v_exp_f32_e64 v163, v163 clamp
    v_max_f32 v75, v183, v75
    v_pk_add_f32 v[68:69], v[68:69], v[156:157]
    v_pk_add_f32 v[70:71], v[70:71], v[158:159]
    v_pk_add_f32 v[72:73], v[72:73], v[160:161]
    v_pk_add_f32 v[74:75], v[74:75], v[162:163]
    v_cvt_pk_bf16_f32 v80, v68, v69
    v_cvt_pk_bf16_f32 v81, v70, v71
    v_cvt_pk_bf16_f32 v82, v72, v73
    v_cvt_pk_bf16_f32 v83, v74, v75
    s_add_u32 s82, s56, s57
    s_add_u32 s82, s82, 0xa00000
    s_add_u32 s83, s82, 90112
    v_lshl_add_u32 v124, v0, 4, v3
    v_sub_u32 v124, v124, v15
Lkv_79:
    buffer_load_dwordx4 v[92:95], v1, s[32:35], s88 offen offset:0 sc1
    buffer_load_dwordx4 v[96:99], v1, s[32:35], s88 offen offset:1344 sc1
    buffer_load_dwordx4 v[100:103], v19, s[32:35], s88 offen offset:0 sc1
    buffer_load_dwordx4 v[104:107], v19, s[32:35], s88 offen offset:1344 sc1
    s_waitcnt vmcnt(0)
Lkvc_81:
    v_pk_add_f32 v[156:157], v[92:93], v[96:97]
    v_pk_add_f32 v[158:159], v[94:95], v[98:99]
    v_pk_add_f32 v[164:165], v[100:101], v[104:105]
    v_pk_add_f32 v[166:167], v[102:103], v[106:107]
    ds_write_b128 v124, v[156:159] offset:1280
    s_mov_b64 exec, 0xfff
    ds_write_b128 v124, v[164:167] offset:2304
    s_mov_b64 exec, -1
    ds_read_b128 v[160:163], v176 offset:1280
    ds_read_b32 v168, v172 offset:1280
    ds_read_b32 v169, v173 offset:1280
    ds_read_b32 v170, v174 offset:1280
    ds_read_b32 v171, v175 offset:1280
    v_cmp_eq_f32 vcc, 0x42000000, v159
    v_cmp_eq_f32 s[76:77], v167, v159
    s_nop 0
    s_and_b64 vcc, vcc, s[72:73]
    s_and_b32 s76, s76, 0x888
    s_xor_b32 s76, s76, 0x888
    s_xor_b64 vcc, vcc, s[72:73]
    s_or_b32 s76, s76, vcc_lo
    s_or_b32 s76, s76, vcc_hi
    s_cbranch_scc0 Lkvd_80
    s_waitcnt lgkmcnt(0)
    s_sub_u32 s61, s61, 1
    s_cmp_lg_u32 s61, 0
    s_cbranch_scc1 Lkv_79
    s_branch L_end
Lkvd_80:
    s_waitcnt lgkmcnt(4)
    v_cvt_pk_bf16_f32 v166, v160, v161
    v_cvt_pk_bf16_f32 v167, v162, v163
    s_nop 1
    v_mfma_f32_16x16x16_bf16 v[108:111], v[166:167], v[76:77], 0
    v_mfma_f32_16x16x16_bf16 v[112:115], v[166:167], v[78:79], 0
    v_mfma_f32_16x16x16_bf16 v[116:119], v[166:167], v[80:81], 0
    v_mfma_f32_16x16x16_bf16 v[120:123], v[166:167], v[82:83], 0
    s_waitcnt lgkmcnt(0)
    v_cvt_pk_bf16_f32 v164, v168, v169
    v_cvt_pk_bf16_f32 v165, v170, v171
    s_nop 1
    v_mfma_f32_16x16x16_bf16 v[60:63], v[164:165], v[76:77], 0
    v_mfma_f32_16x16x16_bf16 v[64:67], v[164:165], v[78:79], 0
    v_mfma_f32_16x16x16_bf16 v[68:71], v[164:165], v[80:81], 0
    v_mfma_f32_16x16x16_bf16 v[72:75], v[164:165], v[82:83], 0
    v_add_f32 v108, s62, v108
    v_add_f32 v112, s62, v112
    v_add_f32 v116, s62, v116
    v_add_f32 v120, s62, v120
    v_rcp_f32 v108, v108
    v_rcp_f32 v112, v112
    v_rcp_f32 v116, v116
    v_rcp_f32 v120, v120
    v_pk_mul_f32 v[60:61], v[60:61], v[108:109] op_sel_hi:[1,0]
    v_pk_mul_f32 v[62:63], v[62:63], v[108:109] op_sel_hi:[1,0]
    v_pk_mul_f32 v[64:65], v[64:65], v[112:113] op_sel_hi:[1,0]
    v_pk_mul_f32 v[66:67], v[66:67], v[112:113] op_sel_hi:[1,0]
    v_pk_mul_f32 v[68:69], v[68:69], v[116:117] op_sel_hi:[1,0]
    v_pk_mul_f32 v[70:71], v[70:71], v[116:117] op_sel_hi:[1,0]
    v_pk_mul_f32 v[72:73], v[72:73], v[120:121] op_sel_hi:[1,0]
    v_pk_mul_f32 v[74:75], v[74:75], v[120:121] op_sel_hi:[1,0]
    v_cvt_pk_bf16_f32 v156, v60, v61
    v_cvt_pk_bf16_f32 v157, v62, v63
    v_cvt_pk_bf16_f32 v158, v64, v65
    v_cvt_pk_bf16_f32 v159, v66, v67
    v_cvt_pk_bf16_f32 v160, v68, v69
    v_cvt_pk_bf16_f32 v161, v70, v71
    v_cvt_pk_bf16_f32 v162, v72, v73
    v_cvt_pk_bf16_f32 v163, v74, v75
    v_permlane16_swap_b32 v156, v158
    v_permlane16_swap_b32 v157, v159
    v_permlane16_swap_b32 v160, v162
    v_permlane16_swap_b32 v161, v163
    s_cmp_eq_u32 s51, 1
    s_cbranch_scc0 Lslow_82
    buffer_store_dwordx4 v[156:159], v5, s[32:35], s82 offen offset:0
    buffer_store_dwordx4 v[160:163], v5, s[32:35], s83 offen offset:0
Ljoin_83:
    s_add_u32 s76, s22, 8
    v_mov_b32 v19, s76
    s_waitcnt vmcnt(0)
    s_mov_b64 exec, 1
    s_cmp_eq_u32 s51, 1
    s_cbranch_scc0 Lslow_84
    buffer_store_dword v19, off, s[32:35], s98
Ljoin_85:
    s_mov_b64 exec, -1
    s_add_u32 s76, s22, 8
Lpoll_86:
    buffer_load_dword v180, v14, s[32:35], s54 offen sc1
    s_waitcnt vmcnt(0)
Lpc_88:
    v_subrev_u32 v180, s76, v180
    v_cmp_gt_u32 vcc, 8, v180
    s_nop 1
    s_cmp_eq_u64 vcc, exec
    s_cbranch_scc1 Lpd_87
    s_sub_u32 s61, s61, 1
    s_cmp_lg_u32 s61, 0
    s_cbranch_scc1 Lpoll_86
    s_branch L_end
Lpd_87:
    s_add_u32 m0, s99, 0x0
    s_add_u32 s101, s56, 0xa00000
    buffer_load_dwordx4 v181, s[32:35], s101 offen offset:0 sc1 lds
    buffer_load_dwordx4 v181, s[32:35], s101 offen offset:1024 sc1 lds
    s_add_u32 m0, s99, 0x2000
    s_add_u32 s101, s56, 0xa16000
    buffer_load_dwordx4 v181, s[32:35], s101 offen offset:0 sc1 lds
    buffer_load_dwordx4 v181, s[32:35], s101 offen offset:1024 sc1 lds
    s_add_u32 m0, s99, 0x4000
    s_add_u32 s101, s56, 0xa02000
    buffer_load_dwordx4 v181, s[32:35], s101 offen offset:0 sc1 lds
    buffer_load_dwordx4 v181, s[32:35], s101 offen offset:1024 sc1 lds
    s_add_u32 m0, s99, 0x6000
    s_add_u32 s101, s56, 0xa18000
    buffer_load_dwordx4 v181, s[32:35], s101 offen offset:0 sc1 lds
    buffer_load_dwordx4 v181, s[32:35], s101 offen offset:1024 sc1 lds
    s_add_u32 m0, s99, 0x8000
    s_add_u32 s101, s56, 0xa04000
    buffer_load_dwordx4 v181, s[32:35], s101 offen offset:0 sc1 lds
    buffer_load_dwordx4 v181, s[32:35], s101 offen offset:1024 sc1 lds
    s_waitcnt vmcnt(8)
    s_barrier
    ds_read_b128 v[108:111], v1 offset:0
    ds_read_b128 v[112:115], v1 offset:2048
    ds_read_b128 v[116:119], v1 offset:1024
    ds_read_b128 v[120:123], v1 offset:3072
    ds_read_b128 v[124:127], v1 offset:4096
    ds_read_b128 v[128:131], v1 offset:6144
    ds_read_b128 v[132:135], v1 offset:5120
    ds_read_b128 v[136:139], v1 offset:7168
    s_waitcnt vmcnt(6)
    s_barrier
    ds_read_b128 v[140:143], v1 offset:8192
    s_waitcnt lgkmcnt(7)
    v_mfma_f32_16x16x32_bf16 v[20:23], a[180:183], v[108:111], v[20:23]
    ds_read_b128 v[144:147], v1 offset:10240
    s_add_u32 m0, s99, 0xa000
    v_mfma_f32_16x16x32_bf16 v[24:27], a[180:183], v[112:115], v[24:27]
    ds_read_b128 v[108:111], v1 offset:9216
    s_add_u32 s101, s56, 0xa1a000
    s_waitcnt lgkmcnt(7)
    v_mfma_f32_16x16x32_bf16 v[20:23], a[184:187], v[116:119], v[20:23]
    buffer_load_dwordx4 v181, s[32:35], s101 offen offset:0 sc1 lds
    v_mfma_f32_16x16x32_bf16 v[24:27], a[184:187], v[120:123], v[24:27]
    ds_read_b128 v[112:115], v1 offset:11264
    ds_read_b128 v[116:119], v1 offset:12288
    s_waitcnt lgkmcnt(7)
    v_mfma_f32_16x16x32_bf16 v[20:23], a[188:191], v[124:127], v[20:23]
    buffer_load_dwordx4 v181, s[32:35], s101 offen offset:1024 sc1 lds
    v_mfma_f32_16x16x32_bf16 v[24:27], a[188:191], v[128:131], v[24:27]
    ds_read_b128 v[120:123], v1 offset:14336
    ds_read_b128 v[124:127], v1 offset:13312
    s_waitcnt lgkmcnt(7)
    v_mfma_f32_16x16x32_bf16 v[20:23], a[192:195], v[132:135], v[20:23]
    ds_read_b128 v[128:131], v1 offset:15360
    s_add_u32 m0, s99, 0xc000
    v_mfma_f32_16x16x32_bf16 v[24:27], a[192:195], v[136:139], v[24:27]
    s_waitcnt vmcnt(4)
    s_barrier
    ds_read_b128 v[132:135], v1 offset:16384
    s_add_u32 s101, s56, 0xa06000
    s_waitcnt lgkmcnt(7)
    v_mfma_f32_16x16x32_bf16 v[28:31], a[180:183], v[140:143], v[28:31]
    buffer_load_dwordx4 v181, s[32:35], s101 offen offset:0 sc1 lds
    v_mfma_f32_16x16x32_bf16 v[32:35], a[180:183], v[144:147], v[32:35]
    ds_read_b128 v[136:139], v1 offset:18432
    ds_read_b128 v[140:143], v1 offset:17408
    s_waitcnt lgkmcnt(7)
    v_mfma_f32_16x16x32_bf16 v[28:31], a[184:187], v[108:111], v[28:31]
    buffer_load_dwordx4 v181, s[32:35], s101 offen offset:1024 sc1 lds
    v_mfma_f32_16x16x32_bf16 v[32:35], a[184:187], v[112:115], v[32:35]
    ds_read_b128 v[144:147], v1 offset:19456
    ds_read_b128 v[108:111], v1 offset:20480
    s_waitcnt lgkmcnt(7)
    v_mfma_f32_16x16x32_bf16 v[28:31], a[188:191], v[116:119], v[28:31]
    ds_read_b128 v[112:115], v1 offset:22528
    s_add_u32 m0, s99, 0xe000
    v_mfma_f32_16x16x32_bf16 v[32:35], a[188:191], v[120:123], v[32:35]
    ds_read_b128 v[116:119], v1 offset:21504
    s_add_u32 s101, s56, 0xa1c000
    s_waitcnt lgkmcnt(7)
    v_mfma_f32_16x16x32_bf16 v[28:31], a[192:195], v[124:127], v[28:31]
    buffer_load_dwordx4 v181, s[32:35], s101 offen offset:0 sc1 lds
    v_mfma_f32_16x16x32_bf16 v[32:35], a[192:195], v[128:131], v[32:35]
    ds_read_b128 v[120:123], v1 offset:23552
    ds_read_b128 v[124:127], v1 offset:24576
    s_waitcnt lgkmcnt(7)
    v_mfma_f32_16x16x32_bf16 v[20:23], a[0:3], v[132:135], v[20:23]
    buffer_load_dwordx4 v181, s[32:35], s101 offen offset:1024 sc1 lds
    v_mfma_f32_16x16x32_bf16 v[24:27], a[0:3], v[136:139], v[24:27]
    ds_read_b128 v[128:131], v1 offset:26624
    ds_read_b128 v[132:135], v1 offset:25600
    s_waitcnt lgkmcnt(7)
    v_mfma_f32_16x16x32_bf16 v[20:23], a[4:7], v[140:143], v[20:23]
    ds_read_b128 v[136:139], v1 offset:27648
    s_add_u32 s96, s52, 0xc000
    v_mfma_f32_16x16x32_bf16 v[24:27], a[4:7], v[144:147], v[24:27]
    buffer_load_dwordx4 a[180:183], v194, s[32:35], s96 offen offset:0 sc1
    s_waitcnt lgkmcnt(6)
    v_mfma_f32_16x16x32_bf16 v[20:23], a[8:11], v[108:111], v[20:23]
    ds_read_b128 v[140:143], v1 offset:28672
    ds_read_b128 v[144:147], v1 offset:30720
    v_mfma_f32_16x16x32_bf16 v[24:27], a[8:11], v[112:115], v[24:27]
    ds_read_b128 v[108:111], v1 offset:29696
    s_waitcnt lgkmcnt(7)
    v_mfma_f32_16x16x32_bf16 v[20:23], a[12:15], v[116:119], v[20:23]
    buffer_load_dwordx4 a[184:187], v192, s[32:35], s96 offen offset:1024 sc1
    v_mfma_f32_16x16x32_bf16 v[24:27], a[12:15], v[120:123], v[24:27]
    ds_read_b128 v[112:115], v1 offset:31744
    s_waitcnt vmcnt(6)
    s_barrier
    ds_read_b128 v[116:119], v1 offset:32768
    s_waitcnt lgkmcnt(7)
    v_mfma_f32_16x16x32_bf16 v[28:31], a[0:3], v[124:127], v[28:31]
    ds_read_b128 v[120:123], v1 offset:34816
    v_mfma_f32_16x16x32_bf16 v[32:35], a[0:3], v[128:131], v[32:35]
    buffer_load_dwordx4 a[188:191], v193, s[32:35], s96 offen offset:2048 sc1
    s_waitcnt lgkmcnt(6)
    v_mfma_f32_16x16x32_bf16 v[28:31], a[4:7], v[132:135], v[28:31]
    ds_read_b128 v[124:127], v1 offset:33792
    ds_read_b128 v[128:131], v1 offset:35840
    v_mfma_f32_16x16x32_bf16 v[32:35], a[4:7], v[136:139], v[32:35]
    ds_read_b128 v[132:135], v1 offset:36864
    s_waitcnt lgkmcnt(7)
    v_mfma_f32_16x16x32_bf16 v[28:31], a[8:11], v[140:143], v[28:31]
    buffer_load_dwordx4 a[192:195], v194, s[32:35], s96 offen offset:3072 sc1
    v_mfma_f32_16x16x32_bf16 v[32:35], a[8:11], v[144:147], v[32:35]
    ds_read_b128 v[136:139], v1 offset:38912
    ds_read_b128 v[140:143], v1 offset:37888
    s_waitcnt lgkmcnt(7)
    v_mfma_f32_16x16x32_bf16 v[28:31], a[12:15], v[108:111], v[28:31]
    ds_read_b128 v[144:147], v1 offset:39936
    s_add_u32 s96, s52, 0x7000
    v_mfma_f32_16x16x32_bf16 v[32:35], a[12:15], v[112:115], v[32:35]
    buffer_load_dwordx4 a[0:3], v192, s[32:35], s96 offen offset:0 sc1
    s_waitcnt lgkmcnt(6)
    v_mfma_f32_16x16x32_bf16 v[20:23], a[16:19], v[116:119], v[20:23]
    ds_read_b128 v[108:111], v1 offset:40960
    ds_read_b128 v[112:115], v1 offset:43008
    v_mfma_f32_16x16x32_bf16 v[24:27], a[16:19], v[120:123], v[24:27]
    ds_read_b128 v[116:119], v1 offset:41984
    s_waitcnt lgkmcnt(7)
    v_mfma_f32_16x16x32_bf16 v[20:23], a[20:23], v[124:127], v[20:23]
    buffer_load_dwordx4 a[4:7], v193, s[32:35], s96 offen offset:1024 sc1
    v_mfma_f32_16x16x32_bf16 v[24:27], a[20:23], v[128:131], v[24:27]
    ds_read_b128 v[120:123], v1 offset:44032
    ds_read_b128 v[124:127], v1 offset:45056
    s_waitcnt lgkmcnt(7)
    v_mfma_f32_16x16x32_bf16 v[20:23], a[24:27], v[132:135], v[20:23]
    ds_read_b128 v[128:131], v1 offset:47104
    v_mfma_f32_16x16x32_bf16 v[24:27], a[24:27], v[136:139], v[24:27]
    buffer_load_dwordx4 a[8:11], v194, s[32:35], s96 offen offset:2048 sc1
    s_waitcnt lgkmcnt(6)
    v_mfma_f32_16x16x32_bf16 v[20:23], a[28:31], v[140:143], v[20:23]
    ds_read_b128 v[132:135], v1 offset:46080
    ds_read_b128 v[136:139], v1 offset:48128
    v_mfma_f32_16x16x32_bf16 v[24:27], a[28:31], v[144:147], v[24:27]
    s_waitcnt vmcnt(7)
    s_barrier
    ds_read_b128 v[140:143], v1 offset:49152
    s_waitcnt lgkmcnt(7)
    v_mfma_f32_16x16x32_bf16 v[28:31], a[16:19], v[108:111], v[28:31]
    buffer_load_dwordx4 a[12:15], v192, s[32:35], s96 offen offset:3072 sc1
    v_mfma_f32_16x16x32_bf16 v[32:35], a[16:19], v[112:115], v[32:35]
    ds_read_b128 v[144:147], v1 offset:51200
    ds_read_b128 v[108:111], v1 offset:50176
    s_waitcnt lgkmcnt(7)
    v_mfma_f32_16x16x32_bf16 v[28:31], a[20:23], v[116:119], v[28:31]
    ds_read_b128 v[112:115], v1 offset:52224
    s_add_u32 s96, s52, 0x8000
    v_mfma_f32_16x16x32_bf16 v[32:35], a[20:23], v[120:123], v[32:35]
    buffer_load_dwordx4 a[16:19], v193, s[32:35], s96 offen offset:0 sc1
    s_waitcnt lgkmcnt(6)
    v_mfma_f32_16x16x32_bf16 v[28:31], a[24:27], v[124:127], v[28:31]
    ds_read_b128 v[116:119], v1 offset:53248
    ds_read_b128 v[120:123], v1 offset:55296
    v_mfma_f32_16x16x32_bf16 v[32:35], a[24:27], v[128:131], v[32:35]
    ds_read_b128 v[124:127], v1 offset:54272
    s_waitcnt lgkmcnt(7)
    v_mfma_f32_16x16x32_bf16 v[28:31], a[28:31], v[132:135], v[28:31]
    buffer_load_dwordx4 a[20:23], v194, s[32:35], s96 offen offset:1024 sc1
    v_mfma_f32_16x16x32_bf16 v[32:35], a[28:31], v[136:139], v[32:35]
    ds_read_b128 v[128:131], v1 offset:56320
    ds_read_b128 v[132:135], v1 offset:57344
    s_waitcnt lgkmcnt(7)
    v_mfma_f32_16x16x32_bf16 v[20:23], a[32:35], v[140:143], v[20:23]
    ds_read_b128 v[136:139], v1 offset:59392
    v_mfma_f32_16x16x32_bf16 v[24:27], a[32:35], v[144:147], v[24:27]
    buffer_load_dwordx4 a[24:27], v192, s[32:35], s96 offen offset:2048 sc1
    s_waitcnt lgkmcnt(6)
    v_mfma_f32_16x16x32_bf16 v[20:23], a[36:39], v[108:111], v[20:23]
    ds_read_b128 v[140:143], v1 offset:58368
    ds_read_b128 v[144:147], v1 offset:60416
    v_mfma_f32_16x16x32_bf16 v[24:27], a[36:39], v[112:115], v[24:27]
    ds_read_b128 v[108:111], v1 offset:61440
    s_waitcnt lgkmcnt(7)
    v_mfma_f32_16x16x32_bf16 v[20:23], a[40:43], v[116:119], v[20:23]
    buffer_load_dwordx4 a[28:31], v193, s[32:35], s96 offen offset:3072 sc1
    v_mfma_f32_16x16x32_bf16 v[24:27], a[40:43], v[120:123], v[24:27]
    ds_read_b128 v[112:115], v1 offset:63488
    ds_read_b128 v[116:119], v1 offset:62464
    s_waitcnt lgkmcnt(7)
    v_mfma_f32_16x16x32_bf16 v[20:23], a[44:47], v[124:127], v[20:23]
    ds_read_b128 v[120:123], v1 offset:64512
    v_mfma_f32_16x16x32_bf16 v[24:27], a[44:47], v[128:131], v[24:27]
    s_waitcnt lgkmcnt(6)
    v_mfma_f32_16x16x32_bf16 v[28:31], a[32:35], v[132:135], v[28:31]
    v_mfma_f32_16x16x32_bf16 v[32:35], a[32:35], v[136:139], v[32:35]
    s_waitcnt lgkmcnt(4)
    v_mfma_f32_16x16x32_bf16 v[28:31], a[36:39], v[140:143], v[28:31]
    v_mfma_f32_16x16x32_bf16 v[32:35], a[36:39], v[144:147], v[32:35]
    s_waitcnt lgkmcnt(2)
    v_mfma_f32_16x16x32_bf16 v[28:31], a[40:43], v[108:111], v[28:31]
    v_mfma_f32_16x16x32_bf16 v[32:35], a[40:43], v[112:115], v[32:35]
    s_waitcnt lgkmcnt(0)
    v_mfma_f32_16x16x32_bf16 v[28:31], a[44:47], v[116:119], v[28:31]
    v_mfma_f32_16x16x32_bf16 v[32:35], a[44:47], v[120:123], v[32:35]
    s_add_u32 s82, s55, s57
    s_add_u32 s82, s82, 0x800000
    v_cvt_pk_bf16_f32 v158, v20, v21
    v_cvt_pk_bf16_f32 v159, v22, v23
    v_cvt_pk_bf16_f32 v160, v24, v25
    v_cvt_pk_bf16_f32 v161, v26, v27
    s_nop 0
    v_permlane16_swap_b32 v158, v160
    v_permlane16_swap_b32 v159, v161
    s_cmp_eq_u32 s51, 1
    s_cbranch_scc0 Lslow_89
    buffer_store_dwordx4 v[158:161], v5, s[32:35], s82 offen offset:0
Ljoin_90:
    s_add_u32 s82, s55, s57
    s_add_u32 s82, s82, 0x808000
    v_cvt_pk_bf16_f32 v162, v28, v29
    v_cvt_pk_bf16_f32 v163, v30, v31
    v_cvt_pk_bf16_f32 v164, v32, v33
    v_cvt_pk_bf16_f32 v165, v34, v35
    s_nop 0
    v_permlane16_swap_b32 v162, v164
    v_permlane16_swap_b32 v163, v165
    s_cmp_eq_u32 s51, 1
    s_cbranch_scc0 Lslow_91
    buffer_store_dwordx4 v[162:165], v5, s[32:35], s82 offen offset:0
Ljoin_92:
    s_add_u32 s84, s41, 8192
    v_cvt_pk_bf16_f32 v124, v20, v21
    v_cvt_pk_bf16_f32 v125, v22, v23
    v_cvt_pk_bf16_f32 v126, v24, v25
    v_cvt_pk_bf16_f32 v127, v26, v27
    v_cvt_pk_bf16_f32 v128, v28, v29
    v_cvt_pk_bf16_f32 v129, v30, v31
    v_cvt_pk_bf16_f32 v130, v32, v33
    v_cvt_pk_bf16_f32 v131, v34, v35
    v_lshlrev_b32 v132, 16, v124
    v_and_b32 v133, 0xffff0000, v124
    v_lshlrev_b32 v134, 16, v125
    v_and_b32 v135, 0xffff0000, v125
    v_lshlrev_b32 v136, 16, v126
    v_and_b32 v137, 0xffff0000, v126
    v_lshlrev_b32 v138, 16, v127
    v_and_b32 v139, 0xffff0000, v127
    v_lshlrev_b32 v140, 16, v128
    v_and_b32 v141, 0xffff0000, v128
    v_lshlrev_b32 v142, 16, v129
    v_and_b32 v143, 0xffff0000, v129
    v_lshlrev_b32 v144, 16, v130
    v_and_b32 v145, 0xffff0000, v130
    v_lshlrev_b32 v146, 16, v131
    v_and_b32 v147, 0xffff0000, v131
    v_pk_add_f32 v[108:109], v[132:133], v[134:135]
    v_pk_mul_f32 v[110:111], v[132:133], v[132:133]
    v_pk_add_f32 v[112:113], v[136:137], v[138:139]
    v_pk_mul_f32 v[114:115], v[136:137], v[136:137]
    v_pk_add_f32 v[116:117], v[140:141], v[142:143]
    v_pk_mul_f32 v[118:119], v[140:141], v[140:141]
    v_pk_add_f32 v[120:121], v[144:145], v[146:147]
    v_pk_mul_f32 v[122:123], v[144:145], v[144:145]
    v_pk_fma_f32 v[110:111], v[134:135], v[134:135], v[110:111]
    v_pk_fma_f32 v[114:115], v[138:139], v[138:139], v[114:115]
    v_pk_fma_f32 v[118:119], v[142:143], v[142:143], v[118:119]
    v_pk_fma_f32 v[122:123], v[146:147], v[146:147], v[122:123]
    v_add_f32 v108, v108, v109
    v_add_f32 v110, v110, v111
    v_add_f32 v112, v112, v113
    v_add_f32 v114, v114, v115
    v_add_f32 v116, v116, v117
    v_add_f32 v118, v118, v119
    v_add_f32 v120, v120, v121
    v_add_f32 v122, v122, v123
    v_permlane32_swap_b32 v108, v112
    v_permlane32_swap_b32 v110, v114
    v_permlane32_swap_b32 v116, v120
    v_permlane32_swap_b32 v118, v122
    v_add_f32 v108, v108, v112
    v_add_f32 v110, v110, v114
    v_add_f32 v116, v116, v120
    v_add_f32 v118, v118, v122
    v_permlane16_swap_b32 v108, v110
    s_nop 0
    v_permlane16_swap_b32 v116, v118
    v_add_f32 v108, v108, v110
    v_add_f32 v116, v116, v118
    s_cmp_eq_u32 s51, 1
    s_cbranch_scc0 Lslow_93
    buffer_store_dword v108, v15, s[32:35], s41 offen
    buffer_store_dword v116, v15, s[32:35], s84 offen
Ljoin_94:
    s_add_u32 s76, s22, 9
    v_mov_b32 v19, s76
    s_waitcnt vmcnt(2)
    s_mov_b64 exec, 1
    s_cmp_eq_u32 s51, 1
    s_cbranch_scc0 Lslow_95
    buffer_store_dword v19, off, s[32:35], s98
Ljoin_96:
    s_mov_b64 exec, -1
    s_add_u32 s76, s22, 9
Lpoll_97:
    buffer_load_dword v180, v14, s[32:35], s54 offen sc1
    s_waitcnt vmcnt(0)
Lpc_99:
    v_subrev_u32 v180, s76, v180
    v_cmp_gt_u32 vcc, 7, v180
    s_nop 1
    s_cmp_eq_u64 vcc, exec
    s_cbranch_scc1 Lpd_98
    s_sub_u32 s61, s61, 1
    s_cmp_lg_u32 s61, 0
    s_cbranch_scc1 Lpoll_97
    s_branch L_end
Lpd_98:
    s_add_u32 m0, s99, 0x10000
    s_add_u32 s101, s55, 0x806000
    buffer_load_dwordx4 v181, s[32:35], s101 offen offset:0 sc1 lds
    buffer_load_dwordx4 v181, s[32:35], s101 offen offset:1024 sc1 lds
    s_add_u32 m0, s99, 0x12000
    s_add_u32 s101, s55, 0x80e000
    buffer_load_dwordx4 v181, s[32:35], s101 offen offset:0 sc1 lds
    buffer_load_dwordx4 v181, s[32:35], s101 offen offset:1024 sc1 lds
    s_add_u32 s76, s22, 10
    v_mov_b32 v19, s76
    s_mov_b64 exec, 1
    s_cmp_eq_u32 s51, 1
    s_cbranch_scc0 Lslow_100
    buffer_store_dword v19, off, s[32:35], s98
Ljoin_101:
    s_mov_b64 exec, -1
    s_add_u32 m0, s99, 0x0
    s_add_u32 s101, s55, 0x804000
    buffer_load_dwordx4 v181, s[32:35], s101 offen offset:0 sc1 lds
    buffer_load_dwordx4 v181, s[32:35], s101 offen offset:1024 sc1 lds
    s_add_u32 m0, s99, 0x2000
    s_add_u32 s101, s55, 0x80c000
    buffer_load_dwordx4 v181, s[32:35], s101 offen offset:0 sc1 lds
    buffer_load_dwordx4 v181, s[32:35], s101 offen offset:1024 sc1 lds
    s_waitcnt vmcnt(5)
    s_barrier
    ds_read_b128 v[108:111], v2 offset:0
    ds_read_b128 v[112:115], v2 offset:2048
    ds_read_b128 v[116:119], v2 offset:8192
    ds_read_b128 v[120:123], v2 offset:10240
    ds_read_b128 v[124:127], v2 offset:1024
    ds_read_b128 v[128:131], v2 offset:3072
    s_waitcnt lgkmcnt(4)
    v_mfma_f32_16x16x32_bf16 v[60:63], a[48:51], v[108:111], 0
    ds_read_b128 v[132:135], v2 offset:9216
    s_add_u32 m0, s99, 0x4000
    v_mfma_f32_16x16x32_bf16 v[68:71], a[52:55], v[108:111], 0
    s_add_u32 s101, s55, 0x802000
    v_mfma_f32_16x16x32_bf16 v[76:79], a[56:59], v[108:111], 0
    buffer_load_dwordx4 v181, s[32:35], s101 offen offset:0 sc1 lds
    v_mfma_f32_16x16x32_bf16 v[64:67], a[48:51], v[112:115], 0
    ds_read_b128 v[136:139], v2 offset:11264
    v_mfma_f32_16x16x32_bf16 v[72:75], a[52:55], v[112:115], 0
    buffer_load_dwordx4 v181, s[32:35], s101 offen offset:1024 sc1 lds
    v_mfma_f32_16x16x32_bf16 v[80:83], a[56:59], v[112:115], 0
    s_add_u32 m0, s99, 0x6000
    s_add_u32 s101, s55, 0x80a000
    s_waitcnt lgkmcnt(4)
    v_mfma_f32_16x16x32_bf16 v[84:87], a[48:51], v[116:119], 0
    buffer_load_dwordx4 v181, s[32:35], s101 offen offset:0 sc1 lds
    v_mfma_f32_16x16x32_bf16 v[92:95], a[52:55], v[116:119], 0
    ds_read_b128 v[140:143], v2 offset:4096
    v_mfma_f32_16x16x32_bf16 v[100:103], a[56:59], v[116:119], 0
    buffer_load_dwordx4 v181, s[32:35], s101 offen offset:1024 sc1 lds
    v_mfma_f32_16x16x32_bf16 v[88:91], a[48:51], v[120:123], 0
    ds_read_b128 v[144:147], v2 offset:6144
    s_add_u32 m0, s99, 0x8000
    v_mfma_f32_16x16x32_bf16 v[96:99], a[52:55], v[120:123], 0
    s_add_u32 s101, s55, 0x800000
    v_mfma_f32_16x16x32_bf16 v[104:107], a[56:59], v[120:123], 0
    buffer_load_dwordx4 v181, s[32:35], s101 offen offset:0 sc1 lds
    s_waitcnt lgkmcnt(4)
    v_mfma_f32_16x16x32_bf16 v[60:63], a[60:63], v[124:127], v[60:63]
    ds_read_b128 v[108:111], v2 offset:12288
    v_mfma_f32_16x16x32_bf16 v[68:71], a[64:67], v[124:127], v[68:71]
    buffer_load_dwordx4 v181, s[32:35], s101 offen offset:1024 sc1 lds
    v_mfma_f32_16x16x32_bf16 v[76:79], a[68:71], v[124:127], v[76:79]
    s_add_u32 m0, s99, 0xa000
    s_add_u32 s101, s55, 0x808000
    v_mfma_f32_16x16x32_bf16 v[64:67], a[60:63], v[128:131], v[64:67]
    buffer_load_dwordx4 v181, s[32:35], s101 offen offset:0 sc1 lds
    v_mfma_f32_16x16x32_bf16 v[72:75], a[64:67], v[128:131], v[72:75]
    ds_read_b128 v[112:115], v2 offset:14336
    v_mfma_f32_16x16x32_bf16 v[80:83], a[68:71], v[128:131], v[80:83]
    buffer_load_dwordx4 v181, s[32:35], s101 offen offset:1024 sc1 lds
    s_waitcnt lgkmcnt(4)
    v_mfma_f32_16x16x32_bf16 v[84:87], a[60:63], v[132:135], v[84:87]
    ds_read_b128 v[116:119], v2 offset:5120
    v_mfma_f32_16x16x32_bf16 v[92:95], a[64:67], v[132:135], v[92:95]
    v_mfma_f32_16x16x32_bf16 v[100:103], a[68:71], v[132:135], v[100:103]
    v_mfma_f32_16x16x32_bf16 v[88:91], a[60:63], v[136:139], v[88:91]
    ds_read_b128 v[120:123], v2 offset:7168
    v_mfma_f32_16x16x32_bf16 v[96:99], a[64:67], v[136:139], v[96:99]
    v_mfma_f32_16x16x32_bf16 v[104:107], a[68:71], v[136:139], v[104:107]
    s_waitcnt lgkmcnt(4)
    v_mfma_f32_16x16x32_bf16 v[60:63], a[72:75], v[140:143], v[60:63]
    ds_read_b128 v[124:127], v2 offset:13312
    v_mfma_f32_16x16x32_bf16 v[68:71], a[76:79], v[140:143], v[68:71]
    v_mfma_f32_16x16x32_bf16 v[76:79], a[80:83], v[140:143], v[76:79]
    buffer_load_dword v180, v14, s[32:35], s54 offen sc1
    v_mfma_f32_16x16x32_bf16 v[64:67], a[72:75], v[144:147], v[64:67]
    ds_read_b128 v[128:131], v2 offset:15360
    v_mfma_f32_16x16x32_bf16 v[72:75], a[76:79], v[144:147], v[72:75]
    v_mfma_f32_16x16x32_bf16 v[80:83], a[80:83], v[144:147], v[80:83]
    s_waitcnt lgkmcnt(4)
    v_mfma_f32_16x16x32_bf16 v[84:87], a[72:75], v[108:111], v[84:87]
    s_waitcnt vmcnt(9)
    s_barrier
    ds_read_b128 v[132:135], v1 offset:0
    v_mfma_f32_16x16x32_bf16 v[92:95], a[76:79], v[108:111], v[92:95]
    v_mfma_f32_16x16x32_bf16 v[100:103], a[80:83], v[108:111], v[100:103]
    v_mfma_f32_16x16x32_bf16 v[88:91], a[72:75], v[112:115], v[88:91]
    ds_read_b128 v[136:139], v1 offset:2048
    v_mfma_f32_16x16x32_bf16 v[96:99], a[76:79], v[112:115], v[96:99]
    v_mfma_f32_16x16x32_bf16 v[104:107], a[80:83], v[112:115], v[104:107]
    s_waitcnt lgkmcnt(4)
    v_mfma_f32_16x16x32_bf16 v[60:63], a[84:87], v[116:119], v[60:63]
    ds_read_b128 v[140:143], v1 offset:8192
    v_mfma_f32_16x16x32_bf16 v[68:71], a[88:91], v[116:119], v[68:71]
    v_mfma_f32_16x16x32_bf16 v[76:79], a[92:95], v[116:119], v[76:79]
    v_mfma_f32_16x16x32_bf16 v[64:67], a[84:87], v[120:123], v[64:67]
    ds_read_b128 v[144:147], v1 offset:10240
    v_mfma_f32_16x16x32_bf16 v[72:75], a[88:91], v[120:123], v[72:75]
    v_mfma_f32_16x16x32_bf16 v[80:83], a[92:95], v[120:123], v[80:83]
    s_waitcnt lgkmcnt(4)
    v_mfma_f32_16x16x32_bf16 v[84:87], a[84:87], v[124:127], v[84:87]
    ds_read_b128 v[108:111], v1 offset:1024
    v_mfma_f32_16x16x32_bf16 v[92:95], a[88:91], v[124:127], v[92:95]
    v_mfma_f32_16x16x32_bf16 v[100:103], a[92:95], v[124:127], v[100:103]
    s_add_u32 s76, s22, 10
    s_waitcnt vmcnt(0)
    s_branch Lpc_104
Lpoll_102:
    buffer_load_dword v180, v14, s[32:35], s54 offen sc1
    s_waitcnt vmcnt(0)
Lpc_104:
    v_subrev_u32 v180, s76, v180
    v_cmp_gt_u32 vcc, 6, v180
    s_nop 1
    s_cmp_eq_u64 vcc, exec
    s_cbranch_scc1 Lpd_103
    s_sub_u32 s61, s61, 1
    s_cmp_lg_u32 s61, 0
    s_cbranch_scc1 Lpoll_102
    s_branch L_end
Lpd_103:
    v_mfma_f32_16x16x32_bf16 v[88:91], a[84:87], v[128:131], v[88:91]
    ds_read_b128 v[112:115], v1 offset:3072
    s_add_u32 m0, s99, 0xc000
    v_mfma_f32_16x16x32_bf16 v[96:99], a[88:91], v[128:131], v[96:99]
    s_add_u32 s101, s42, 0x0
    v_mfma_f32_16x16x32_bf16 v[104:107], a[92:95], v[128:131], v[104:107]
    buffer_load_dwordx4 v1, s[32:35], s101 offen offset:0 sc1 lds
    s_waitcnt lgkmcnt(4)
    v_mfma_f32_16x16x32_bf16 v[60:63], a[96:99], v[132:135], v[60:63]
    buffer_load_dwordx4 v1, s[32:35], s101 offen offset:1024 sc1 lds
    v_mfma_f32_16x16x32_bf16 v[68:71], a[100:103], v[132:135], v[68:71]
    ds_read_b128 v[116:119], v1 offset:9216
    s_add_u32 m0, s99, 0xe000
    v_mfma_f32_16x16x32_bf16 v[76:79], a[104:107], v[132:135], v[76:79]
    s_add_u32 s101, s42, 0x2000
    v_mfma_f32_16x16x32_bf16 v[64:67], a[96:99], v[136:139], v[64:67]
    buffer_load_dwordx4 v1, s[32:35], s101 offen offset:0 sc1 lds
    v_mfma_f32_16x16x32_bf16 v[72:75], a[100:103], v[136:139], v[72:75]
    buffer_load_dwordx4 v1, s[32:35], s101 offen offset:1024 sc1 lds
    v_mfma_f32_16x16x32_bf16 v[80:83], a[104:107], v[136:139], v[80:83]
    ds_read_b128 v[120:123], v1 offset:11264
    s_add_u32 s96, s52, 0x9000
    s_waitcnt lgkmcnt(4)
    v_mfma_f32_16x16x32_bf16 v[84:87], a[96:99], v[140:143], v[84:87]
    ds_read_b128 v[124:127], v1 offset:4096
    v_mfma_f32_16x16x32_bf16 v[92:95], a[100:103], v[140:143], v[92:95]
    buffer_load_dwordx4 a[32:35], v194, s[32:35], s96 offen offset:0 sc1
    v_mfma_f32_16x16x32_bf16 v[100:103], a[104:107], v[140:143], v[100:103]
    v_mfma_f32_16x16x32_bf16 v[88:91], a[96:99], v[144:147], v[88:91]
    ds_read_b128 v[128:131], v1 offset:6144
    v_mfma_f32_16x16x32_bf16 v[96:99], a[100:103], v[144:147], v[96:99]
    buffer_load_dwordx4 a[36:39], v192, s[32:35], s96 offen offset:1024 sc1
    v_mfma_f32_16x16x32_bf16 v[104:107], a[104:107], v[144:147], v[104:107]
    s_waitcnt lgkmcnt(4)
    v_mfma_f32_16x16x32_bf16 v[60:63], a[108:111], v[108:111], v[60:63]
    ds_read_b128 v[132:135], v1 offset:12288
    v_mfma_f32_16x16x32_bf16 v[68:71], a[112:115], v[108:111], v[68:71]
    buffer_load_dwordx4 a[40:43], v193, s[32:35], s96 offen offset:2048 sc1
    v_mfma_f32_16x16x32_bf16 v[76:79], a[116:119], v[108:111], v[76:79]
    v_mfma_f32_16x16x32_bf16 v[64:67], a[108:111], v[112:115], v[64:67]
    ds_read_b128 v[136:139], v1 offset:14336
    v_mfma_f32_16x16x32_bf16 v[72:75], a[112:115], v[112:115], v[72:75]
    buffer_load_dwordx4 a[44:47], v194, s[32:35], s96 offen offset:3072 sc1
    v_mfma_f32_16x16x32_bf16 v[80:83], a[116:119], v[112:115], v[80:83]
    s_add_u32 s96, s52, 0x4000
    s_waitcnt lgkmcnt(4)
    v_mfma_f32_16x16x32_bf16 v[84:87], a[108:111], v[116:119], v[84:87]
    ds_read_b128 v[140:143], v1 offset:5120
    v_mfma_f32_16x16x32_bf16 v[92:95], a[112:115], v[116:119], v[92:95]
    buffer_load_dwordx4 a[48:51], v192, s[32:35], s96 offen offset:0 sc1
    v_mfma_f32_16x16x32_bf16 v[100:103], a[116:119], v[116:119], v[100:103]
    v_mfma_f32_16x16x32_bf16 v[88:91], a[108:111], v[120:123], v[88:91]
    ds_read_b128 v[144:147], v1 offset:7168
    v_mfma_f32_16x16x32_bf16 v[96:99], a[112:115], v[120:123], v[96:99]
    buffer_load_dwordx4 a[52:55], v193, s[32:35], s96 offen offset:1024 sc1
    v_mfma_f32_16x16x32_bf16 v[104:107], a[116:119], v[120:123], v[104:107]
    s_waitcnt lgkmcnt(4)
    v_mfma_f32_16x16x32_bf16 v[60:63], a[120:123], v[124:127], v[60:63]
    ds_read_b128 v[108:111], v1 offset:13312
    v_mfma_f32_16x16x32_bf16 v[68:71], a[124:127], v[124:127], v[68:71]
    buffer_load_dwordx4 a[56:59], v194, s[32:35], s96 offen offset:2048 sc1
    v_mfma_f32_16x16x32_bf16 v[76:79], a[180:183], v[124:127], v[76:79]
    v_mfma_f32_16x16x32_bf16 v[64:67], a[120:123], v[128:131], v[64:67]
    ds_read_b128 v[112:115], v1 offset:15360
    v_mfma_f32_16x16x32_bf16 v[72:75], a[124:127], v[128:131], v[72:75]
    buffer_load_dwordx4 a[60:63], v192, s[32:35], s96 offen offset:3072 sc1
    v_mfma_f32_16x16x32_bf16 v[80:83], a[180:183], v[128:131], v[80:83]
    s_add_u32 s96, s52, 0x5000
    s_waitcnt lgkmcnt(4)
    v_mfma_f32_16x16x32_bf16 v[84:87], a[120:123], v[132:135], v[84:87]
    s_barrier
    ds_read_b128 v[116:119], v1 offset:16384
    v_mfma_f32_16x16x32_bf16 v[92:95], a[124:127], v[132:135], v[92:95]
    buffer_load_dwordx4 a[64:67], v193, s[32:35], s96 offen offset:0 sc1
    v_mfma_f32_16x16x32_bf16 v[100:103], a[180:183], v[132:135], v[100:103]
    v_mfma_f32_16x16x32_bf16 v[88:91], a[120:123], v[136:139], v[88:91]
    ds_read_b128 v[120:123], v1 offset:18432
    v_add_u32 v156, 0xc000, v8
    v_mfma_f32_16x16x32_bf16 v[96:99], a[124:127], v[136:139], v[96:99]
    buffer_load_dwordx4 a[68:71], v194, s[32:35], s96 offen offset:1024 sc1
    v_mfma_f32_16x16x32_bf16 v[104:107], a[180:183], v[136:139], v[104:107]
    s_waitcnt vmcnt(12)
    ds_read2st64_b32 v[184:185], v156 offset0:0 offset1:1
    s_waitcnt lgkmcnt(5)
    v_mfma_f32_16x16x32_bf16 v[60:63], a[184:187], v[140:143], v[60:63]
    ds_read_b128 v[124:127], v1 offset:24576
    ds_read2st64_b32 v[186:187], v156 offset0:2 offset1:3
    v_mfma_f32_16x16x32_bf16 v[68:71], a[188:191], v[140:143], v[68:71]
    buffer_load_dwordx4 a[72:75], v192, s[32:35], s96 offen offset:2048 sc1
    v_mfma_f32_16x16x32_bf16 v[76:79], a[192:195], v[140:143], v[76:79]
    ds_read2st64_b32 v[188:189], v156 offset0:4 offset1:5
    ds_read2st64_b32 v[190:191], v156 offset0:6 offset1:7
    v_mfma_f32_16x16x32_bf16 v[64:67], a[184:187], v[144:147], v[64:67]
    ds_read_b128 v[128:131], v1 offset:26624
    v_mfma_f32_16x16x32_bf16 v[72:75], a[188:191], v[144:147], v[72:75]
    buffer_load_dwordx4 a[76:79], v193, s[32:35], s96 offen offset:3072 sc1
    v_mfma_f32_16x16x32_bf16 v[80:83], a[192:195], v[144:147], v[80:83]
    s_add_u32 s96, s52, 0x6000
    s_waitcnt lgkmcnt(8)
    v_mfma_f32_16x16x32_bf16 v[84:87], a[184:187], v[108:111], v[84:87]
    ds_read_b128 v[132:135], v1 offset:17408
    v_mfma_f32_16x16x32_bf16 v[92:95], a[188:191], v[108:111], v[92:95]
    buffer_load_dwordx4 a[80:83], v194, s[32:35], s96 offen offset:0 sc1
    v_mfma_f32_16x16x32_bf16 v[100:103], a[192:195], v[108:111], v[100:103]
    v_mfma_f32_16x16x32_bf16 v[88:91], a[184:187], v[112:115], v[88:91]
    ds_read_b128 v[136:139], v1 offset:19456
    v_mfma_f32_16x16x32_bf16 v[96:99], a[188:191], v[112:115], v[96:99]
    buffer_load_dwordx4 a[84:87], v192, s[32:35], s96 offen offset:1024 sc1
    v_mfma_f32_16x16x32_bf16 v[104:107], a[192:195], v[112:115], v[104:107]
    s_waitcnt lgkmcnt(8)
    v_mfma_f32_16x16x32_bf16 v[60:63], a[0:3], v[116:119], v[60:63]
    ds_read_b128 v[140:143], v1 offset:25600
    s_waitcnt lgkmcnt(4)
    v_mfma_f32_16x16x32_bf16 v[68:71], a[4:7], v[116:119], v[68:71]
    buffer_load_dwordx4 a[88:91], v193, s[32:35], s96 offen offset:2048 sc1
    v_mfma_f32_16x16x32_bf16 v[76:79], a[8:11], v[116:119], v[76:79]
    v_add_f32 v184, v184, v188
    v_add_f32 v185, v185, v189
    v_mfma_f32_16x16x32_bf16 v[64:67], a[0:3], v[120:123], v[64:67]
    ds_read_b128 v[144:147], v1 offset:27648
    v_add_f32 v186, v186, v190
    v_mfma_f32_16x16x32_bf16 v[72:75], a[4:7], v[120:123], v[72:75]
    buffer_load_dwordx4 a[92:95], v194, s[32:35], s96 offen offset:3072 sc1
    v_mfma_f32_16x16x32_bf16 v[80:83], a[8:11], v[120:123], v[80:83]
    v_add_f32 v187, v187, v191
    v_add_f32 v184, v184, v186
    s_waitcnt lgkmcnt(4)
    v_mfma_f32_16x16x32_bf16 v[84:87], a[0:3], v[124:127], v[84:87]
    ds_read_b128 v[108:111], v1 offset:20480
    v_add_f32 v185, v185, v187
    v_mfma_f32_16x16x32_bf16 v[92:95], a[4:7], v[124:127], v[92:95]
    v_add_f32 v184, v184, v185
    ds_write_b32 v177, v184 offset:0
    v_mfma_f32_16x16x32_bf16 v[100:103], a[8:11], v[124:127], v[100:103]
    v_add_u32 v156, 0xe000, v8
    s_waitcnt vmcnt(16)
    v_mfma_f32_16x16x32_bf16 v[88:91], a[0:3], v[128:131], v[88:91]
    ds_read_b128 v[112:115], v1 offset:22528
    ds_read2st64_b32 v[184:185], v156 offset0:0 offset1:1
    v_mfma_f32_16x16x32_bf16 v[96:99], a[4:7], v[128:131], v[96:99]
    ds_read2st64_b32 v[186:187], v156 offset0:2 offset1:3
    ds_read2st64_b32 v[188:189], v156 offset0:4 offset1:5
    v_mfma_f32_16x16x32_bf16 v[104:107], a[8:11], v[128:131], v[104:107]
    ds_read2st64_b32 v[190:191], v156 offset0:6 offset1:7
    s_waitcnt lgkmcnt(9)
    v_mfma_f32_16x16x32_bf16 v[60:63], a[12:15], v[132:135], v[60:63]
    ds_read_b128 v[116:119], v1 offset:21504
    v_mfma_f32_16x16x32_bf16 v[68:71], a[16:19], v[132:135], v[68:71]
    v_mfma_f32_16x16x32_bf16 v[76:79], a[20:23], v[132:135], v[76:79]
    s_lshr_b32 s77, s50, 1
    s_mul_i32 s77, s77, 77824
    s_mul_i32 s78, s50, 6144
    s_add_u32 s77, s77, s78
    s_mul_i32 s78, s49, 12288
    s_add_u32 s77, s77, s78
    s_add_u32 s77, s77, s56
    s_add_u32 s77, s77, 0xa00000
    s_cmp_lt_u32 s49, 7
    s_cselect_b32 s77, s77, 0x1000000
    s_mov_b32 exec_hi, 0xffff
    buffer_load_dword v178, v179, s[32:35], s77 offen sc1
    s_mov_b32 exec_hi, -1
    v_mfma_f32_16x16x32_bf16 v[64:67], a[12:15], v[136:139], v[64:67]
    ds_read_b128 v[120:123], v1 offset:23552
    v_mfma_f32_16x16x32_bf16 v[72:75], a[16:19], v[136:139], v[72:75]
    v_mfma_f32_16x16x32_bf16 v[80:83], a[20:23], v[136:139], v[80:83]
    s_waitcnt lgkmcnt(2)
    v_add_f32 v184, v184, v188
    v_mfma_f32_16x16x32_bf16 v[84:87], a[12:15], v[140:143], v[84:87]
    ds_read_b128 v[124:127], v1 offset:32768
    v_add_f32 v185, v185, v189
    v_mfma_f32_16x16x32_bf16 v[92:95], a[16:19], v[140:143], v[92:95]
    v_add_f32 v186, v186, v190
    v_add_f32 v187, v187, v191
    v_mfma_f32_16x16x32_bf16 v[100:103], a[20:23], v[140:143], v[100:103]
    v_add_f32 v184, v184, v186
    v_add_f32 v185, v185, v187
    v_mfma_f32_16x16x32_bf16 v[88:91], a[12:15], v[144:147], v[88:91]
    ds_read_b128 v[128:131], v1 offset:34816
    v_add_f32 v184, v184, v185
    v_mfma_f32_16x16x32_bf16 v[96:99], a[16:19], v[144:147], v[96:99]
    ds_write_b32 v177, v184 offset:1024
    v_mfma_f32_16x16x32_bf16 v[104:107], a[20:23], v[144:147], v[104:107]
    s_waitcnt vmcnt(16)
    v_mfma_f32_16x16x32_bf16 v[60:63], a[24:27], v[108:111], v[60:63]
    ds_read_b128 v[132:135], v1 offset:33792
    v_mfma_f32_16x16x32_bf16 v[68:71], a[28:31], v[108:111], v[68:71]
    v_mfma_f32_16x16x32_bf16 v[76:79], a[32:35], v[108:111], v[76:79]
    v_mfma_f32_16x16x32_bf16 v[64:67], a[24:27], v[112:115], v[64:67]
    ds_read_b128 v[136:139], v1 offset:35840
    v_mfma_f32_16x16x32_bf16 v[72:75], a[28:31], v[112:115], v[72:75]
    v_mfma_f32_16x16x32_bf16 v[80:83], a[32:35], v[112:115], v[80:83]
    s_waitcnt vmcnt(15)
    s_waitcnt vmcnt(14)
    s_waitcnt vmcnt(13)
    s_waitcnt lgkmcnt(5)
    v_mfma_f32_16x16x32_bf16 v[60:63], a[36:39], v[116:119], v[60:63]
    ds_read_b128 v[140:143], v1 offset:36864
    v_mfma_f32_16x16x32_bf16 v[68:71], a[40:43], v[116:119], v[68:71]
    v_mfma_f32_16x16x32_bf16 v[76:79], a[44:47], v[116:119], v[76:79]
    s_waitcnt lgkmcnt(3)
    s_barrier
    v_mfma_f32_16x16x32_bf16 v[64:67], a[36:39], v[120:123], v[64:67]
    ds_read_b128 v[144:147], v1 offset:38912
    ds_read2st64_b32 v[184:185], v9 offset0:0 offset1:1
    v_mfma_f32_16x16x32_bf16 v[72:75], a[40:43], v[120:123], v[72:75]
    ds_read2st64_b32 v[186:187], v9 offset0:2 offset1:3
    v_mfma_f32_16x16x32_bf16 v[80:83], a[44:47], v[120:123], v[80:83]
    s_waitcnt vmcnt(12)
    s_waitcnt vmcnt(11)
    s_waitcnt vmcnt(10)
    v_mfma_f32_16x16x32_bf16 v[60:63], a[48:51], v[124:127], v[60:63]
    ds_read_b128 v[108:111], v1 offset:37888
    v_mfma_f32_16x16x32_bf16 v[68:71], a[52:55], v[124:127], v[68:71]
    v_mfma_f32_16x16x32_bf16 v[76:79], a[56:59], v[124:127], v[76:79]
    v_mfma_f32_16x16x32_bf16 v[64:67], a[48:51], v[128:131], v[64:67]
    ds_read_b128 v[112:115], v1 offset:39936
    v_mfma_f32_16x16x32_bf16 v[72:75], a[52:55], v[128:131], v[72:75]
    s_waitcnt lgkmcnt(2)
    v_add_f32 v184, v184, v186
    v_mfma_f32_16x16x32_bf16 v[80:83], a[56:59], v[128:131], v[80:83]
    v_add_f32 v185, v185, v187
    v_add_f32 v184, v184, v185
    s_waitcnt vmcnt(9)
    s_waitcnt vmcnt(8)
    s_waitcnt vmcnt(7)
    v_mfma_f32_16x16x32_bf16 v[60:63], a[60:63], v[132:135], v[60:63]
    v_mul_f32 v184, 0x3b000000, v184
    v_mov_b32 v185, v184
    v_mfma_f32_16x16x32_bf16 v[68:71], a[64:67], v[132:135], v[68:71]
    v_mfma_f32_16x16x32_bf16 v[76:79], a[68:71], v[132:135], v[76:79]
    v_permlane16_swap_b32 v184, v185
    v_mfma_f32_16x16x32_bf16 v[64:67], a[60:63], v[136:139], v[64:67]
    v_fma_f32 v185, -v184, v184, v185
    v_max_f32 v185, 0, v185
    v_mfma_f32_16x16x32_bf16 v[72:75], a[64:67], v[136:139], v[72:75]
    v_add_f32 v185, 0x3727c5ac, v185
    v_rsq_f32 v148, v185
    v_mfma_f32_16x16x32_bf16 v[80:83], a[68:71], v[136:139], v[80:83]
    s_waitcnt vmcnt(6)
    s_waitcnt vmcnt(5)
    s_waitcnt vmcnt(4)
    v_mfma_f32_16x16x32_bf16 v[60:63], a[72:75], v[140:143], v[60:63]
    v_mul_f32_e64 v148, -v148, v182
    v_mul_f32_e64 v149, -v184, v148
    v_mfma_f32_16x16x32_bf16 v[68:71], a[76:79], v[140:143], v[68:71]
    v_mov_b32 v150, v148
    v_mov_b32 v151, v149
    v_mfma_f32_16x16x32_bf16 v[76:79], a[80:83], v[140:143], v[76:79]
    v_mfma_f32_16x16x32_bf16 v[64:67], a[72:75], v[144:147], v[64:67]
    v_permlane32_swap_b32 v148, v150
    v_permlane32_swap_b32 v149, v151
    v_mfma_f32_16x16x32_bf16 v[72:75], a[76:79], v[144:147], v[72:75]
    ds_read2st64_b32 v[184:185], v9 offset0:4 offset1:5
    ds_read2st64_b32 v[186:187], v9 offset0:6 offset1:7
    v_mfma_f32_16x16x32_bf16 v[80:83], a[80:83], v[144:147], v[80:83]
    s_waitcnt vmcnt(3)
    s_waitcnt vmcnt(2)
    s_waitcnt vmcnt(1)
    s_waitcnt lgkmcnt(2)
    v_mfma_f32_16x16x32_bf16 v[60:63], a[84:87], v[108:111], v[60:63]
    v_mfma_f32_16x16x32_bf16 v[68:71], a[88:91], v[108:111], v[68:71]
    v_mfma_f32_16x16x32_bf16 v[76:79], a[92:95], v[108:111], v[76:79]
    v_mfma_f32_16x16x32_bf16 v[64:67], a[84:87], v[112:115], v[64:67]
    v_mfma_f32_16x16x32_bf16 v[72:75], a[88:91], v[112:115], v[72:75]
    v_mfma_f32_16x16x32_bf16 v[80:83], a[92:95], v[112:115], v[80:83]
    s_waitcnt lgkmcnt(0)
    v_add_f32 v184, v184, v186
    v_add_f32 v185, v185, v187
    v_add_f32 v184, v184, v185
    v_mul_f32 v184, 0x3b000000, v184
    v_mov_b32 v185, v184
    s_nop 1
    v_permlane16_swap_b32 v184, v185
    v_fma_f32 v185, -v184, v184, v185
    v_max_f32 v185, 0, v185
    v_add_f32 v185, 0x3727c5ac, v185
    v_rsq_f32 v152, v185
    s_nop 0
    v_mul_f32_e64 v152, -v152, v182
    v_mul_f32_e64 v153, -v184, v152
    v_mov_b32 v154, v152
    v_mov_b32 v155, v153
    s_nop 0
    v_permlane32_swap_b32 v152, v154
    v_permlane32_swap_b32 v153, v155
    ds_read_b128 v[108:111], v1 offset:28672
    ds_read_b128 v[112:115], v1 offset:30720
    ds_read_b128 v[116:119], v1 offset:29696
    ds_read_b128 v[120:123], v1 offset:31744
    ds_read_b128 v[124:127], v1 offset:40960
    ds_read_b128 v[128:131], v1 offset:43008
    s_add_u32 s82, s58, 0xa00000
    s_add_u32 s83, s59, 0xa00000
    s_add_u32 s84, s60, 0xa00000
    v_pk_mul_f32 v[156:157], v[44:45], v[148:149] op_sel:[0,1] op_sel_hi:[1,1]
    v_pk_mul_f32 v[158:159], v[46:47], v[148:149] op_sel:[0,1] op_sel_hi:[1,1]
    v_pk_mul_f32 v[160:161], v[44:45], v[150:151] op_sel:[0,1] op_sel_hi:[1,1]
    v_pk_mul_f32 v[162:163], v[46:47], v[150:151] op_sel:[0,1] op_sel_hi:[1,1]
    v_pk_fma_f32 v[60:61], v[60:61], v[148:149], v[156:157] op_sel:[0,0,0] op_sel_hi:[1,0,1]
    v_pk_fma_f32 v[62:63], v[62:63], v[148:149], v[158:159] op_sel:[0,0,0] op_sel_hi:[1,0,1]
    v_pk_fma_f32 v[64:65], v[64:65], v[150:151], v[160:161] op_sel:[0,0,0] op_sel_hi:[1,0,1]
    v_pk_fma_f32 v[66:67], v[66:67], v[150:151], v[162:163] op_sel:[0,0,0] op_sel_hi:[1,0,1]
    v_exp_f32 v156, v60
    v_exp_f32 v157, v61
    v_exp_f32 v158, v62
    v_exp_f32 v159, v63
    v_exp_f32 v160, v64
    v_exp_f32 v161, v65
    v_exp_f32 v162, v66
    v_exp_f32 v163, v67
    v_pk_fma_f32 v[156:157], v[156:157], v[182:183], v[182:183] op_sel:[0,0,0] op_sel_hi:[1,0,0] neg_lo:[0,1,1] neg_hi:[0,1,1]
    v_pk_fma_f32 v[158:159], v[158:159], v[182:183], v[182:183] op_sel:[0,0,0] op_sel_hi:[1,0,0] neg_lo:[0,1,1] neg_hi:[0,1,1]
    v_pk_fma_f32 v[160:161], v[160:161], v[182:183], v[182:183] op_sel:[0,0,0] op_sel_hi:[1,0,0] neg_lo:[0,1,1] neg_hi:[0,1,1]
    v_pk_fma_f32 v[162:163], v[162:163], v[182:183], v[182:183] op_sel:[0,0,0] op_sel_hi:[1,0,0] neg_lo:[0,1,1] neg_hi:[0,1,1]
    v_rcp_f32 v156, v156
    v_rcp_f32 v157, v157
    v_rcp_f32 v158, v158
    v_rcp_f32 v159, v159
    v_rcp_f32 v160, v160
    v_rcp_f32 v161, v161
    v_rcp_f32 v162, v162
    v_rcp_f32 v163, v163
    v_pk_mul_f32 v[60:61], v[60:61], v[156:157]
    v_pk_mul_f32 v[62:63], v[62:63], v[158:159]
    v_pk_mul_f32 v[64:65], v[64:65], v[160:161]
    v_pk_mul_f32 v[66:67], v[66:67], v[162:163]
    v_cvt_pk_bf16_f32 v60, v60, v61
    v_cvt_pk_bf16_f32 v61, v62, v63
    v_cvt_pk_bf16_f32 v62, v64, v65
    v_cvt_pk_bf16_f32 v63, v66, v67
    s_nop 0
    v_permlane16_swap_b32 v60, v62
    v_permlane16_swap_b32 v61, v63
    s_cmp_eq_u32 s51, 1
    s_cbranch_scc0 Lslow_105
    buffer_store_dwordx4 v[60:63], v5, s[32:35], s82 offen offset:0
Ljoin_106:
    v_pk_mul_f32 v[164:165], v[48:49], v[148:149] op_sel:[0,1] op_sel_hi:[1,1]
    v_pk_mul_f32 v[166:167], v[50:51], v[148:149] op_sel:[0,1] op_sel_hi:[1,1]
    v_pk_mul_f32 v[168:169], v[48:49], v[150:151] op_sel:[0,1] op_sel_hi:[1,1]
    v_pk_mul_f32 v[170:171], v[50:51], v[150:151] op_sel:[0,1] op_sel_hi:[1,1]
    v_pk_fma_f32 v[68:69], v[68:69], v[148:149], v[164:165] op_sel:[0,0,0] op_sel_hi:[1,0,1]
    v_pk_fma_f32 v[70:71], v[70:71], v[148:149], v[166:167] op_sel:[0,0,0] op_sel_hi:[1,0,1]
    v_pk_fma_f32 v[72:73], v[72:73], v[150:151], v[168:169] op_sel:[0,0,0] op_sel_hi:[1,0,1]
    v_pk_fma_f32 v[74:75], v[74:75], v[150:151], v[170:171] op_sel:[0,0,0] op_sel_hi:[1,0,1]
    v_exp_f32 v164, v68
    v_exp_f32 v165, v69
    v_exp_f32 v166, v70
    v_exp_f32 v167, v71
    v_exp_f32 v168, v72
    v_exp_f32 v169, v73
    v_exp_f32 v170, v74
    v_exp_f32 v171, v75
    v_pk_fma_f32 v[164:165], v[164:165], v[182:183], v[182:183] op_sel:[0,0,0] op_sel_hi:[1,0,0] neg_lo:[0,1,1] neg_hi:[0,1,1]
    v_pk_fma_f32 v[166:167], v[166:167], v[182:183], v[182:183] op_sel:[0,0,0] op_sel_hi:[1,0,0] neg_lo:[0,1,1] neg_hi:[0,1,1]
    v_pk_fma_f32 v[168:169], v[168:169], v[182:183], v[182:183] op_sel:[0,0,0] op_sel_hi:[1,0,0] neg_lo:[0,1,1] neg_hi:[0,1,1]
    v_pk_fma_f32 v[170:171], v[170:171], v[182:183], v[182:183] op_sel:[0,0,0] op_sel_hi:[1,0,0] neg_lo:[0,1,1] neg_hi:[0,1,1]
    v_rcp_f32 v164, v164
    v_rcp_f32 v165, v165
    v_rcp_f32 v166, v166
    v_rcp_f32 v167, v167
    v_rcp_f32 v168, v168
    v_rcp_f32 v169, v169
    v_rcp_f32 v170, v170
    v_rcp_f32 v171, v171
    v_pk_mul_f32 v[68:69], v[68:69], v[164:165]
    v_pk_mul_f32 v[70:71], v[70:71], v[166:167]
    v_pk_mul_f32 v[72:73], v[72:73], v[168:169]
    v_pk_mul_f32 v[74:75], v[74:75], v[170:171]
    v_cvt_pk_bf16_f32 v68, v68, v69
    v_cvt_pk_bf16_f32 v69, v70, v71
    v_cvt_pk_bf16_f32 v70, v72, v73
    v_cvt_pk_bf16_f32 v71, v74, v75
    s_nop 0
    v_permlane16_swap_b32 v68, v70
    v_permlane16_swap_b32 v69, v71
    s_cmp_eq_u32 s51, 1
    s_cbranch_scc0 Lslow_107
    buffer_store_dwordx4 v[68:71], v5, s[32:35], s83 offen offset:0
Ljoin_108:
    v_pk_mul_f32 v[156:157], v[52:53], v[148:149] op_sel:[0,1] op_sel_hi:[1,1]
    v_pk_mul_f32 v[158:159], v[54:55], v[148:149] op_sel:[0,1] op_sel_hi:[1,1]
    v_pk_mul_f32 v[160:161], v[52:53], v[150:151] op_sel:[0,1] op_sel_hi:[1,1]
    v_pk_mul_f32 v[162:163], v[54:55], v[150:151] op_sel:[0,1] op_sel_hi:[1,1]
    v_pk_fma_f32 v[76:77], v[76:77], v[148:149], v[156:157] op_sel:[0,0,0] op_sel_hi:[1,0,1]
    v_pk_fma_f32 v[78:79], v[78:79], v[148:149], v[158:159] op_sel:[0,0,0] op_sel_hi:[1,0,1]
    v_pk_fma_f32 v[80:81], v[80:81], v[150:151], v[160:161] op_sel:[0,0,0] op_sel_hi:[1,0,1]
    v_pk_fma_f32 v[82:83], v[82:83], v[150:151], v[162:163] op_sel:[0,0,0] op_sel_hi:[1,0,1]
    v_exp_f32 v156, v76
    v_exp_f32 v157, v77
    v_exp_f32 v158, v78
    v_exp_f32 v159, v79
    v_exp_f32 v160, v80
    v_exp_f32 v161, v81
    v_exp_f32 v162, v82
    v_exp_f32 v163, v83
    v_pk_fma_f32 v[156:157], v[156:157], v[182:183], v[182:183] op_sel:[0,0,0] op_sel_hi:[1,0,0] neg_lo:[0,1,1] neg_hi:[0,1,1]
    v_pk_fma_f32 v[158:159], v[158:159], v[182:183], v[182:183] op_sel:[0,0,0] op_sel_hi:[1,0,0] neg_lo:[0,1,1] neg_hi:[0,1,1]
    v_pk_fma_f32 v[160:161], v[160:161], v[182:183], v[182:183] op_sel:[0,0,0] op_sel_hi:[1,0,0] neg_lo:[0,1,1] neg_hi:[0,1,1]
    v_pk_fma_f32 v[162:163], v[162:163], v[182:183], v[182:183] op_sel:[0,0,0] op_sel_hi:[1,0,0] neg_lo:[0,1,1] neg_hi:[0,1,1]
    v_rcp_f32 v156, v156
    v_rcp_f32 v157, v157
    v_rcp_f32 v158, v158
    v_rcp_f32 v159, v159
    v_rcp_f32 v160, v160
    v_rcp_f32 v161, v161
    v_rcp_f32 v162, v162
    v_rcp_f32 v163, v163
    v_pk_mul_f32 v[76:77], v[76:77], v[156:157]
    v_pk_mul_f32 v[78:79], v[78:79], v[158:159]
    v_pk_mul_f32 v[80:81], v[80:81], v[160:161]
    v_pk_mul_f32 v[82:83], v[82:83], v[162:163]
    v_cvt_pk_bf16_f32 v76, v76, v77
    v_cvt_pk_bf16_f32 v77, v78, v79
    v_cvt_pk_bf16_f32 v78, v80, v81
    v_cvt_pk_bf16_f32 v79, v82, v83
    s_nop 0
    v_permlane16_swap_b32 v76, v78
    v_permlane16_swap_b32 v77, v79
    s_cmp_eq_u32 s51, 1
    s_cbranch_scc0 Lslow_109
    buffer_store_dwordx4 v[76:79], v5, s[32:35], s84 offen offset:0
Ljoin_110:
    s_waitcnt lgkmcnt(4)
    v_mfma_f32_16x16x32_bf16 v[84:87], a[24:27], v[108:111], v[84:87]
    ds_read_b128 v[132:135], v1 offset:41984
    v_mfma_f32_16x16x32_bf16 v[92:95], a[28:31], v[108:111], v[92:95]
    v_mfma_f32_16x16x32_bf16 v[100:103], a[32:35], v[108:111], v[100:103]
    v_mfma_f32_16x16x32_bf16 v[88:91], a[24:27], v[112:115], v[88:91]
    ds_read_b128 v[136:139], v1 offset:44032
    v_mfma_f32_16x16x32_bf16 v[96:99], a[28:31], v[112:115], v[96:99]
    v_mfma_f32_16x16x32_bf16 v[104:107], a[32:35], v[112:115], v[104:107]
    s_waitcnt lgkmcnt(4)
    v_mfma_f32_16x16x32_bf16 v[84:87], a[36:39], v[116:119], v[84:87]
    ds_read_b128 v[140:143], v1 offset:45056
    v_mfma_f32_16x16x32_bf16 v[92:95], a[40:43], v[116:119], v[92:95]
    v_mfma_f32_16x16x32_bf16 v[100:103], a[44:47], v[116:119], v[100:103]
    v_mfma_f32_16x16x32_bf16 v[88:91], a[36:39], v[120:123], v[88:91]
    ds_read_b128 v[144:147], v1 offset:47104
    v_mfma_f32_16x16x32_bf16 v[96:99], a[40:43], v[120:123], v[96:99]
    v_mfma_f32_16x16x32_bf16 v[104:107], a[44:47], v[120:123], v[104:107]
    s_waitcnt lgkmcnt(4)
    v_mfma_f32_16x16x32_bf16 v[84:87], a[48:51], v[124:127], v[84:87]
    ds_read_b128 v[108:111], v1 offset:46080
    v_mfma_f32_16x16x32_bf16 v[92:95], a[52:55], v[124:127], v[92:95]
    v_mfma_f32_16x16x32_bf16 v[100:103], a[56:59], v[124:127], v[100:103]
    v_mfma_f32_16x16x32_bf16 v[88:91], a[48:51], v[128:131], v[88:91]
    ds_read_b128 v[112:115], v1 offset:48128
    v_mfma_f32_16x16x32_bf16 v[96:99], a[52:55], v[128:131], v[96:99]
    v_mfma_f32_16x16x32_bf16 v[104:107], a[56:59], v[128:131], v[104:107]
    s_waitcnt lgkmcnt(4)
    v_mfma_f32_16x16x32_bf16 v[84:87], a[60:63], v[132:135], v[84:87]
    v_mfma_f32_16x16x32_bf16 v[92:95], a[64:67], v[132:135], v[92:95]
    v_mfma_f32_16x16x32_bf16 v[100:103], a[68:71], v[132:135], v[100:103]
    v_mfma_f32_16x16x32_bf16 v[88:91], a[60:63], v[136:139], v[88:91]
    v_mfma_f32_16x16x32_bf16 v[96:99], a[64:67], v[136:139], v[96:99]
    v_mfma_f32_16x16x32_bf16 v[104:107], a[68:71], v[136:139], v[104:107]
    s_waitcnt lgkmcnt(2)
    v_mfma_f32_16x16x32_bf16 v[84:87], a[72:75], v[140:143], v[84:87]
    v_mfma_f32_16x16x32_bf16 v[92:95], a[76:79], v[140:143], v[92:95]
    v_mfma_f32_16x16x32_bf16 v[100:103], a[80:83], v[140:143], v[100:103]
    s_add_u32 s76, s22, 11
    v_mov_b32 v19, s76
    s_waitcnt vmcnt(0)
    s_mov_b64 exec, 1
    s_cmp_eq_u32 s51, 1
    s_cbranch_scc0 Lslow_111
    buffer_store_dword v19, off, s[32:35], s98
Ljoin_112:
    s_mov_b64 exec, -1
    v_mfma_f32_16x16x32_bf16 v[88:91], a[72:75], v[144:147], v[88:91]
    v_mfma_f32_16x16x32_bf16 v[96:99], a[76:79], v[144:147], v[96:99]
    v_mfma_f32_16x16x32_bf16 v[104:107], a[80:83], v[144:147], v[104:107]
    s_waitcnt lgkmcnt(0)
    v_mfma_f32_16x16x32_bf16 v[84:87], a[84:87], v[108:111], v[84:87]
    v_mfma_f32_16x16x32_bf16 v[92:95], a[88:91], v[108:111], v[92:95]
    v_mfma_f32_16x16x32_bf16 v[100:103], a[92:95], v[108:111], v[100:103]
    v_mfma_f32_16x16x32_bf16 v[88:91], a[84:87], v[112:115], v[88:91]
    v_mfma_f32_16x16x32_bf16 v[96:99], a[88:91], v[112:115], v[96:99]
    v_mfma_f32_16x16x32_bf16 v[104:107], a[92:95], v[112:115], v[104:107]
    s_add_u32 s82, s58, 0xa16000
    s_add_u32 s83, s59, 0xa16000
    s_add_u32 s84, s60, 0xa16000
    v_pk_mul_f32 v[156:157], v[44:45], v[152:153] op_sel:[0,1] op_sel_hi:[1,1]
    v_pk_mul_f32 v[158:159], v[46:47], v[152:153] op_sel:[0,1] op_sel_hi:[1,1]
    v_pk_mul_f32 v[160:161], v[44:45], v[154:155] op_sel:[0,1] op_sel_hi:[1,1]
    v_pk_mul_f32 v[162:163], v[46:47], v[154:155] op_sel:[0,1] op_sel_hi:[1,1]
    v_pk_fma_f32 v[84:85], v[84:85], v[152:153], v[156:157] op_sel:[0,0,0] op_sel_hi:[1,0,1]
    v_pk_fma_f32 v[86:87], v[86:87], v[152:153], v[158:159] op_sel:[0,0,0] op_sel_hi:[1,0,1]
    v_pk_fma_f32 v[88:89], v[88:89], v[154:155], v[160:161] op_sel:[0,0,0] op_sel_hi:[1,0,1]
    v_pk_fma_f32 v[90:91], v[90:91], v[154:155], v[162:163] op_sel:[0,0,0] op_sel_hi:[1,0,1]
    v_exp_f32 v156, v84
    v_exp_f32 v157, v85
    v_exp_f32 v158, v86
    v_exp_f32 v159, v87
    v_exp_f32 v160, v88
    v_exp_f32 v161, v89
    v_exp_f32 v162, v90
    v_exp_f32 v163, v91
    v_pk_fma_f32 v[156:157], v[156:157], v[182:183], v[182:183] op_sel:[0,0,0] op_sel_hi:[1,0,0] neg_lo:[0,1,1] neg_hi:[0,1,1]
    v_pk_fma_f32 v[158:159], v[158:159], v[182:183], v[182:183] op_sel:[0,0,0] op_sel_hi:[1,0,0] neg_lo:[0,1,1] neg_hi:[0,1,1]
    v_pk_fma_f32 v[160:161], v[160:161], v[182:183], v[182:183] op_sel:[0,0,0] op_sel_hi:[1,0,0] neg_lo:[0,1,1] neg_hi:[0,1,1]
    v_pk_fma_f32 v[162:163], v[162:163], v[182:183], v[182:183] op_sel:[0,0,0] op_sel_hi:[1,0,0] neg_lo:[0,1,1] neg_hi:[0,1,1]
    v_rcp_f32 v156, v156
    v_rcp_f32 v157, v157
    v_rcp_f32 v158, v158
    v_rcp_f32 v159, v159
    v_rcp_f32 v160, v160
    v_rcp_f32 v161, v161
    v_rcp_f32 v162, v162
    v_rcp_f32 v163, v163
    v_pk_mul_f32 v[84:85], v[84:85], v[156:157]
    v_pk_mul_f32 v[86:87], v[86:87], v[158:159]
    v_pk_mul_f32 v[88:89], v[88:89], v[160:161]
    v_pk_mul_f32 v[90:91], v[90:91], v[162:163]
    v_cvt_pk_bf16_f32 v84, v84, v85
    v_cvt_pk_bf16_f32 v85, v86, v87
    v_cvt_pk_bf16_f32 v86, v88, v89
    v_cvt_pk_bf16_f32 v87, v90, v91
    s_nop 0
    v_permlane16_swap_b32 v84, v86
    v_permlane16_swap_b32 v85, v87
    s_cmp_eq_u32 s51, 1
    s_cbranch_scc0 Lslow_113
    buffer_store_dwordx4 v[84:87], v5, s[32:35], s82 offen offset:0
Ljoin_114:
    buffer_load_dword v180, v14, s[32:35], s54 offen sc1
    v_pk_mul_f32 v[164:165], v[48:49], v[152:153] op_sel:[0,1] op_sel_hi:[1,1]
    v_pk_mul_f32 v[166:167], v[50:51], v[152:153] op_sel:[0,1] op_sel_hi:[1,1]
    v_pk_mul_f32 v[168:169], v[48:49], v[154:155] op_sel:[0,1] op_sel_hi:[1,1]
    v_pk_mul_f32 v[170:171], v[50:51], v[154:155] op_sel:[0,1] op_sel_hi:[1,1]
    v_pk_fma_f32 v[92:93], v[92:93], v[152:153], v[164:165] op_sel:[0,0,0] op_sel_hi:[1,0,1]
    v_pk_fma_f32 v[94:95], v[94:95], v[152:153], v[166:167] op_sel:[0,0,0] op_sel_hi:[1,0,1]
    v_pk_fma_f32 v[96:97], v[96:97], v[154:155], v[168:169] op_sel:[0,0,0] op_sel_hi:[1,0,1]
    v_pk_fma_f32 v[98:99], v[98:99], v[154:155], v[170:171] op_sel:[0,0,0] op_sel_hi:[1,0,1]
    v_exp_f32 v164, v92
    v_exp_f32 v165, v93
    v_exp_f32 v166, v94
    v_exp_f32 v167, v95
    v_exp_f32 v168, v96
    v_exp_f32 v169, v97
    v_exp_f32 v170, v98
    v_exp_f32 v171, v99
    v_pk_fma_f32 v[164:165], v[164:165], v[182:183], v[182:183] op_sel:[0,0,0] op_sel_hi:[1,0,0] neg_lo:[0,1,1] neg_hi:[0,1,1]
    v_pk_fma_f32 v[166:167], v[166:167], v[182:183], v[182:183] op_sel:[0,0,0] op_sel_hi:[1,0,0] neg_lo:[0,1,1] neg_hi:[0,1,1]
    v_pk_fma_f32 v[168:169], v[168:169], v[182:183], v[182:183] op_sel:[0,0,0] op_sel_hi:[1,0,0] neg_lo:[0,1,1] neg_hi:[0,1,1]
    v_pk_fma_f32 v[170:171], v[170:171], v[182:183], v[182:183] op_sel:[0,0,0] op_sel_hi:[1,0,0] neg_lo:[0,1,1] neg_hi:[0,1,1]
    v_rcp_f32 v164, v164
    v_rcp_f32 v165, v165
    v_rcp_f32 v166, v166
    v_rcp_f32 v167, v167
    v_rcp_f32 v168, v168
    v_rcp_f32 v169, v169
    v_rcp_f32 v170, v170
    v_rcp_f32 v171, v171
    v_pk_mul_f32 v[92:93], v[92:93], v[164:165]
    v_pk_mul_f32 v[94:95], v[94:95], v[166:167]
    v_pk_mul_f32 v[96:97], v[96:97], v[168:169]
    v_pk_mul_f32 v[98:99], v[98:99], v[170:171]
    v_cvt_pk_bf16_f32 v92, v92, v93
    v_cvt_pk_bf16_f32 v93, v94, v95
    v_cvt_pk_bf16_f32 v94, v96, v97
    v_cvt_pk_bf16_f32 v95, v98, v99
    s_nop 0
    v_permlane16_swap_b32 v92, v94
    v_permlane16_swap_b32 v93, v95
    s_cmp_eq_u32 s51, 1
    s_cbranch_scc0 Lslow_115
    buffer_store_dwordx4 v[92:95], v5, s[32:35], s83 offen offset:0
Ljoin_116:
    s_add_u32 s76, s22, 11
    s_waitcnt vmcnt(1)
    s_branch Lpc_119
Lpoll_117:
    buffer_load_dword v180, v14, s[32:35], s54 offen sc1
    s_waitcnt vmcnt(0)
Lpc_119:
    v_subrev_u32 v180, s76, v180
    v_cmp_gt_u32 vcc, 5, v180
    s_nop 1
    s_cmp_eq_u64 vcc, exec
    s_cbranch_scc1 Lpd_118
    s_sub_u32 s61, s61, 1
    s_cmp_lg_u32 s61, 0
    s_cbranch_scc1 Lpoll_117
    s_branch L_end
Lpd_118:
    s_add_u32 m0, s99, 0x10000
    s_add_u32 s101, s56, 0xa00000
    buffer_load_dwordx4 v181, s[32:35], s101 offen offset:0 sc1 lds
    buffer_load_dwordx4 v181, s[32:35], s101 offen offset:1024 sc1 lds
    s_add_u32 m0, s99, 0x12000
    s_add_u32 s101, s56, 0xa02000
    buffer_load_dwordx4 v181, s[32:35], s101 offen offset:0 sc1 lds
    buffer_load_dwordx4 v181, s[32:35], s101 offen offset:1024 sc1 lds
    v_pk_mul_f32 v[156:157], v[52:53], v[152:153] op_sel:[0,1] op_sel_hi:[1,1]
    v_pk_mul_f32 v[158:159], v[54:55], v[152:153] op_sel:[0,1] op_sel_hi:[1,1]
    v_pk_mul_f32 v[160:161], v[52:53], v[154:155] op_sel:[0,1] op_sel_hi:[1,1]
    v_pk_mul_f32 v[162:163], v[54:55], v[154:155] op_sel:[0,1] op_sel_hi:[1,1]
    v_pk_fma_f32 v[100:101], v[100:101], v[152:153], v[156:157] op_sel:[0,0,0] op_sel_hi:[1,0,1]
    v_pk_fma_f32 v[102:103], v[102:103], v[152:153], v[158:159] op_sel:[0,0,0] op_sel_hi:[1,0,1]
    v_pk_fma_f32 v[104:105], v[104:105], v[154:155], v[160:161] op_sel:[0,0,0] op_sel_hi:[1,0,1]
    v_pk_fma_f32 v[106:107], v[106:107], v[154:155], v[162:163] op_sel:[0,0,0] op_sel_hi:[1,0,1]
    v_exp_f32 v156, v100
    v_exp_f32 v157, v101
    v_exp_f32 v158, v102
    v_exp_f32 v159, v103
    s_add_u32 m0, s99, 0x0
    s_add_u32 s101, s56, 0xa04000
    buffer_load_dwordx4 v181, s[32:35], s101 offen offset:0 sc1 lds
    v_exp_f32 v160, v104
    v_exp_f32 v161, v105
    v_exp_f32 v162, v106
    v_exp_f32 v163, v107
    v_pk_fma_f32 v[156:157], v[156:157], v[182:183], v[182:183] op_sel:[0,0,0] op_sel_hi:[1,0,0] neg_lo:[0,1,1] neg_hi:[0,1,1]
    v_pk_fma_f32 v[158:159], v[158:159], v[182:183], v[182:183] op_sel:[0,0,0] op_sel_hi:[1,0,0] neg_lo:[0,1,1] neg_hi:[0,1,1]
    v_pk_fma_f32 v[160:161], v[160:161], v[182:183], v[182:183] op_sel:[0,0,0] op_sel_hi:[1,0,0] neg_lo:[0,1,1] neg_hi:[0,1,1]
    v_pk_fma_f32 v[162:163], v[162:163], v[182:183], v[182:183] op_sel:[0,0,0] op_sel_hi:[1,0,0] neg_lo:[0,1,1] neg_hi:[0,1,1]
    v_rcp_f32 v156, v156
    v_rcp_f32 v157, v157
    buffer_load_dwordx4 v181, s[32:35], s101 offen offset:1024 sc1 lds
    v_rcp_f32 v158, v158
    v_rcp_f32 v159, v159
    v_rcp_f32 v160, v160
    v_rcp_f32 v161, v161
    v_rcp_f32 v162, v162
    v_rcp_f32 v163, v163
    v_pk_mul_f32 v[100:101], v[100:101], v[156:157]
    v_pk_mul_f32 v[102:103], v[102:103], v[158:159]
    v_pk_mul_f32 v[104:105], v[104:105], v[160:161]
    s_add_u32 m0, s99, 0x2000
    s_add_u32 s101, s56, 0xa06000
    buffer_load_dwordx4 v181, s[32:35], s101 offen offset:0 sc1 lds
    v_pk_mul_f32 v[106:107], v[106:107], v[162:163]
    v_cvt_pk_bf16_f32 v100, v100, v101
    v_cvt_pk_bf16_f32 v101, v102, v103
    v_cvt_pk_bf16_f32 v102, v104, v105
    v_cvt_pk_bf16_f32 v103, v106, v107
    s_nop 0
    v_permlane16_swap_b32 v100, v102
    v_permlane16_swap_b32 v101, v103
    s_cmp_eq_u32 s51, 1
    s_cbranch_scc0 Lslow_120
    buffer_store_dwordx4 v[100:103], v5, s[32:35], s84 offen offset:0
Ljoin_121:
    buffer_load_dwordx4 v181, s[32:35], s101 offen offset:1024 sc1 lds
    s_add_u32 m0, s99, 0x4000
    s_add_u32 s101, s56, 0xa08000
    buffer_load_dwordx4 v181, s[32:35], s101 offen offset:0 sc1 lds
    buffer_load_dwordx4 v181, s[32:35], s101 offen offset:1024 sc1 lds
    s_waitcnt vmcnt(9)
    s_barrier
    ds_read_b128 v[108:111], v2 offset:0
    ds_read_b128 v[112:115], v2 offset:2048
    ds_read_b128 v[116:119], v2 offset:1024
    ds_read_b128 v[120:123], v2 offset:3072
    ds_read_b128 v[124:127], v2 offset:4096
    ds_read_b128 v[128:131], v2 offset:6144
    ds_read_b128 v[132:135], v2 offset:5120
    ds_read_b128 v[136:139], v2 offset:7168
    s_waitcnt vmcnt(7)
    s_barrier
    ds_read_b128 v[140:143], v2 offset:8192
    s_waitcnt lgkmcnt(7)
    v_mfma_f32_16x16x32_bf16 v[20:23], a[196:199], v[108:111], v[20:23]
    ds_read_b128 v[144:147], v2 offset:10240
    s_add_u32 m0, s99, 0x6000
    v_mfma_f32_16x16x32_bf16 v[24:27], a[196:199], v[112:115], v[24:27]
    ds_read_b128 v[108:111], v2 offset:9216
    s_add_u32 s101, s56, 0xa0a000
    s_waitcnt lgkmcnt(7)
    v_mfma_f32_16x16x32_bf16 v[20:23], a[200:203], v[116:119], v[20:23]
    buffer_load_dwordx4 v181, s[32:35], s101 offen offset:0 sc1 lds
    v_mfma_f32_16x16x32_bf16 v[24:27], a[200:203], v[120:123], v[24:27]
    ds_read_b128 v[112:115], v2 offset:11264
    ds_read_b128 v[116:119], v2 offset:12288
    s_waitcnt lgkmcnt(7)
    v_mfma_f32_16x16x32_bf16 v[20:23], a[204:207], v[124:127], v[20:23]
    buffer_load_dwordx4 v181, s[32:35], s101 offen offset:1024 sc1 lds
    v_mfma_f32_16x16x32_bf16 v[24:27], a[204:207], v[128:131], v[24:27]
    ds_read_b128 v[120:123], v2 offset:14336
    ds_read_b128 v[124:127], v2 offset:13312
    s_waitcnt lgkmcnt(7)
    v_mfma_f32_16x16x32_bf16 v[20:23], a[208:211], v[132:135], v[20:23]
    ds_read_b128 v[128:131], v2 offset:15360
    s_add_u32 m0, s99, 0x8000
    v_mfma_f32_16x16x32_bf16 v[24:27], a[208:211], v[136:139], v[24:27]
    s_waitcnt vmcnt(4)
    s_barrier
    ds_read_b128 v[132:135], v1 offset:0
    s_add_u32 s101, s56, 0xa0c000
    s_waitcnt lgkmcnt(7)
    v_mfma_f32_16x16x32_bf16 v[20:23], a[212:215], v[140:143], v[20:23]
    buffer_load_dwordx4 v181, s[32:35], s101 offen offset:0 sc1 lds
    v_mfma_f32_16x16x32_bf16 v[24:27], a[212:215], v[144:147], v[24:27]
    ds_read_b128 v[136:139], v1 offset:2048
    ds_read_b128 v[140:143], v1 offset:1024
    s_waitcnt lgkmcnt(7)
    v_mfma_f32_16x16x32_bf16 v[20:23], a[216:219], v[108:111], v[20:23]
    buffer_load_dwordx4 v181, s[32:35], s101 offen offset:1024 sc1 lds
    v_mfma_f32_16x16x32_bf16 v[24:27], a[216:219], v[112:115], v[24:27]
    ds_read_b128 v[144:147], v1 offset:3072
    ds_read_b128 v[108:111], v1 offset:4096
    s_waitcnt lgkmcnt(7)
    v_mfma_f32_16x16x32_bf16 v[20:23], a[220:223], v[116:119], v[20:23]
    ds_read_b128 v[112:115], v1 offset:6144
    s_add_u32 m0, s99, 0xa000
    v_mfma_f32_16x16x32_bf16 v[24:27], a[220:223], v[120:123], v[24:27]
    ds_read_b128 v[116:119], v1 offset:5120
    s_add_u32 s101, s56, 0xa0e000
    s_waitcnt lgkmcnt(7)
    v_mfma_f32_16x16x32_bf16 v[20:23], a[224:227], v[124:127], v[20:23]
    buffer_load_dwordx4 v181, s[32:35], s101 offen offset:0 sc1 lds
    s_add_u32 s76, s22, 12
    v_mov_b32 v19, s76
    s_mov_b64 exec, 1
    s_cmp_eq_u32 s51, 1
    s_cbranch_scc0 Lslow_122
    buffer_store_dword v19, off, s[32:35], s98
Ljoin_123:
    s_mov_b64 exec, -1
    v_mfma_f32_16x16x32_bf16 v[24:27], a[224:227], v[128:131], v[24:27]
    ds_read_b128 v[120:123], v1 offset:7168
    ds_read_b128 v[124:127], v1 offset:8192
    s_waitcnt lgkmcnt(7)
    v_mfma_f32_16x16x32_bf16 v[20:23], a[228:231], v[132:135], v[20:23]
    buffer_load_dwordx4 v181, s[32:35], s101 offen offset:1024 sc1 lds
    v_mfma_f32_16x16x32_bf16 v[24:27], a[228:231], v[136:139], v[24:27]
    ds_read_b128 v[128:131], v1 offset:10240
    ds_read_b128 v[132:135], v1 offset:9216
    s_waitcnt lgkmcnt(7)
    v_mfma_f32_16x16x32_bf16 v[20:23], a[232:235], v[140:143], v[20:23]
    ds_read_b128 v[136:139], v1 offset:11264
    s_add_u32 m0, s99, 0xc000
    v_mfma_f32_16x16x32_bf16 v[24:27], a[232:235], v[144:147], v[24:27]
    ds_read_b128 v[140:143], v1 offset:12288
    s_add_u32 s101, s56, 0xa10000
    s_waitcnt lgkmcnt(7)
    v_mfma_f32_16x16x32_bf16 v[20:23], a[236:239], v[108:111], v[20:23]
    buffer_load_dwordx4 v181, s[32:35], s101 offen offset:0 sc1 lds
    v_mfma_f32_16x16x32_bf16 v[24:27], a[236:239], v[112:115], v[24:27]
    ds_read_b128 v[144:147], v1 offset:14336
    ds_read_b128 v[108:111], v1 offset:13312
    s_waitcnt lgkmcnt(7)
    v_mfma_f32_16x16x32_bf16 v[20:23], a[240:243], v[116:119], v[20:23]
    buffer_load_dwordx4 v181, s[32:35], s101 offen offset:1024 sc1 lds
    v_mfma_f32_16x16x32_bf16 v[24:27], a[240:243], v[120:123], v[24:27]
    ds_read_b128 v[112:115], v1 offset:15360
    s_waitcnt vmcnt(7)
    s_barrier
    ds_read_b128 v[116:119], v1 offset:16384
    s_waitcnt lgkmcnt(7)
    v_mfma_f32_16x16x32_bf16 v[20:23], a[244:247], v[124:127], v[20:23]
    ds_read_b128 v[120:123], v1 offset:18432
    s_add_u32 m0, s99, 0xe000
    v_mfma_f32_16x16x32_bf16 v[24:27], a[244:247], v[128:131], v[24:27]
    ds_read_b128 v[124:127], v1 offset:17408
    s_add_u32 s101, s56, 0xa12000
    s_waitcnt lgkmcnt(7)
    v_mfma_f32_16x16x32_bf16 v[20:23], a[248:251], v[132:135], v[20:23]
    buffer_load_dwordx4 v181, s[32:35], s101 offen offset:0 sc1 lds
    v_mfma_f32_16x16x32_bf16 v[24:27], a[248:251], v[136:139], v[24:27]
    ds_read_b128 v[128:131], v1 offset:19456
    ds_read_b128 v[132:135], v1 offset:20480
    s_waitcnt lgkmcnt(7)
    v_mfma_f32_16x16x32_bf16 v[20:23], a[252:255], v[140:143], v[20:23]
    buffer_load_dwordx4 v181, s[32:35], s101 offen offset:1024 sc1 lds
    v_mfma_f32_16x16x32_bf16 v[24:27], a[252:255], v[144:147], v[24:27]
    ds_read_b128 v[136:139], v1 offset:22528
    ds_read_b128 v[140:143], v1 offset:21504
    s_waitcnt lgkmcnt(7)
    v_mfma_f32_16x16x32_bf16 v[20:23], v[196:199], v[108:111], v[20:23]
    ds_read_b128 v[144:147], v1 offset:23552
    s_add_u32 m0, s99, 0x10000
    v_mfma_f32_16x16x32_bf16 v[24:27], v[196:199], v[112:115], v[24:27]
    ds_read_b128 v[108:111], v1 offset:24576
    s_add_u32 s101, s56, 0xa14000
    s_waitcnt lgkmcnt(7)
    v_mfma_f32_16x16x32_bf16 v[20:23], v[200:203], v[116:119], v[20:23]
    buffer_load_dwordx4 v181, s[32:35], s101 offen offset:0 sc1 lds
    v_mfma_f32_16x16x32_bf16 v[24:27], v[200:203], v[120:123], v[24:27]
    ds_read_b128 v[112:115], v1 offset:26624
    ds_read_b128 v[116:119], v1 offset:25600
    s_waitcnt lgkmcnt(7)
    v_mfma_f32_16x16x32_bf16 v[20:23], v[204:207], v[124:127], v[20:23]
    buffer_load_dwordx4 v181, s[32:35], s101 offen offset:1024 sc1 lds
    buffer_load_dword v180, v14, s[32:35], s54 offen sc1
    v_mfma_f32_16x16x32_bf16 v[24:27], v[204:207], v[128:131], v[24:27]
    ds_read_b128 v[120:123], v1 offset:27648
    ds_read_b128 v[124:127], v1 offset:28672
    s_waitcnt lgkmcnt(7)
    v_mfma_f32_16x16x32_bf16 v[20:23], v[208:211], v[132:135], v[20:23]
    ds_read_b128 v[128:131], v1 offset:30720
    v_mfma_f32_16x16x32_bf16 v[24:27], v[208:211], v[136:139], v[24:27]
    ds_read_b128 v[132:135], v1 offset:29696
    s_waitcnt lgkmcnt(7)
    v_mfma_f32_16x16x32_bf16 v[20:23], v[212:215], v[140:143], v[20:23]
    ds_read_b128 v[136:139], v1 offset:31744
    v_mfma_f32_16x16x32_bf16 v[24:27], v[212:215], v[144:147], v[24:27]
    s_waitcnt vmcnt(7)
    s_barrier
    ds_read_b128 v[140:143], v1 offset:32768
    s_waitcnt lgkmcnt(7)
    v_mfma_f32_16x16x32_bf16 v[20:23], v[216:219], v[108:111], v[20:23]
    ds_read_b128 v[144:147], v1 offset:34816
    v_mfma_f32_16x16x32_bf16 v[24:27], v[216:219], v[112:115], v[24:27]
    ds_read_b128 v[108:111], v1 offset:33792
    s_waitcnt lgkmcnt(7)
    v_mfma_f32_16x16x32_bf16 v[20:23], v[220:223], v[116:119], v[20:23]
    ds_read_b128 v[112:115], v1 offset:35840
    v_mfma_f32_16x16x32_bf16 v[24:27], v[220:223], v[120:123], v[24:27]
    ds_read_b128 v[116:119], v1 offset:36864
    s_waitcnt lgkmcnt(7)
    v_mfma_f32_16x16x32_bf16 v[20:23], v[224:227], v[124:127], v[20:23]
    ds_read_b128 v[120:123], v1 offset:38912
    v_mfma_f32_16x16x32_bf16 v[24:27], v[224:227], v[128:131], v[24:27]
    ds_read_b128 v[124:127], v1 offset:37888
    s_waitcnt lgkmcnt(7)
    v_mfma_f32_16x16x32_bf16 v[20:23], v[228:231], v[132:135], v[20:23]
    ds_read_b128 v[128:131], v1 offset:39936
    s_add_u32 s76, s22, 12
    s_waitcnt vmcnt(0)
    s_branch Lpc_126
Lpoll_124:
    buffer_load_dword v180, v14, s[32:35], s54 offen sc1
    s_waitcnt vmcnt(0)
Lpc_126:
    v_subrev_u32 v180, s76, v180
    v_cmp_gt_u32 vcc, 4, v180
    s_nop 1
    s_cmp_eq_u64 vcc, exec
    s_cbranch_scc1 Lpd_125
    s_sub_u32 s61, s61, 1
    s_cmp_lg_u32 s61, 0
    s_cbranch_scc1 Lpoll_124
    s_branch L_end
Lpd_125:
    s_add_u32 m0, s99, 0x12000
    s_add_u32 s101, s56, 0xa16000
    buffer_load_dwordx4 v181, s[32:35], s101 offen offset:0 sc1 lds
    buffer_load_dwordx4 v181, s[32:35], s101 offen offset:1024 sc1 lds
    s_add_u32 m0, s99, 0x0
    s_add_u32 s101, s56, 0xa18000
    buffer_load_dwordx4 v181, s[32:35], s101 offen offset:0 sc1 lds
    buffer_load_dwordx4 v181, s[32:35], s101 offen offset:1024 sc1 lds
    v_mfma_f32_16x16x32_bf16 v[24:27], v[228:231], v[136:139], v[24:27]
    ds_read_b128 v[132:135], v1 offset:40960
    s_add_u32 m0, s99, 0x2000
    s_waitcnt lgkmcnt(7)
    v_mfma_f32_16x16x32_bf16 v[20:23], v[252:255], v[140:143], v[20:23]
    ds_read_b128 v[136:139], v1 offset:43008
    s_add_u32 s101, s56, 0xa1a000
    v_mfma_f32_16x16x32_bf16 v[24:27], v[252:255], v[144:147], v[24:27]
    buffer_load_dwordx4 v181, s[32:35], s101 offen offset:0 sc1 lds
    s_waitcnt lgkmcnt(6)
    v_mfma_f32_16x16x32_bf16 v[20:23], v[248:251], v[108:111], v[20:23]
    ds_read_b128 v[140:143], v1 offset:41984
    ds_read_b128 v[144:147], v1 offset:44032
    v_mfma_f32_16x16x32_bf16 v[24:27], v[248:251], v[112:115], v[24:27]
    buffer_load_dwordx4 v181, s[32:35], s101 offen offset:1024 sc1 lds
    s_waitcnt lgkmcnt(6)
    v_mfma_f32_16x16x32_bf16 v[20:23], v[244:247], v[116:119], v[20:23]
    ds_read_b128 v[108:111], v1 offset:45056
    ds_read_b128 v[112:115], v1 offset:47104
    v_mfma_f32_16x16x32_bf16 v[24:27], v[244:247], v[120:123], v[24:27]
    ds_read_b128 v[116:119], v1 offset:46080
    s_waitcnt lgkmcnt(7)
    v_mfma_f32_16x16x32_bf16 v[20:23], v[240:243], v[124:127], v[20:23]
    ds_read_b128 v[120:123], v1 offset:48128
    v_mfma_f32_16x16x32_bf16 v[24:27], v[240:243], v[128:131], v[24:27]
    s_barrier
    ds_read_b128 v[124:127], v1 offset:49152
    s_waitcnt lgkmcnt(7)
    v_mfma_f32_16x16x32_bf16 v[20:23], v[236:239], v[132:135], v[20:23]
    ds_read_b128 v[128:131], v1 offset:51200
    s_add_u32 m0, s99, 0x4000
    v_mfma_f32_16x16x32_bf16 v[24:27], v[236:239], v[136:139], v[24:27]
    ds_read_b128 v[132:135], v1 offset:50176
    s_add_u32 s101, s56, 0xa1c000
    s_waitcnt lgkmcnt(7)
    v_mfma_f32_16x16x32_bf16 v[20:23], v[232:235], v[140:143], v[20:23]
    buffer_load_dwordx4 v181, s[32:35], s101 offen offset:0 sc1 lds
    v_mfma_f32_16x16x32_bf16 v[24:27], v[232:235], v[144:147], v[24:27]
    ds_read_b128 v[136:139], v1 offset:52224
    ds_read_b128 v[140:143], v1 offset:53248
    s_waitcnt lgkmcnt(7)
    v_mfma_f32_16x16x32_bf16 v[20:23], a[128:131], v[108:111], v[20:23]
    buffer_load_dwordx4 v181, s[32:35], s101 offen offset:1024 sc1 lds
    v_mfma_f32_16x16x32_bf16 v[24:27], a[128:131], v[112:115], v[24:27]
    ds_read_b128 v[144:147], v1 offset:55296
    ds_read_b128 v[108:111], v1 offset:54272
    s_waitcnt lgkmcnt(7)
    v_mfma_f32_16x16x32_bf16 v[20:23], a[132:135], v[116:119], v[20:23]
    ds_read_b128 v[112:115], v1 offset:56320
    s_add_u32 m0, s99, 0x6000
    v_mfma_f32_16x16x32_bf16 v[24:27], a[132:135], v[120:123], v[24:27]
    ds_read_b128 v[116:119], v1 offset:57344
    s_add_u32 s101, s56, 0xa1e000
    s_waitcnt lgkmcnt(7)
    v_mfma_f32_16x16x32_bf16 v[20:23], a[136:139], v[124:127], v[20:23]
    buffer_load_dwordx4 v181, s[32:35], s101 offen offset:0 sc1 lds
    v_mfma_f32_16x16x32_bf16 v[24:27], a[136:139], v[128:131], v[24:27]
    ds_read_b128 v[120:123], v1 offset:59392
    ds_read_b128 v[124:127], v1 offset:58368
    s_waitcnt lgkmcnt(7)
    v_mfma_f32_16x16x32_bf16 v[20:23], a[140:143], v[132:135], v[20:23]
    buffer_load_dwordx4 v181, s[32:35], s101 offen offset:1024 sc1 lds
    v_mfma_f32_16x16x32_bf16 v[24:27], a[140:143], v[136:139], v[24:27]
    ds_read_b128 v[128:131], v1 offset:60416
    ds_read_b128 v[132:135], v1 offset:61440
    s_waitcnt lgkmcnt(7)
    v_mfma_f32_16x16x32_bf16 v[20:23], a[144:147], v[140:143], v[20:23]
    ds_read_b128 v[136:139], v1 offset:63488
    v_mfma_f32_16x16x32_bf16 v[24:27], a[144:147], v[144:147], v[24:27]
    ds_read_b128 v[140:143], v1 offset:62464
    s_waitcnt lgkmcnt(7)
    v_mfma_f32_16x16x32_bf16 v[20:23], a[148:151], v[108:111], v[20:23]
    ds_read_b128 v[144:147], v1 offset:64512
    v_mfma_f32_16x16x32_bf16 v[24:27], a[148:151], v[112:115], v[24:27]
    ds_read_b128 v[108:111], v2 offset:0
    s_waitcnt lgkmcnt(7)
    v_mfma_f32_16x16x32_bf16 v[20:23], a[152:155], v[116:119], v[20:23]
    ds_read_b128 v[112:115], v2 offset:2048
    v_mfma_f32_16x16x32_bf16 v[24:27], a[152:155], v[120:123], v[24:27]
    ds_read_b128 v[116:119], v2 offset:1024
    s_waitcnt lgkmcnt(7)
    v_mfma_f32_16x16x32_bf16 v[20:23], a[156:159], v[124:127], v[20:23]
    ds_read_b128 v[120:123], v2 offset:3072
    v_mfma_f32_16x16x32_bf16 v[24:27], a[156:159], v[128:131], v[24:27]
    ds_read_b128 v[124:127], v2 offset:4096
    s_waitcnt lgkmcnt(7)
    v_mfma_f32_16x16x32_bf16 v[20:23], a[160:163], v[132:135], v[20:23]
    ds_read_b128 v[128:131], v2 offset:6144
    v_mfma_f32_16x16x32_bf16 v[24:27], a[160:163], v[136:139], v[24:27]
    s_waitcnt vmcnt(8)
    s_barrier
    ds_read_b128 v[132:135], v2 offset:8192
    s_waitcnt lgkmcnt(7)
    v_mfma_f32_16x16x32_bf16 v[20:23], a[164:167], v[140:143], v[20:23]
    ds_read_b128 v[136:139], v2 offset:10240
    s_add_u32 m0, s99, 0x8000
    v_mfma_f32_16x16x32_bf16 v[24:27], a[164:167], v[144:147], v[24:27]
    ds_read_b128 v[140:143], v2 offset:9216
    s_add_u32 s101, s56, 0xa20000
    s_waitcnt lgkmcnt(7)
    v_mfma_f32_16x16x32_bf16 v[20:23], a[168:171], v[108:111], v[20:23]
    buffer_load_dwordx4 v181, s[32:35], s101 offen offset:0 sc1 lds
    v_mfma_f32_16x16x32_bf16 v[24:27], a[168:171], v[112:115], v[24:27]
    ds_read_b128 v[144:147], v2 offset:11264
    ds_read_b128 v[108:111], v2 offset:12288
    s_waitcnt lgkmcnt(7)
    v_mfma_f32_16x16x32_bf16 v[20:23], a[172:175], v[116:119], v[20:23]
    buffer_load_dwordx4 v181, s[32:35], s101 offen offset:1024 sc1 lds
    v_mfma_f32_16x16x32_bf16 v[24:27], a[172:175], v[120:123], v[24:27]
    ds_read_b128 v[112:115], v2 offset:14336
    ds_read_b128 v[116:119], v2 offset:13312
    s_waitcnt lgkmcnt(7)
    v_mfma_f32_16x16x32_bf16 v[20:23], a[176:179], v[124:127], v[20:23]
    ds_read_b128 v[120:123], v2 offset:15360
    s_add_u32 m0, s99, 0xa000
    v_mfma_f32_16x16x32_bf16 v[24:27], a[176:179], v[128:131], v[24:27]
    s_waitcnt vmcnt(8)
    s_barrier
    ds_read_b128 v[124:127], v1 offset:0
    s_add_u32 s101, s56, 0xa22000
    s_waitcnt lgkmcnt(7)
    v_mfma_f32_16x16x32_bf16 v[28:31], a[196:199], v[132:135], v[28:31]
    buffer_load_dwordx4 v181, s[32:35], s101 offen offset:0 sc1 lds
    v_mfma_f32_16x16x32_bf16 v[32:35], a[196:199], v[136:139], v[32:35]
    ds_read_b128 v[128:131], v1 offset:2048
    ds_read_b128 v[132:135], v1 offset:1024
    s_add_u32 s82, s55, s63
    s_waitcnt lgkmcnt(7)
    v_mfma_f32_16x16x32_bf16 v[28:31], a[200:203], v[140:143], v[28:31]
    buffer_load_dwordx4 v181, s[32:35], s101 offen offset:1024 sc1 lds
    v_mfma_f32_16x16x32_bf16 v[32:35], a[200:203], v[144:147], v[32:35]
    ds_read_b128 v[136:139], v1 offset:3072
    ds_read_b128 v[140:143], v1 offset:4096
    s_add_u32 s82, s82, 0
    s_waitcnt lgkmcnt(7)
    v_mfma_f32_16x16x32_bf16 v[28:31], a[204:207], v[108:111], v[28:31]
    ds_read_b128 v[144:147], v1 offset:6144
    s_add_u32 m0, s99, 0xc000
    v_mfma_f32_16x16x32_bf16 v[32:35], a[204:207], v[112:115], v[32:35]
    ds_read_b128 v[108:111], v1 offset:5120
    s_add_u32 s101, s56, 0xa24000
    s_waitcnt lgkmcnt(7)
    v_mfma_f32_16x16x32_bf16 v[28:31], a[208:211], v[116:119], v[28:31]
    buffer_load_dwordx4 v181, s[32:35], s101 offen offset:0 sc1 lds
    v_mfma_f32_16x16x32_bf16 v[32:35], a[208:211], v[120:123], v[32:35]
    ds_read_b128 v[112:115], v1 offset:7168
    s_waitcnt vmcnt(9)
    s_barrier
    ds_read_b128 v[116:119], v1 offset:8192
    v_cvt_pk_bf16_f32 v156, v20, v21
    s_waitcnt lgkmcnt(7)
    v_mfma_f32_16x16x32_bf16 v[28:31], a[212:215], v[124:127], v[28:31]
    buffer_load_dwordx4 v181, s[32:35], s101 offen offset:1024 sc1 lds
    v_mfma_f32_16x16x32_bf16 v[32:35], a[212:215], v[128:131], v[32:35]
    ds_read_b128 v[120:123], v1 offset:10240
    ds_read_b128 v[124:127], v1 offset:9216
    v_cvt_pk_bf16_f32 v157, v22, v23
    s_waitcnt lgkmcnt(7)
    v_mfma_f32_16x16x32_bf16 v[28:31], a[216:219], v[132:135], v[28:31]
    ds_read_b128 v[128:131], v1 offset:11264
    s_add_u32 m0, s99, 0xe000
    v_cvt_pk_bf16_f32 v158, v24, v25
    v_mfma_f32_16x16x32_bf16 v[32:35], a[216:219], v[136:139], v[32:35]
    ds_read_b128 v[132:135], v1 offset:12288
    s_add_u32 s101, s56, 0xa26000
    v_cvt_pk_bf16_f32 v159, v26, v27
    s_waitcnt lgkmcnt(7)
    v_mfma_f32_16x16x32_bf16 v[28:31], a[220:223], v[140:143], v[28:31]
    buffer_load_dwordx4 v181, s[32:35], s101 offen offset:0 sc1 lds
    v_mfma_f32_16x16x32_bf16 v[32:35], a[220:223], v[144:147], v[32:35]
    ds_read_b128 v[136:139], v1 offset:14336
    ds_read_b128 v[140:143], v1 offset:13312
    s_waitcnt lgkmcnt(7)
    v_mfma_f32_16x16x32_bf16 v[28:31], a[224:227], v[108:111], v[28:31]
    buffer_load_dwordx4 v181, s[32:35], s101 offen offset:1024 sc1 lds
    v_mfma_f32_16x16x32_bf16 v[32:35], a[224:227], v[112:115], v[32:35]
    ds_read_b128 v[144:147], v1 offset:15360
    s_waitcnt vmcnt(10)
    s_barrier
    ds_read_b128 v[108:111], v1 offset:16384
    v_permlane16_swap_b32 v156, v158
    s_waitcnt lgkmcnt(7)
    v_mfma_f32_16x16x32_bf16 v[28:31], a[228:231], v[116:119], v[28:31]
    ds_read_b128 v[112:115], v1 offset:18432
    s_add_u32 m0, s99, 0x10000
    v_permlane16_swap_b32 v157, v159
    v_mfma_f32_16x16x32_bf16 v[32:35], a[228:231], v[120:123], v[32:35]
    ds_read_b128 v[116:119], v1 offset:17408
    s_add_u32 s101, s56, 0xa28000
    buffer_store_dwordx4 v[156:159], v11, s[36:39], s82 offen
    s_waitcnt lgkmcnt(7)
    v_mfma_f32_16x16x32_bf16 v[28:31], a[232:235], v[124:127], v[28:31]
    buffer_load_dwordx4 v181, s[32:35], s101 offen offset:0 sc1 lds
    v_mfma_f32_16x16x32_bf16 v[32:35], a[232:235], v[128:131], v[32:35]
    ds_read_b128 v[120:123], v1 offset:19456
    ds_read_b128 v[124:127], v1 offset:20480
    s_waitcnt lgkmcnt(7)
    v_mfma_f32_16x16x32_bf16 v[28:31], a[236:239], v[132:135], v[28:31]
    buffer_load_dwordx4 v181, s[32:35], s101 offen offset:1024 sc1 lds
    v_mfma_f32_16x16x32_bf16 v[32:35], a[236:239], v[136:139], v[32:35]
    ds_read_b128 v[128:131], v1 offset:22528
    ds_read_b128 v[132:135], v1 offset:21504
    s_waitcnt lgkmcnt(7)
    v_mfma_f32_16x16x32_bf16 v[28:31], a[240:243], v[140:143], v[28:31]
    ds_read_b128 v[136:139], v1 offset:23552
    s_add_u32 m0, s99, 0x12000
    v_mfma_f32_16x16x32_bf16 v[32:35], a[240:243], v[144:147], v[32:35]
    s_waitcnt vmcnt(11)
    s_barrier
    ds_read_b128 v[140:143], v1 offset:24576
    s_add_u32 s101, s56, 0xa2a000
    s_waitcnt lgkmcnt(7)
    v_mfma_f32_16x16x32_bf16 v[28:31], a[244:247], v[108:111], v[28:31]
    buffer_load_dwordx4 v181, s[32:35], s101 offen offset:0 sc1 lds
    v_mfma_f32_16x16x32_bf16 v[32:35], a[244:247], v[112:115], v[32:35]
    ds_read_b128 v[144:147], v1 offset:26624
    ds_read_b128 v[108:111], v1 offset:25600
    s_waitcnt lgkmcnt(7)
    v_mfma_f32_16x16x32_bf16 v[28:31], a[248:251], v[116:119], v[28:31]
    buffer_load_dwordx4 v181, s[32:35], s101 offen offset:1024 sc1 lds
    v_mfma_f32_16x16x32_bf16 v[32:35], a[248:251], v[120:123], v[32:35]
    ds_read_b128 v[112:115], v1 offset:27648
    ds_read_b128 v[116:119], v1 offset:28672
    s_waitcnt lgkmcnt(7)
    v_mfma_f32_16x16x32_bf16 v[28:31], a[252:255], v[124:127], v[28:31]
    ds_read_b128 v[120:123], v1 offset:30720
    v_mfma_f32_16x16x32_bf16 v[32:35], a[252:255], v[128:131], v[32:35]
    ds_read_b128 v[124:127], v1 offset:29696
    s_waitcnt lgkmcnt(7)
    v_mfma_f32_16x16x32_bf16 v[28:31], v[196:199], v[132:135], v[28:31]
    ds_read_b128 v[128:131], v1 offset:31744
    v_mfma_f32_16x16x32_bf16 v[32:35], v[196:199], v[136:139], v[32:35]
    s_waitcnt vmcnt(9)
    s_barrier
    ds_read_b128 v[132:135], v1 offset:32768
    s_waitcnt lgkmcnt(7)
    v_mfma_f32_16x16x32_bf16 v[28:31], v[200:203], v[140:143], v[28:31]
    ds_read_b128 v[136:139], v1 offset:34816
    v_mfma_f32_16x16x32_bf16 v[32:35], v[200:203], v[144:147], v[32:35]
    ds_read_b128 v[140:143], v1 offset:33792
    s_waitcnt lgkmcnt(7)
    v_mfma_f32_16x16x32_bf16 v[28:31], v[204:207], v[108:111], v[28:31]
    ds_read_b128 v[144:147], v1 offset:35840
    v_mfma_f32_16x16x32_bf16 v[32:35], v[204:207], v[112:115], v[32:35]
    ds_read_b128 v[108:111], v1 offset:36864
    s_waitcnt lgkmcnt(7)
    v_mfma_f32_16x16x32_bf16 v[28:31], v[208:211], v[116:119], v[28:31]
    ds_read_b128 v[112:115], v1 offset:38912
    v_mfma_f32_16x16x32_bf16 v[32:35], v[208:211], v[120:123], v[32:35]
    ds_read_b128 v[116:119], v1 offset:37888
    s_waitcnt lgkmcnt(7)
    v_mfma_f32_16x16x32_bf16 v[28:31], v[212:215], v[124:127], v[28:31]
    ds_read_b128 v[120:123], v1 offset:39936
    v_mfma_f32_16x16x32_bf16 v[32:35], v[212:215], v[128:131], v[32:35]
    ds_read_b128 v[124:127], v1 offset:40960
    s_waitcnt lgkmcnt(7)
    v_mfma_f32_16x16x32_bf16 v[28:31], v[216:219], v[132:135], v[28:31]
    ds_read_b128 v[128:131], v1 offset:43008
    v_mfma_f32_16x16x32_bf16 v[32:35], v[216:219], v[136:139], v[32:35]
    ds_read_b128 v[132:135], v1 offset:41984
    s_waitcnt lgkmcnt(7)
    v_mfma_f32_16x16x32_bf16 v[28:31], v[220:223], v[140:143], v[28:31]
    ds_read_b128 v[136:139], v1 offset:44032
    v_mfma_f32_16x16x32_bf16 v[32:35], v[220:223], v[144:147], v[32:35]
    ds_read_b128 v[140:143], v1 offset:45056
    s_waitcnt lgkmcnt(7)
    v_mfma_f32_16x16x32_bf16 v[28:31], v[224:227], v[108:111], v[28:31]
    ds_read_b128 v[144:147], v1 offset:47104
    v_mfma_f32_16x16x32_bf16 v[32:35], v[224:227], v[112:115], v[32:35]
    ds_read_b128 v[108:111], v1 offset:46080
    s_waitcnt lgkmcnt(7)
    v_mfma_f32_16x16x32_bf16 v[28:31], v[228:231], v[116:119], v[28:31]
    ds_read_b128 v[112:115], v1 offset:48128
    v_mfma_f32_16x16x32_bf16 v[32:35], v[228:231], v[120:123], v[32:35]
    s_waitcnt vmcnt(5)
    s_barrier
    ds_read_b128 v[116:119], v1 offset:49152
    s_waitcnt lgkmcnt(7)
    v_mfma_f32_16x16x32_bf16 v[28:31], v[252:255], v[124:127], v[28:31]
    ds_read_b128 v[120:123], v1 offset:51200
    v_mfma_f32_16x16x32_bf16 v[32:35], v[252:255], v[128:131], v[32:35]
    ds_read_b128 v[124:127], v1 offset:50176
    s_waitcnt lgkmcnt(7)
    v_mfma_f32_16x16x32_bf16 v[28:31], v[248:251], v[132:135], v[28:31]
    ds_read_b128 v[128:131], v1 offset:52224
    v_mfma_f32_16x16x32_bf16 v[32:35], v[248:251], v[136:139], v[32:35]
    ds_read_b128 v[132:135], v1 offset:53248
    s_waitcnt lgkmcnt(7)
    v_mfma_f32_16x16x32_bf16 v[28:31], v[244:247], v[140:143], v[28:31]
    ds_read_b128 v[136:139], v1 offset:55296
    v_mfma_f32_16x16x32_bf16 v[32:35], v[244:247], v[144:147], v[32:35]
    ds_read_b128 v[140:143], v1 offset:54272
    s_waitcnt lgkmcnt(7)
    v_mfma_f32_16x16x32_bf16 v[28:31], v[240:243], v[108:111], v[28:31]
    ds_read_b128 v[144:147], v1 offset:56320
    v_mfma_f32_16x16x32_bf16 v[32:35], v[240:243], v[112:115], v[32:35]
    ds_read_b128 v[108:111], v1 offset:57344
    s_waitcnt lgkmcnt(7)
    v_mfma_f32_16x16x32_bf16 v[28:31], v[236:239], v[116:119], v[28:31]
    ds_read_b128 v[112:115], v1 offset:59392
    v_mfma_f32_16x16x32_bf16 v[32:35], v[236:239], v[120:123], v[32:35]
    ds_read_b128 v[116:119], v1 offset:58368
    s_waitcnt lgkmcnt(7)
    v_mfma_f32_16x16x32_bf16 v[28:31], v[232:235], v[124:127], v[28:31]
    ds_read_b128 v[120:123], v1 offset:60416
    v_mfma_f32_16x16x32_bf16 v[32:35], v[232:235], v[128:131], v[32:35]
    ds_read_b128 v[124:127], v1 offset:61440
    s_waitcnt lgkmcnt(7)
    v_mfma_f32_16x16x32_bf16 v[28:31], a[128:131], v[132:135], v[28:31]
    ds_read_b128 v[128:131], v1 offset:63488
    v_mfma_f32_16x16x32_bf16 v[32:35], a[128:131], v[136:139], v[32:35]
    ds_read_b128 v[132:135], v1 offset:62464
    s_waitcnt lgkmcnt(7)
    v_mfma_f32_16x16x32_bf16 v[28:31], a[132:135], v[140:143], v[28:31]
    ds_read_b128 v[136:139], v1 offset:64512
    v_mfma_f32_16x16x32_bf16 v[32:35], a[132:135], v[144:147], v[32:35]
    s_waitcnt vmcnt(0)
    s_barrier
    ds_read_b128 v[140:143], v2 offset:0
    s_waitcnt lgkmcnt(7)
    v_mfma_f32_16x16x32_bf16 v[28:31], a[136:139], v[108:111], v[28:31]
    ds_read_b128 v[144:147], v2 offset:2048
    v_mfma_f32_16x16x32_bf16 v[32:35], a[136:139], v[112:115], v[32:35]
    ds_read_b128 v[108:111], v2 offset:1024
    s_waitcnt lgkmcnt(7)
    v_mfma_f32_16x16x32_bf16 v[28:31], a[140:143], v[116:119], v[28:31]
    ds_read_b128 v[112:115], v2 offset:3072
    v_mfma_f32_16x16x32_bf16 v[32:35], a[140:143], v[120:123], v[32:35]
    ds_read_b128 v[116:119], v2 offset:4096
    s_waitcnt lgkmcnt(7)
    v_mfma_f32_16x16x32_bf16 v[28:31], a[144:147], v[124:127], v[28:31]
    ds_read_b128 v[120:123], v2 offset:6144
    v_mfma_f32_16x16x32_bf16 v[32:35], a[144:147], v[128:131], v[32:35]
    ds_read_b128 v[124:127], v2 offset:5120
    s_waitcnt lgkmcnt(7)
    v_mfma_f32_16x16x32_bf16 v[28:31], a[148:151], v[132:135], v[28:31]
    ds_read_b128 v[128:131], v2 offset:7168
    v_mfma_f32_16x16x32_bf16 v[32:35], a[148:151], v[136:139], v[32:35]
    ds_read_b128 v[132:135], v2 offset:8192
    s_waitcnt lgkmcnt(7)
    v_mfma_f32_16x16x32_bf16 v[28:31], a[152:155], v[140:143], v[28:31]
    ds_read_b128 v[136:139], v2 offset:10240
    v_mfma_f32_16x16x32_bf16 v[32:35], a[152:155], v[144:147], v[32:35]
    ds_read_b128 v[140:143], v2 offset:9216
    s_waitcnt lgkmcnt(7)
    v_mfma_f32_16x16x32_bf16 v[28:31], a[156:159], v[108:111], v[28:31]
    ds_read_b128 v[144:147], v2 offset:11264
    v_mfma_f32_16x16x32_bf16 v[32:35], a[156:159], v[112:115], v[32:35]
    ds_read_b128 v[108:111], v2 offset:12288
    s_waitcnt lgkmcnt(7)
    v_mfma_f32_16x16x32_bf16 v[28:31], a[160:163], v[116:119], v[28:31]
    ds_read_b128 v[112:115], v2 offset:14336
    v_mfma_f32_16x16x32_bf16 v[32:35], a[160:163], v[120:123], v[32:35]
    s_waitcnt lgkmcnt(6)
    v_mfma_f32_16x16x32_bf16 v[28:31], a[164:167], v[124:127], v[28:31]
    v_mfma_f32_16x16x32_bf16 v[32:35], a[164:167], v[128:131], v[32:35]
    s_waitcnt lgkmcnt(4)
    v_mfma_f32_16x16x32_bf16 v[28:31], a[168:171], v[132:135], v[28:31]
    v_mfma_f32_16x16x32_bf16 v[32:35], a[168:171], v[136:139], v[32:35]
    s_waitcnt lgkmcnt(2)
    v_mfma_f32_16x16x32_bf16 v[28:31], a[172:175], v[140:143], v[28:31]
    v_mfma_f32_16x16x32_bf16 v[32:35], a[172:175], v[144:147], v[32:35]
    s_waitcnt lgkmcnt(0)
    v_mfma_f32_16x16x32_bf16 v[28:31], a[176:179], v[108:111], v[28:31]
    v_mfma_f32_16x16x32_bf16 v[32:35], a[176:179], v[112:115], v[32:35]
    s_add_u32 s82, s55, s63
    s_add_u32 s82, s82, 32768
    s_nop 4
    v_cvt_pk_bf16_f32 v160, v28, v29
    v_cvt_pk_bf16_f32 v161, v30, v31
    v_cvt_pk_bf16_f32 v162, v32, v33
    v_cvt_pk_bf16_f32 v163, v34, v35
    s_nop 0
    v_permlane16_swap_b32 v160, v162
    v_permlane16_swap_b32 v161, v163
    buffer_store_dwordx4 v[160:163], v11, s[36:39], s82 offen
    s_or_b32 s76, s2, s50
    s_cbranch_scc1 Lep_127
    s_add_u32 s76, s23, 16
    v_mov_b32 v165, s76
    s_mov_b32 s76, 0x390000
    s_mov_b64 exec, 1
    buffer_store_dword v165, off, s[32:35], s76 sc1
    s_mov_b64 exec, -1
Lep_127:
L_end:
    s_endpgm
Lslow_16:
    buffer_store_dwordx4 v[156:159], v5, s[32:35], s82 offen offset:0 sc1
    buffer_store_dwordx4 v[160:163], v5, s[32:35], s83 offen offset:0 sc1
    s_branch Ljoin_17
Lslow_18:
    buffer_store_dword v19, off, s[32:35], s98 sc1
    s_branch Ljoin_19
Lslow_23:
    buffer_store_dwordx4 v[158:161], v5, s[32:35], s82 offen offset:0 sc1
    s_branch Ljoin_24
Lslow_25:
    buffer_store_dword v19, off, s[32:35], s98 sc1
    s_branch Ljoin_26
Lslow_27:
    buffer_store_dwordx4 v[162:165], v5, s[32:35], s82 offen offset:0 sc1
    s_branch Ljoin_28
Lslow_29:
    buffer_store_dword v108, v15, s[32:35], s41 offen sc1
    buffer_store_dword v116, v15, s[32:35], s84 offen sc1
    s_branch Ljoin_30
Lslow_34:
    buffer_store_dword v19, off, s[32:35], s98 sc1
    s_branch Ljoin_35
Lslow_39:
    buffer_store_dwordx4 v[60:63], v5, s[32:35], s82 offen offset:0 sc1
    s_branch Ljoin_40
Lslow_41:
    buffer_store_dwordx4 v[68:71], v5, s[32:35], s83 offen offset:0 sc1
    s_branch Ljoin_42
Lslow_43:
    buffer_store_dwordx4 v[76:79], v5, s[32:35], s84 offen offset:0 sc1
    s_branch Ljoin_44
Lslow_45:
    buffer_store_dwordx4 v[84:87], v5, s[32:35], s82 offen offset:0 sc1
    s_branch Ljoin_46
Lslow_47:
    buffer_store_dword v19, off, s[32:35], s98 sc1
    s_branch Ljoin_48
Lslow_49:
    buffer_store_dwordx4 v[92:95], v5, s[32:35], s83 offen offset:0 sc1
    s_branch Ljoin_50
Lslow_51:
    buffer_store_dwordx4 v[100:103], v5, s[32:35], s84 offen offset:0 sc1
    s_branch Ljoin_52
Lslow_56:
    buffer_store_dword v19, off, s[32:35], s98 sc1
    s_branch Ljoin_57
Lslow_61:
    buffer_store_dwordx4 v[158:161], v5, s[32:35], s82 offen offset:0 sc1
    s_branch Ljoin_62
Lslow_63:
    buffer_store_dword v162, v15, s[32:35], s83 offen sc1
    s_branch Ljoin_64
Lslow_65:
    buffer_store_dword v19, off, s[32:35], s98 sc1
    s_branch Ljoin_66
Lslow_70:
    buffer_store_dwordx4 v[158:161], v5, s[32:35], s82 offen offset:0 sc1
    s_branch Ljoin_71
Lslow_72:
    buffer_store_dword v162, v15, s[32:35], s83 offen sc1
    s_branch Ljoin_73
Lslow_74:
    buffer_store_dword v19, off, s[32:35], s98 sc1
    s_branch Ljoin_75
Lslow_82:
    buffer_store_dwordx4 v[156:159], v5, s[32:35], s82 offen offset:0 sc1
    buffer_store_dwordx4 v[160:163], v5, s[32:35], s83 offen offset:0 sc1
    s_branch Ljoin_83
Lslow_84:
    buffer_store_dword v19, off, s[32:35], s98 sc1
    s_branch Ljoin_85
Lslow_89:
    buffer_store_dwordx4 v[158:161], v5, s[32:35], s82 offen offset:0 sc1
    s_branch Ljoin_90
Lslow_91:
    buffer_store_dwordx4 v[162:165], v5, s[32:35], s82 offen offset:0 sc1
    s_branch Ljoin_92
Lslow_93:
    buffer_store_dword v108, v15, s[32:35], s41 offen sc1
    buffer_store_dword v116, v15, s[32:35], s84 offen sc1
    s_branch Ljoin_94
Lslow_95:
    buffer_store_dword v19, off, s[32:35], s98 sc1
    s_branch Ljoin_96
Lslow_100:
    buffer_store_dword v19, off, s[32:35], s98 sc1
    s_branch Ljoin_101
Lslow_105:
    buffer_store_dwordx4 v[60:63], v5, s[32:35], s82 offen offset:0 sc1
    s_branch Ljoin_106
Lslow_107:
    buffer_store_dwordx4 v[68:71], v5, s[32:35], s83 offen offset:0 sc1
    s_branch Ljoin_108
Lslow_109:
    buffer_store_dwordx4 v[76:79], v5, s[32:35], s84 offen offset:0 sc1
    s_branch Ljoin_110
Lslow_111:
    buffer_store_dword v19, off, s[32:35], s98 sc1
    s_branch Ljoin_112
Lslow_113:
    buffer_store_dwordx4 v[84:87], v5, s[32:35], s82 offen offset:0 sc1
    s_branch Ljoin_114
Lslow_115:
    buffer_store_dwordx4 v[92:95], v5, s[32:35], s83 offen offset:0 sc1
    s_branch Ljoin_116
Lslow_120:
    buffer_store_dwordx4 v[100:103], v5, s[32:35], s84 offen offset:0 sc1
    s_branch Ljoin_121
Lslow_122:
    buffer_store_dword v19, off, s[32:35], s98 sc1
    s_branch Ljoin_123
.section .rodata,"a"
.p2align 6
.amdhsa_kernel interleave_layers__linear_attn_block__dense_activation_silu__prompt_kernel
  .amdhsa_next_free_vgpr 512
  .amdhsa_next_free_sgpr 102
  .amdhsa_accum_offset 256
  .amdhsa_group_segment_fixed_size 0
  .amdhsa_kernarg_size 72
  .amdhsa_user_sgpr_count 2
  .amdhsa_user_sgpr_kernarg_segment_ptr 1
  .amdhsa_system_sgpr_workgroup_id_x 1
.end_amdhsa_kernel
```
